```python
import torch

def _softmax(x, axis=-1):
    return torch.softmax(x, dim=axis)

def _gelu(x):
    return torch.nn.functional.gelu(x, approximate='tanh')

def _silu(x):
    return torch.nn.functional.silu(x)

def _sigmoid(x):
    return torch.sigmoid(x)

def _layernorm(x, axis=-1, eps=1e-05):
    m = x.mean(dim=axis, keepdim=True)
    v = x.var(dim=axis, keepdim=True, unbiased=False)
    return (x - m) / torch.sqrt(v + eps)

def _scatter_add(tgt, idx, src, axis=0):
    return tgt.clone().index_add_(axis, idx, src)

def _segment_sum(src, seg, n):
    out = torch.zeros((n,) + src.shape[1:], dtype=src.dtype)
    return out.index_add_(0, seg, src)

def _pad(x, pw):
    flat = tuple((v for pair in reversed(pw) for v in pair))
    return torch.nn.functional.pad(x, flat)
kernel_name = 'concat_heads__softmax_full_mha__memory_aug_recurrent_mem_tr__prompt'

def setup_inputs():

    _w = lambda a: (lambda t: t.to(torch.bfloat16) if t.is_floating_point() else t)(torch.as_tensor(a))

    def _A_setup():
        B, S, D = (1, 2048, 576)
        return {'x': _w((lambda *s: torch.randn(*s, dtype=torch.bfloat16) * 0.2)(B, S, D)), 'wqkv': _w((lambda *s: torch.randn(*s, dtype=torch.bfloat16) * 0.2)(D, 3 * D)), 'wo': _w((lambda *s: torch.randn(*s, dtype=torch.bfloat16) * 0.05)(D, D))}
    _A_in = _A_setup()

    def _B_setup():
        B, S, Dm = (1, 2048, 576)
        H, Dh = (32, 128)
        M, seg = (8, 32)
        seg = min(seg, S)
        S = S // seg * seg
        return {'x': _w((lambda *s: torch.randn(*s, dtype=torch.bfloat16) * 0.05)(B, S, Dm)), 'mem0': _w((lambda *s: torch.randn(*s, dtype=torch.bfloat16) * 0.8)(B, M, Dm)), 'Wq': _w((lambda *s: torch.randn(*s, dtype=torch.bfloat16) * 1.6)(Dm, H, Dh) * Dm ** (-0.5)), 'Wk': _w((lambda *s: torch.randn(*s, dtype=torch.bfloat16) * 1.6)(Dm, H, Dh) * Dm ** (-0.5)), 'Wv': _w((lambda *s: torch.randn(*s, dtype=torch.bfloat16) * 0.8)(Dm, H, Dh) * Dm ** (-0.5)), 'Wo': _w((lambda *s: torch.randn(*s, dtype=torch.bfloat16) * 0.8)(H, Dh, Dm) * (H * Dh) ** (-0.5)), 'seg_len': seg}
    _B_in = _B_setup()
    return {'A_x': _A_in['x'], 'A_wqkv': _A_in['wqkv'], 'A_wo': _A_in['wo'], 'B_x': _B_in['x'], 'B_mem0': _B_in['mem0'], 'B_Wq': _B_in['Wq'], 'B_Wk': _B_in['Wk'], 'B_Wv': _B_in['Wv'], 'B_Wo': _B_in['Wo'], 'B_seg_len': _B_in['seg_len']}

def reference(A_x, A_wqkv, A_wo, B_x, B_mem0, B_Wq, B_Wk, B_Wv, B_Wo, B_seg_len):

    def _A_ref(x, wqkv, wo):
        B, S, D = x.shape
        H = 32
        Dh = D // H
        qkv = (lambda x, *d: x.permute(*d))((x @ wqkv).reshape(B, S, 3, H, Dh), 2, 0, 3, 1, 4)
        q, k, v = (qkv[0], qkv[1], qkv[2])
        scale = Dh ** (-0.5)
        scores = torch.einsum('bhqd,bhkd->bhqk', q, k) * scale
        p = _softmax(scores, axis=-1)
        o = torch.einsum('bhqk,bhkd->bhqd', p, v)
        return (lambda x, *d: x.permute(*d))(o, 0, 2, 1, 3).reshape(B, S, D) @ wo

    def _B_ref(x, mem0, Wq, Wk, Wv, Wo, seg_len):
        B, S, Dm = x.shape
        H, Dh = (Wq.shape[1], Wq.shape[2])
        M = mem0.shape[1]
        scale = Dh ** (-0.5)
        n_seg = S // seg_len
        L = M + seg_len
        idx = torch.arange(L)
        mask = (idx[:, None] < M) | (idx[:, None] >= idx[None, :])
        mem = mem0
        outs = []
        for s in range(n_seg):
            xs = x[:, s * seg_len:(s + 1) * seg_len, :].clone()
            h = torch.concatenate([mem, xs], axis=1)
            q = torch.einsum('btd,dhe->bhte', h, Wq)
            k = torch.einsum('btd,dhe->bhte', h, Wk)
            v = torch.einsum('btd,dhe->bhte', h, Wv)
            scores = torch.einsum('bhqe,bhke->bhqk', q, k) * scale
            scores = torch.where(mask[None, None], scores, -1000000000.0)
            p = _softmax(scores, axis=-1)
            o = torch.einsum('bhqk,bhke->bhqe', p, v)
            o = torch.einsum('bhte,hed->btd', o, Wo)
            mem = o[:, :M, :].clone()
            outs.append(o[:, M:, :])
        return torch.concatenate(outs, axis=1)
    a = _A_ref(A_x, A_wqkv, A_wo)
    b = _B_ref(B_x, B_mem0, B_Wq, B_Wk, B_Wv, B_Wo, B_seg_len)
    return torch.concatenate([a, b], axis=-1)
```

```asm
; @launch grid=(256,1,1) block=(256,1,1) lds=163840
.amdgcn_target "amdgcn-amd-amdhsa--gfx950"
.text
.globl concat_heads__softmax_full_mha__memory_aug_recurrent_mem_tr__prompt_kernel
.p2align 8
.type concat_heads__softmax_full_mha__memory_aug_recurrent_mem_tr__prompt_kernel,@function
concat_heads__softmax_full_mha__memory_aug_recurrent_mem_tr__prompt_kernel:
    s_cmp_ge_u32 s2, 256
    s_cbranch_scc1 K_exit
    s_and_b32 s6, s2, 7
    s_lshr_b32 s7, s2, 3
    s_cmp_eq_u32 s6, 0
    s_cbranch_scc1 K_rc
    s_cmp_ge_u32 s6, 4
    s_cbranch_scc1 K_ra
    s_sub_u32 s6, s6, 1
    s_lshl_b32 s6, s6, 5
    s_add_u32 s6, s6, s7
    s_mul_i32 s3, s6, 21846
    s_lshr_b32 s3, s3, 16
    s_mul_i32 s7, s3, 3
    s_sub_u32 s5, s6, s7
    s_load_dwordx2 s[60:61], s[0:1], 24
    s_load_dwordx4 s[64:67], s[0:1], 40
    s_load_dwordx2 s[68:69], s[0:1], 56
    s_load_dwordx4 s[72:75], s[0:1], 88
    v_lshrrev_b32 v10, 6, v0
    v_and_b32 v0, 63, v0
    v_readfirstlane_b32 s4, v10
    s_waitcnt lgkmcnt(0)
    s_mov_b32 s20, s60
    s_and_b32 s21, s61, 0xffff
    s_mov_b32 s22, 2359296
    s_mov_b32 s23, 0x20000
    s_mov_b32 s8, s64
    s_and_b32 s9, s65, 0xffff
    s_mov_b32 s10, 4718592
    s_mov_b32 s11, 0x20000
    s_mov_b32 s12, s66
    s_and_b32 s13, s67, 0xffff
    s_mov_b32 s14, 4718592
    s_mov_b32 s15, 0x20000
    s_mov_b32 s16, s68
    s_and_b32 s17, s69, 0xffff
    s_mov_b32 s18, 4718592
    s_mov_b32 s19, 0x20000
    s_mov_b32 s24, s74
    s_and_b32 s25, s75, 0xffff
    s_mov_b32 s26, 268435456
    s_mov_b32 s27, 0x20000
    s_mov_b32 s28, s72
    s_mov_b32 s29, s73
    s_mov_b32 s42, 0x3e0293ee
    v_mov_b32 v7, 1
    v_lshlrev_b32 v1, 4, v0
    v_lshrrev_b32 v10, 5, v0
    v_lshlrev_b32 v2, 10, v10
    v_bfe_u32 v10, v0, 4, 1
    v_lshl_add_u32 v2, v10, 8, v2
    v_lshl_add_u32 v2, v10, 5, v2
    v_bfe_u32 v10, v0, 2, 2
    v_lshl_add_u32 v2, v10, 6, v2
    v_and_b32 v10, 3, v0
    v_lshl_add_u32 v2, v10, 3, v2
    v_bfe_u32 v10, v0, 2, 2
    v_bfe_u32 v11, v0, 4, 1
    v_lshl_add_u32 v10, v11, 3, v10
    v_lshrrev_b32 v11, 5, v0
    v_lshl_add_u32 v10, v11, 2, v10
    v_mul_u32_u24 v10, 8192, v10
    v_bfe_u32 v11, v0, 4, 1
    v_lshlrev_b32 v11, 1, v11
    v_xor_b32 v11, v11, v0
    v_and_b32 v11, 3, v11
    v_lshl_add_u32 v4, v11, 4, v10
    v_and_b32 v10, 15, v0
    v_mul_u32_u24 v10, 1152, v10
    v_lshrrev_b32 v5, 4, v0
    v_lshl_add_u32 v5, v5, 4, v10
    s_mul_i32 s35, s4, 24576
    s_add_u32 s35, s35, 36864
    v_add_u32 v2, s35, v2
    v_xor_b32 v3, 32, v2
    s_lshl_b32 s36, s3, 8
    s_lshl_b32 s32, s4, 6
    s_add_u32 s36, s36, s32
    s_lshr_b32 s32, s4, 1
    s_mul_i32 s40, s32, 18432
    s_and_b32 s32, s4, 1
    s_mul_i32 s32, s32, 576
    s_add_u32 s40, s40, s32
    s_mul_i32 s41, s4, 9216
    s_lshl_b32 s48, s3, 12
    s_add_u32 s48, s48, s4
    s_add_u32 s48, s48, 51904512
    s_lshl_b32 s49, s3, 3
    s_lshr_b32 s32, s4, 1
    s_lshl_b32 s32, s32, 2
    s_add_u32 s49, s49, s32
    s_and_b32 s32, s4, 1
    s_lshl_b32 s32, s32, 8
    s_add_u32 s49, s49, s32
    s_add_u32 s49, s49, 51905536
    s_mov_b32 s37, s5
    s_mov_b32 s39, 0
    s_add_u32 s45, s5, 3
    s_mov_b32 s46, 36864
    s_min_u32 s33, s37, 63
    s_mul_i32 s33, s33, 36864
    s_add_u32 s33, s33, s40
    s_add_u32 s34, s39, s41
    s_add_u32 m0, s34, 0
    s_add_u32 s32, s33, 0
    buffer_load_dwordx4 v5, s[20:23], s32 offen lds
    s_add_u32 m0, s34, 1024
    s_add_u32 s32, s33, 64
    buffer_load_dwordx4 v5, s[20:23], s32 offen lds
    s_add_u32 m0, s34, 2048
    s_add_u32 s32, s33, 128
    buffer_load_dwordx4 v5, s[20:23], s32 offen lds
    s_add_u32 m0, s34, 3072
    s_add_u32 s32, s33, 192
    buffer_load_dwordx4 v5, s[20:23], s32 offen lds
    s_add_u32 m0, s34, 4096
    s_add_u32 s32, s33, 256
    buffer_load_dwordx4 v5, s[20:23], s32 offen lds
    s_add_u32 m0, s34, 5120
    s_add_u32 s32, s33, 320
    buffer_load_dwordx4 v5, s[20:23], s32 offen lds
    s_add_u32 m0, s34, 6144
    s_add_u32 s32, s33, 384
    buffer_load_dwordx4 v5, s[20:23], s32 offen lds
    s_add_u32 m0, s34, 7168
    s_add_u32 s32, s33, 448
    buffer_load_dwordx4 v5, s[20:23], s32 offen lds
    s_add_u32 m0, s34, 8192
    s_add_u32 s32, s33, 512
    buffer_load_dwordx4 v5, s[20:23], s32 offen lds
    v_lshrrev_b32 v12, 1, v0
    v_lshlrev_b32 v12, 13, v12
    v_and_b32 v13, 1, v0
    v_lshl_add_u32 v12, v13, 7, v12
    s_lshl_b32 s32, s5, 2
    s_add_u32 s32, s32, s4
    s_mul_i32 s32, s32, 393216
    s_lshl_b32 s33, s3, 8
    s_add_u32 s32, s32, s33
    s_add_u32 s33, s32, 131072
    buffer_load_dword v74, v12, s[12:15], s32 offen
    buffer_load_dword v75, v12, s[12:15], s33 offen
    buffer_load_dword v76, v12, s[16:19], s32 offen
    buffer_load_dword v77, v12, s[16:19], s33 offen
    v_mov_b32 v72, 0xffbfffbf
    v_mov_b32 v73, 0xffbfffbf
    v_lshrrev_b32 v78, 1, v1
    s_add_u32 m0, s35, 0
    s_add_u32 s32, s36, 0
    buffer_load_dwordx4 v4, s[12:15], s32 offen lds
    s_add_u32 m0, s35, 1024
    s_add_u32 s32, s36, 131072
    buffer_load_dwordx4 v4, s[12:15], s32 offen lds
    s_add_u32 m0, s35, 2048
    s_add_u32 s32, s36, 262144
    buffer_load_dwordx4 v4, s[12:15], s32 offen lds
    s_add_u32 m0, s35, 3072
    s_add_u32 s32, s36, 393216
    buffer_load_dwordx4 v4, s[12:15], s32 offen lds
    s_add_u32 m0, s35, 4096
    s_add_u32 s32, s36, 524288
    buffer_load_dwordx4 v4, s[12:15], s32 offen lds
    s_add_u32 m0, s35, 5120
    s_add_u32 s32, s36, 655360
    buffer_load_dwordx4 v4, s[12:15], s32 offen lds
    s_add_u32 m0, s35, 6144
    s_add_u32 s32, s36, 786432
    buffer_load_dwordx4 v4, s[12:15], s32 offen lds
    s_add_u32 m0, s35, 7168
    s_add_u32 s32, s36, 917504
    buffer_load_dwordx4 v4, s[12:15], s32 offen lds
    s_add_u32 m0, s35, 8192
    s_add_u32 s32, s36, 1048576
    buffer_load_dwordx4 v4, s[12:15], s32 offen lds
    s_add_u32 m0, s35, 9216
    s_add_u32 s32, s36, 1179648
    buffer_load_dwordx4 v4, s[12:15], s32 offen lds
    s_add_u32 m0, s35, 10240
    s_add_u32 s32, s36, 1310720
    buffer_load_dwordx4 v4, s[12:15], s32 offen lds
    s_add_u32 m0, s35, 11264
    s_add_u32 s32, s36, 1441792
    buffer_load_dwordx4 v4, s[12:15], s32 offen lds
    s_add_u32 m0, s35, 12288
    s_add_u32 s32, s36, 1572864
    buffer_load_dwordx4 v4, s[12:15], s32 offen lds
    s_add_u32 m0, s35, 13312
    s_add_u32 s32, s36, 1703936
    buffer_load_dwordx4 v4, s[12:15], s32 offen lds
    s_add_u32 m0, s35, 14336
    s_add_u32 s32, s36, 1835008
    buffer_load_dwordx4 v4, s[12:15], s32 offen lds
    s_add_u32 m0, s35, 15360
    s_add_u32 s32, s36, 1966080
    buffer_load_dwordx4 v4, s[12:15], s32 offen lds
    s_add_u32 m0, s35, 16384
    s_add_u32 s32, s36, 2097152
    buffer_load_dwordx4 v4, s[12:15], s32 offen lds
    s_add_u32 m0, s35, 17408
    s_add_u32 s32, s36, 2228224
    buffer_load_dwordx4 v4, s[12:15], s32 offen lds
    s_add_u32 m0, s35, 18432
    s_add_u32 s32, s36, 2359296
    buffer_load_dwordx4 v4, s[12:15], s32 offen lds
    s_add_u32 m0, s35, 19456
    s_add_u32 s32, s36, 2490368
    buffer_load_dwordx4 v4, s[12:15], s32 offen lds
    s_add_u32 m0, s35, 20480
    s_add_u32 s32, s36, 2621440
    buffer_load_dwordx4 v4, s[12:15], s32 offen lds
    s_add_u32 m0, s35, 21504
    s_add_u32 s32, s36, 2752512
    buffer_load_dwordx4 v4, s[12:15], s32 offen lds
    s_add_u32 m0, s35, 22528
    s_add_u32 s32, s36, 2883584
    buffer_load_dwordx4 v4, s[12:15], s32 offen lds
    s_add_u32 m0, s35, 23552
    s_add_u32 s32, s36, 3014656
    buffer_load_dwordx4 v4, s[12:15], s32 offen lds
    s_waitcnt vmcnt(16)
    ds_read_b64_tr_b16 a[0:1], v2 offset:0
    ds_read_b64_tr_b16 a[2:3], v2 offset:512
    ds_read_b64_tr_b16 a[72:73], v3 offset:0
    ds_read_b64_tr_b16 a[74:75], v3 offset:512
    ds_read_b64_tr_b16 a[4:5], v2 offset:2048
    ds_read_b64_tr_b16 a[6:7], v2 offset:2560
    ds_read_b64_tr_b16 a[76:77], v3 offset:2048
    ds_read_b64_tr_b16 a[78:79], v3 offset:2560
    ds_read_b64_tr_b16 a[8:9], v2 offset:4096
    ds_read_b64_tr_b16 a[10:11], v2 offset:4608
    ds_read_b64_tr_b16 a[80:81], v3 offset:4096
    ds_read_b64_tr_b16 a[82:83], v3 offset:4608
    ds_read_b64_tr_b16 a[12:13], v2 offset:6144
    ds_read_b64_tr_b16 a[14:15], v2 offset:6656
    ds_read_b64_tr_b16 a[84:85], v3 offset:6144
    ds_read_b64_tr_b16 a[86:87], v3 offset:6656
    s_waitcnt lgkmcnt(0)
    s_add_u32 m0, s35, 0
    s_add_u32 s32, s36, 3145728
    buffer_load_dwordx4 v4, s[12:15], s32 offen lds
    s_add_u32 m0, s35, 1024
    s_add_u32 s32, s36, 3276800
    buffer_load_dwordx4 v4, s[12:15], s32 offen lds
    s_add_u32 m0, s35, 2048
    s_add_u32 s32, s36, 3407872
    buffer_load_dwordx4 v4, s[12:15], s32 offen lds
    s_add_u32 m0, s35, 3072
    s_add_u32 s32, s36, 3538944
    buffer_load_dwordx4 v4, s[12:15], s32 offen lds
    s_add_u32 m0, s35, 4096
    s_add_u32 s32, s36, 3670016
    buffer_load_dwordx4 v4, s[12:15], s32 offen lds
    s_add_u32 m0, s35, 5120
    s_add_u32 s32, s36, 3801088
    buffer_load_dwordx4 v4, s[12:15], s32 offen lds
    s_add_u32 m0, s35, 6144
    s_add_u32 s32, s36, 3932160
    buffer_load_dwordx4 v4, s[12:15], s32 offen lds
    s_add_u32 m0, s35, 7168
    s_add_u32 s32, s36, 4063232
    buffer_load_dwordx4 v4, s[12:15], s32 offen lds
    s_waitcnt vmcnt(16)
    ds_read_b64_tr_b16 a[16:17], v2 offset:8192
    ds_read_b64_tr_b16 a[18:19], v2 offset:8704
    ds_read_b64_tr_b16 a[88:89], v3 offset:8192
    ds_read_b64_tr_b16 a[90:91], v3 offset:8704
    ds_read_b64_tr_b16 a[20:21], v2 offset:10240
    ds_read_b64_tr_b16 a[22:23], v2 offset:10752
    ds_read_b64_tr_b16 a[92:93], v3 offset:10240
    ds_read_b64_tr_b16 a[94:95], v3 offset:10752
    ds_read_b64_tr_b16 a[24:25], v2 offset:12288
    ds_read_b64_tr_b16 a[26:27], v2 offset:12800
    ds_read_b64_tr_b16 a[96:97], v3 offset:12288
    ds_read_b64_tr_b16 a[98:99], v3 offset:12800
    ds_read_b64_tr_b16 a[28:29], v2 offset:14336
    ds_read_b64_tr_b16 a[30:31], v2 offset:14848
    ds_read_b64_tr_b16 a[100:101], v3 offset:14336
    ds_read_b64_tr_b16 a[102:103], v3 offset:14848
    s_waitcnt lgkmcnt(0)
    s_add_u32 m0, s35, 8192
    s_add_u32 s32, s36, 4194304
    buffer_load_dwordx4 v4, s[12:15], s32 offen lds
    s_add_u32 m0, s35, 9216
    s_add_u32 s32, s36, 4325376
    buffer_load_dwordx4 v4, s[12:15], s32 offen lds
    s_add_u32 m0, s35, 10240
    s_add_u32 s32, s36, 4456448
    buffer_load_dwordx4 v4, s[12:15], s32 offen lds
    s_add_u32 m0, s35, 11264
    s_add_u32 s32, s36, 4587520
    buffer_load_dwordx4 v4, s[12:15], s32 offen lds
    s_add_u32 m0, s35, 12288
    s_add_u32 s32, s36, 0
    buffer_load_dwordx4 v4, s[16:19], s32 offen lds
    s_add_u32 m0, s35, 13312
    s_add_u32 s32, s36, 131072
    buffer_load_dwordx4 v4, s[16:19], s32 offen lds
    s_add_u32 m0, s35, 14336
    s_add_u32 s32, s36, 262144
    buffer_load_dwordx4 v4, s[16:19], s32 offen lds
    s_add_u32 m0, s35, 15360
    s_add_u32 s32, s36, 393216
    buffer_load_dwordx4 v4, s[16:19], s32 offen lds
    s_waitcnt vmcnt(16)
    ds_read_b64_tr_b16 a[32:33], v2 offset:16384
    ds_read_b64_tr_b16 a[34:35], v2 offset:16896
    ds_read_b64_tr_b16 a[104:105], v3 offset:16384
    ds_read_b64_tr_b16 a[106:107], v3 offset:16896
    ds_read_b64_tr_b16 a[36:37], v2 offset:18432
    ds_read_b64_tr_b16 a[38:39], v2 offset:18944
    ds_read_b64_tr_b16 a[108:109], v3 offset:18432
    ds_read_b64_tr_b16 a[110:111], v3 offset:18944
    ds_read_b64_tr_b16 a[40:41], v2 offset:20480
    ds_read_b64_tr_b16 a[42:43], v2 offset:20992
    ds_read_b64_tr_b16 a[112:113], v3 offset:20480
    ds_read_b64_tr_b16 a[114:115], v3 offset:20992
    ds_read_b64_tr_b16 a[44:45], v2 offset:22528
    ds_read_b64_tr_b16 a[46:47], v2 offset:23040
    ds_read_b64_tr_b16 a[116:117], v3 offset:22528
    ds_read_b64_tr_b16 a[118:119], v3 offset:23040
    s_waitcnt lgkmcnt(0)
    s_add_u32 m0, s35, 16384
    s_add_u32 s32, s36, 524288
    buffer_load_dwordx4 v4, s[16:19], s32 offen lds
    s_add_u32 m0, s35, 17408
    s_add_u32 s32, s36, 655360
    buffer_load_dwordx4 v4, s[16:19], s32 offen lds
    s_add_u32 m0, s35, 18432
    s_add_u32 s32, s36, 786432
    buffer_load_dwordx4 v4, s[16:19], s32 offen lds
    s_add_u32 m0, s35, 19456
    s_add_u32 s32, s36, 917504
    buffer_load_dwordx4 v4, s[16:19], s32 offen lds
    s_add_u32 m0, s35, 20480
    s_add_u32 s32, s36, 1048576
    buffer_load_dwordx4 v4, s[16:19], s32 offen lds
    s_add_u32 m0, s35, 21504
    s_add_u32 s32, s36, 1179648
    buffer_load_dwordx4 v4, s[16:19], s32 offen lds
    s_add_u32 m0, s35, 22528
    s_add_u32 s32, s36, 1310720
    buffer_load_dwordx4 v4, s[16:19], s32 offen lds
    s_add_u32 m0, s35, 23552
    s_add_u32 s32, s36, 1441792
    buffer_load_dwordx4 v4, s[16:19], s32 offen lds
    s_waitcnt vmcnt(16)
    ds_read_b64_tr_b16 a[48:49], v2 offset:0
    ds_read_b64_tr_b16 a[50:51], v2 offset:512
    ds_read_b64_tr_b16 a[120:121], v3 offset:0
    ds_read_b64_tr_b16 a[122:123], v3 offset:512
    ds_read_b64_tr_b16 a[52:53], v2 offset:2048
    ds_read_b64_tr_b16 a[54:55], v2 offset:2560
    ds_read_b64_tr_b16 a[124:125], v3 offset:2048
    ds_read_b64_tr_b16 a[126:127], v3 offset:2560
    ds_read_b64_tr_b16 a[56:57], v2 offset:4096
    ds_read_b64_tr_b16 a[58:59], v2 offset:4608
    ds_read_b64_tr_b16 a[128:129], v3 offset:4096
    ds_read_b64_tr_b16 a[130:131], v3 offset:4608
    ds_read_b64_tr_b16 a[60:61], v2 offset:6144
    ds_read_b64_tr_b16 a[62:63], v2 offset:6656
    ds_read_b64_tr_b16 a[132:133], v3 offset:6144
    ds_read_b64_tr_b16 a[134:135], v3 offset:6656
    s_waitcnt lgkmcnt(0)
    s_add_u32 m0, s35, 0
    s_add_u32 s32, s36, 1572864
    buffer_load_dwordx4 v4, s[16:19], s32 offen lds
    s_add_u32 m0, s35, 1024
    s_add_u32 s32, s36, 1703936
    buffer_load_dwordx4 v4, s[16:19], s32 offen lds
    s_add_u32 m0, s35, 2048
    s_add_u32 s32, s36, 1835008
    buffer_load_dwordx4 v4, s[16:19], s32 offen lds
    s_add_u32 m0, s35, 3072
    s_add_u32 s32, s36, 1966080
    buffer_load_dwordx4 v4, s[16:19], s32 offen lds
    s_add_u32 m0, s35, 4096
    s_add_u32 s32, s36, 2097152
    buffer_load_dwordx4 v4, s[16:19], s32 offen lds
    s_add_u32 m0, s35, 5120
    s_add_u32 s32, s36, 2228224
    buffer_load_dwordx4 v4, s[16:19], s32 offen lds
    s_add_u32 m0, s35, 6144
    s_add_u32 s32, s36, 2359296
    buffer_load_dwordx4 v4, s[16:19], s32 offen lds
    s_add_u32 m0, s35, 7168
    s_add_u32 s32, s36, 2490368
    buffer_load_dwordx4 v4, s[16:19], s32 offen lds
    s_waitcnt vmcnt(16)
    ds_read_b64_tr_b16 a[64:65], v2 offset:8192
    ds_read_b64_tr_b16 a[66:67], v2 offset:8704
    ds_read_b64_tr_b16 a[136:137], v3 offset:8192
    ds_read_b64_tr_b16 a[138:139], v3 offset:8704
    ds_read_b64_tr_b16 a[68:69], v2 offset:10240
    ds_read_b64_tr_b16 a[70:71], v2 offset:10752
    ds_read_b64_tr_b16 a[140:141], v3 offset:10240
    ds_read_b64_tr_b16 a[142:143], v3 offset:10752
    ds_read_b64_tr_b16 a[144:145], v2 offset:12288
    ds_read_b64_tr_b16 a[146:147], v2 offset:12800
    ds_read_b64_tr_b16 a[216:217], v3 offset:12288
    ds_read_b64_tr_b16 a[218:219], v3 offset:12800
    ds_read_b64_tr_b16 a[148:149], v2 offset:14336
    ds_read_b64_tr_b16 a[150:151], v2 offset:14848
    ds_read_b64_tr_b16 a[220:221], v3 offset:14336
    ds_read_b64_tr_b16 a[222:223], v3 offset:14848
    s_waitcnt lgkmcnt(0)
    s_add_u32 m0, s35, 8192
    s_add_u32 s32, s36, 2621440
    buffer_load_dwordx4 v4, s[16:19], s32 offen lds
    s_add_u32 m0, s35, 9216
    s_add_u32 s32, s36, 2752512
    buffer_load_dwordx4 v4, s[16:19], s32 offen lds
    s_add_u32 m0, s35, 10240
    s_add_u32 s32, s36, 2883584
    buffer_load_dwordx4 v4, s[16:19], s32 offen lds
    s_add_u32 m0, s35, 11264
    s_add_u32 s32, s36, 3014656
    buffer_load_dwordx4 v4, s[16:19], s32 offen lds
    s_add_u32 m0, s35, 12288
    s_add_u32 s32, s36, 3145728
    buffer_load_dwordx4 v4, s[16:19], s32 offen lds
    s_add_u32 m0, s35, 13312
    s_add_u32 s32, s36, 3276800
    buffer_load_dwordx4 v4, s[16:19], s32 offen lds
    s_add_u32 m0, s35, 14336
    s_add_u32 s32, s36, 3407872
    buffer_load_dwordx4 v4, s[16:19], s32 offen lds
    s_add_u32 m0, s35, 15360
    s_add_u32 s32, s36, 3538944
    buffer_load_dwordx4 v4, s[16:19], s32 offen lds
    s_waitcnt vmcnt(16)
    ds_read_b64_tr_b16 a[152:153], v2 offset:16384
    ds_read_b64_tr_b16 a[154:155], v2 offset:16896
    ds_read_b64_tr_b16 a[224:225], v3 offset:16384
    ds_read_b64_tr_b16 a[226:227], v3 offset:16896
    ds_read_b64_tr_b16 a[156:157], v2 offset:18432
    ds_read_b64_tr_b16 a[158:159], v2 offset:18944
    ds_read_b64_tr_b16 a[228:229], v3 offset:18432
    ds_read_b64_tr_b16 a[230:231], v3 offset:18944
    ds_read_b64_tr_b16 a[160:161], v2 offset:20480
    ds_read_b64_tr_b16 a[162:163], v2 offset:20992
    ds_read_b64_tr_b16 a[232:233], v3 offset:20480
    ds_read_b64_tr_b16 a[234:235], v3 offset:20992
    ds_read_b64_tr_b16 a[164:165], v2 offset:22528
    ds_read_b64_tr_b16 a[166:167], v2 offset:23040
    ds_read_b64_tr_b16 a[236:237], v3 offset:22528
    ds_read_b64_tr_b16 a[238:239], v3 offset:23040
    s_waitcnt lgkmcnt(0)
    s_add_u32 m0, s35, 16384
    s_add_u32 s32, s36, 3670016
    buffer_load_dwordx4 v4, s[16:19], s32 offen lds
    s_add_u32 m0, s35, 17408
    s_add_u32 s32, s36, 3801088
    buffer_load_dwordx4 v4, s[16:19], s32 offen lds
    s_add_u32 m0, s35, 18432
    s_add_u32 s32, s36, 3932160
    buffer_load_dwordx4 v4, s[16:19], s32 offen lds
    s_add_u32 m0, s35, 19456
    s_add_u32 s32, s36, 4063232
    buffer_load_dwordx4 v4, s[16:19], s32 offen lds
    s_add_u32 m0, s35, 20480
    s_add_u32 s32, s36, 4194304
    buffer_load_dwordx4 v4, s[16:19], s32 offen lds
    s_add_u32 m0, s35, 21504
    s_add_u32 s32, s36, 4325376
    buffer_load_dwordx4 v4, s[16:19], s32 offen lds
    s_add_u32 m0, s35, 22528
    s_add_u32 s32, s36, 4456448
    buffer_load_dwordx4 v4, s[16:19], s32 offen lds
    s_add_u32 m0, s35, 23552
    s_add_u32 s32, s36, 4587520
    buffer_load_dwordx4 v4, s[16:19], s32 offen lds
    s_waitcnt vmcnt(16)
    ds_read_b64_tr_b16 a[168:169], v2 offset:0
    ds_read_b64_tr_b16 a[170:171], v2 offset:512
    ds_read_b64_tr_b16 a[240:241], v3 offset:0
    ds_read_b64_tr_b16 a[242:243], v3 offset:512
    ds_read_b64_tr_b16 a[172:173], v2 offset:2048
    ds_read_b64_tr_b16 a[174:175], v2 offset:2560
    ds_read_b64_tr_b16 a[244:245], v3 offset:2048
    ds_read_b64_tr_b16 a[246:247], v3 offset:2560
    ds_read_b64_tr_b16 a[176:177], v2 offset:4096
    ds_read_b64_tr_b16 a[178:179], v2 offset:4608
    ds_read_b64_tr_b16 a[248:249], v3 offset:4096
    ds_read_b64_tr_b16 a[250:251], v3 offset:4608
    ds_read_b64_tr_b16 a[180:181], v2 offset:6144
    ds_read_b64_tr_b16 a[182:183], v2 offset:6656
    ds_read_b64_tr_b16 a[252:253], v3 offset:6144
    ds_read_b64_tr_b16 a[254:255], v3 offset:6656
    s_waitcnt lgkmcnt(0)
    s_waitcnt vmcnt(8)
    ds_read_b64_tr_b16 a[184:185], v2 offset:8192
    ds_read_b64_tr_b16 a[186:187], v2 offset:8704
    ds_read_b64_tr_b16 v[80:81], v3 offset:8192
    ds_read_b64_tr_b16 v[82:83], v3 offset:8704
    ds_read_b64_tr_b16 a[188:189], v2 offset:10240
    ds_read_b64_tr_b16 a[190:191], v2 offset:10752
    ds_read_b64_tr_b16 v[84:85], v3 offset:10240
    ds_read_b64_tr_b16 v[86:87], v3 offset:10752
    ds_read_b64_tr_b16 a[192:193], v2 offset:12288
    ds_read_b64_tr_b16 a[194:195], v2 offset:12800
    ds_read_b64_tr_b16 v[88:89], v3 offset:12288
    ds_read_b64_tr_b16 v[90:91], v3 offset:12800
    ds_read_b64_tr_b16 a[196:197], v2 offset:14336
    ds_read_b64_tr_b16 a[198:199], v2 offset:14848
    ds_read_b64_tr_b16 v[92:93], v3 offset:14336
    ds_read_b64_tr_b16 v[94:95], v3 offset:14848
    s_waitcnt lgkmcnt(0)
    s_waitcnt vmcnt(0)
    ds_read_b64_tr_b16 a[200:201], v2 offset:16384
    ds_read_b64_tr_b16 a[202:203], v2 offset:16896
    ds_read_b64_tr_b16 v[96:97], v3 offset:16384
    ds_read_b64_tr_b16 v[98:99], v3 offset:16896
    ds_read_b64_tr_b16 a[204:205], v2 offset:18432
    ds_read_b64_tr_b16 a[206:207], v2 offset:18944
    ds_read_b64_tr_b16 v[100:101], v3 offset:18432
    ds_read_b64_tr_b16 v[102:103], v3 offset:18944
    ds_read_b64_tr_b16 a[208:209], v2 offset:20480
    ds_read_b64_tr_b16 a[210:211], v2 offset:20992
    ds_read_b64_tr_b16 v[104:105], v3 offset:20480
    ds_read_b64_tr_b16 v[106:107], v3 offset:20992
    ds_read_b64_tr_b16 a[212:213], v2 offset:22528
    ds_read_b64_tr_b16 a[214:215], v2 offset:23040
    ds_read_b64_tr_b16 v[108:109], v3 offset:22528
    ds_read_b64_tr_b16 v[110:111], v3 offset:23040
    s_waitcnt lgkmcnt(0)
    s_cmp_lg_u32 s4, 0
    s_cbranch_scc1 B_iw_d
    v_mov_b32 v10, 128
    s_mov_b32 s44, 0
B_iw:
    global_load_dword v11, v10, s[28:29] sc1
    s_add_u32 s44, s44, 1
    s_waitcnt vmcnt(0)
    v_readfirstlane_b32 s32, v11
    s_cmp_gt_u32 s44, 200000
    s_nop 3
    s_cbranch_scc1 B_iw_d
    s_and_b32 s32, s32, 0xff
    s_cmp_ge_u32 s32, 32
    s_cbranch_scc1 B_iw_d
    s_sleep 8
    s_branch B_iw
B_iw_d:
    s_barrier
    s_min_u32 s33, s45, 63
    s_mul_i32 s33, s33, 36864
    s_add_u32 s33, s33, s40
    s_add_u32 s34, s46, s41
    s_add_u32 m0, s34, 0
    s_add_u32 s32, s33, 0
    buffer_load_dwordx4 v5, s[20:23], s32 offen lds
    s_add_u32 m0, s34, 1024
    s_add_u32 s32, s33, 64
    buffer_load_dwordx4 v5, s[20:23], s32 offen lds
    s_add_u32 m0, s34, 2048
    s_add_u32 s32, s33, 128
    buffer_load_dwordx4 v5, s[20:23], s32 offen lds
    s_add_u32 m0, s34, 3072
    s_add_u32 s32, s33, 192
    buffer_load_dwordx4 v5, s[20:23], s32 offen lds
    s_add_u32 m0, s34, 4096
    s_add_u32 s32, s33, 256
    buffer_load_dwordx4 v5, s[20:23], s32 offen lds
    s_add_u32 m0, s34, 5120
    s_add_u32 s32, s33, 320
    buffer_load_dwordx4 v5, s[20:23], s32 offen lds
    s_add_u32 m0, s34, 6144
    s_add_u32 s32, s33, 384
    buffer_load_dwordx4 v5, s[20:23], s32 offen lds
    s_add_u32 m0, s34, 7168
    s_add_u32 s32, s33, 448
    buffer_load_dwordx4 v5, s[20:23], s32 offen lds
    s_add_u32 m0, s34, 8192
    s_add_u32 s32, s33, 512
    buffer_load_dwordx4 v5, s[20:23], s32 offen lds
    s_mov_b32 s47, 192
    s_waitcnt vmcnt(9)
B_kv:
    s_barrier
    s_add_u32 s45, s45, 3
    s_add_u32 s46, s46, 36864
    s_cmp_eq_u32 s46, 110592
    s_cselect_b32 s46, 0, s46
    s_min_u32 s33, s45, 63
    s_mul_i32 s33, s33, 36864
    s_add_u32 s33, s33, s40
    s_add_u32 s34, s46, s41
    s_add_u32 m0, s34, 0
    s_add_u32 s32, s33, 0
    buffer_load_dwordx4 v5, s[20:23], s32 offen lds
    s_add_u32 m0, s34, 1024
    s_add_u32 s32, s33, 64
    buffer_load_dwordx4 v5, s[20:23], s32 offen lds
    s_add_u32 m0, s34, 2048
    s_add_u32 s32, s33, 128
    buffer_load_dwordx4 v5, s[20:23], s32 offen lds
    s_add_u32 m0, s34, 3072
    s_add_u32 s32, s33, 192
    buffer_load_dwordx4 v5, s[20:23], s32 offen lds
    s_add_u32 m0, s34, 4096
    s_add_u32 s32, s33, 256
    buffer_load_dwordx4 v5, s[20:23], s32 offen lds
    s_add_u32 m0, s34, 5120
    s_add_u32 s32, s33, 320
    buffer_load_dwordx4 v5, s[20:23], s32 offen lds
    s_add_u32 m0, s34, 6144
    s_add_u32 s32, s33, 384
    buffer_load_dwordx4 v5, s[20:23], s32 offen lds
    s_add_u32 m0, s34, 7168
    s_add_u32 s32, s33, 448
    buffer_load_dwordx4 v5, s[20:23], s32 offen lds
    s_add_u32 m0, s34, 8192
    s_add_u32 s32, s33, 512
    buffer_load_dwordx4 v5, s[20:23], s32 offen lds
    v_add_u32 v6, s39, v1
    ds_read_b128 v[8:11], v6 offset:0
    ds_read_b128 v[12:15], v6 offset:18432
    ds_read_b128 v[16:19], v6 offset:1024
    ds_read_b128 v[20:23], v6 offset:19456
    s_waitcnt lgkmcnt(3)
    v_mfma_f32_16x16x32_bf16 v[24:27], a[0:3], v[8:11], 0
    s_waitcnt lgkmcnt(2)
    v_mfma_f32_16x16x32_bf16 v[28:31], a[0:3], v[12:15], 0
    v_mfma_f32_16x16x32_bf16 v[32:35], a[72:75], v[8:11], 0
    v_mfma_f32_16x16x32_bf16 v[36:39], a[72:75], v[12:15], 0
    v_mfma_f32_16x16x32_bf16 v[40:43], v[8:11], a[144:147], 0
    v_mfma_f32_16x16x32_bf16 v[44:47], v[12:15], a[144:147], 0
    v_mfma_f32_16x16x32_bf16 v[48:51], v[8:11], a[216:219], 0
    v_mfma_f32_16x16x32_bf16 v[52:55], v[12:15], a[216:219], 0
    s_waitcnt lgkmcnt(1)
    ds_read_b128 v[8:11], v6 offset:2048
    ds_read_b128 v[12:15], v6 offset:20480
    v_mfma_f32_16x16x32_bf16 v[24:27], a[4:7], v[16:19], v[24:27]
    s_waitcnt lgkmcnt(2)
    v_mfma_f32_16x16x32_bf16 v[28:31], a[4:7], v[20:23], v[28:31]
    v_mfma_f32_16x16x32_bf16 v[32:35], a[76:79], v[16:19], v[32:35]
    v_mfma_f32_16x16x32_bf16 v[36:39], a[76:79], v[20:23], v[36:39]
    v_mfma_f32_16x16x32_bf16 v[40:43], v[16:19], a[148:151], v[40:43]
    v_mfma_f32_16x16x32_bf16 v[44:47], v[20:23], a[148:151], v[44:47]
    v_mfma_f32_16x16x32_bf16 v[48:51], v[16:19], a[220:223], v[48:51]
    v_mfma_f32_16x16x32_bf16 v[52:55], v[20:23], a[220:223], v[52:55]
    s_waitcnt lgkmcnt(1)
    ds_read_b128 v[16:19], v6 offset:3072
    ds_read_b128 v[20:23], v6 offset:21504
    v_mfma_f32_16x16x32_bf16 v[24:27], a[8:11], v[8:11], v[24:27]
    s_waitcnt lgkmcnt(2)
    v_mfma_f32_16x16x32_bf16 v[28:31], a[8:11], v[12:15], v[28:31]
    v_mfma_f32_16x16x32_bf16 v[32:35], a[80:83], v[8:11], v[32:35]
    v_mfma_f32_16x16x32_bf16 v[36:39], a[80:83], v[12:15], v[36:39]
    v_mfma_f32_16x16x32_bf16 v[40:43], v[8:11], a[152:155], v[40:43]
    v_mfma_f32_16x16x32_bf16 v[44:47], v[12:15], a[152:155], v[44:47]
    v_mfma_f32_16x16x32_bf16 v[48:51], v[8:11], a[224:227], v[48:51]
    v_mfma_f32_16x16x32_bf16 v[52:55], v[12:15], a[224:227], v[52:55]
    s_waitcnt lgkmcnt(1)
    ds_read_b128 v[8:11], v6 offset:4096
    ds_read_b128 v[12:15], v6 offset:22528
    v_mfma_f32_16x16x32_bf16 v[24:27], a[12:15], v[16:19], v[24:27]
    s_waitcnt lgkmcnt(2)
    v_mfma_f32_16x16x32_bf16 v[28:31], a[12:15], v[20:23], v[28:31]
    v_mfma_f32_16x16x32_bf16 v[32:35], a[84:87], v[16:19], v[32:35]
    v_mfma_f32_16x16x32_bf16 v[36:39], a[84:87], v[20:23], v[36:39]
    v_mfma_f32_16x16x32_bf16 v[40:43], v[16:19], a[156:159], v[40:43]
    v_mfma_f32_16x16x32_bf16 v[44:47], v[20:23], a[156:159], v[44:47]
    v_mfma_f32_16x16x32_bf16 v[48:51], v[16:19], a[228:231], v[48:51]
    v_mfma_f32_16x16x32_bf16 v[52:55], v[20:23], a[228:231], v[52:55]
    s_waitcnt lgkmcnt(1)
    ds_read_b128 v[16:19], v6 offset:5120
    ds_read_b128 v[20:23], v6 offset:23552
    v_mfma_f32_16x16x32_bf16 v[24:27], a[16:19], v[8:11], v[24:27]
    s_waitcnt lgkmcnt(2)
    v_mfma_f32_16x16x32_bf16 v[28:31], a[16:19], v[12:15], v[28:31]
    v_mfma_f32_16x16x32_bf16 v[32:35], a[88:91], v[8:11], v[32:35]
    v_mfma_f32_16x16x32_bf16 v[36:39], a[88:91], v[12:15], v[36:39]
    v_mfma_f32_16x16x32_bf16 v[40:43], v[8:11], a[160:163], v[40:43]
    v_mfma_f32_16x16x32_bf16 v[44:47], v[12:15], a[160:163], v[44:47]
    v_mfma_f32_16x16x32_bf16 v[48:51], v[8:11], a[232:235], v[48:51]
    v_mfma_f32_16x16x32_bf16 v[52:55], v[12:15], a[232:235], v[52:55]
    ds_read_b128 v[8:11], v6 offset:6144
    ds_read_b128 v[12:15], v6 offset:24576
    s_waitcnt vmcnt(9)
    s_lshl_b32 s33, s47, 2
    s_add_u32 s33, s33, s48
    s_mov_b64 exec, 1
    buffer_store_byte v7, v1, s[24:27], s33 offen sc1
    s_mov_b64 exec, -1
    s_waitcnt lgkmcnt(3)
    v_mfma_f32_16x16x32_bf16 v[24:27], a[20:23], v[16:19], v[24:27]
    s_waitcnt lgkmcnt(2)
    v_mfma_f32_16x16x32_bf16 v[28:31], a[20:23], v[20:23], v[28:31]
    v_mfma_f32_16x16x32_bf16 v[32:35], a[92:95], v[16:19], v[32:35]
    v_mfma_f32_16x16x32_bf16 v[36:39], a[92:95], v[20:23], v[36:39]
    v_mfma_f32_16x16x32_bf16 v[40:43], v[16:19], a[164:167], v[40:43]
    v_mfma_f32_16x16x32_bf16 v[44:47], v[20:23], a[164:167], v[44:47]
    v_mfma_f32_16x16x32_bf16 v[48:51], v[16:19], a[236:239], v[48:51]
    v_mfma_f32_16x16x32_bf16 v[52:55], v[20:23], a[236:239], v[52:55]
    s_waitcnt lgkmcnt(1)
    ds_read_b128 v[16:19], v6 offset:7168
    ds_read_b128 v[20:23], v6 offset:25600
    v_mfma_f32_16x16x32_bf16 v[24:27], a[24:27], v[8:11], v[24:27]
    s_waitcnt lgkmcnt(2)
    v_mfma_f32_16x16x32_bf16 v[28:31], a[24:27], v[12:15], v[28:31]
    v_mfma_f32_16x16x32_bf16 v[32:35], a[96:99], v[8:11], v[32:35]
    v_mfma_f32_16x16x32_bf16 v[36:39], a[96:99], v[12:15], v[36:39]
    v_mfma_f32_16x16x32_bf16 v[40:43], v[8:11], a[168:171], v[40:43]
    v_mfma_f32_16x16x32_bf16 v[44:47], v[12:15], a[168:171], v[44:47]
    v_mfma_f32_16x16x32_bf16 v[48:51], v[8:11], a[240:243], v[48:51]
    v_mfma_f32_16x16x32_bf16 v[52:55], v[12:15], a[240:243], v[52:55]
    s_waitcnt lgkmcnt(1)
    ds_read_b128 v[8:11], v6 offset:8192
    ds_read_b128 v[12:15], v6 offset:26624
    v_mfma_f32_16x16x32_bf16 v[24:27], a[28:31], v[16:19], v[24:27]
    s_waitcnt lgkmcnt(2)
    v_mfma_f32_16x16x32_bf16 v[28:31], a[28:31], v[20:23], v[28:31]
    v_mfma_f32_16x16x32_bf16 v[32:35], a[100:103], v[16:19], v[32:35]
    v_mfma_f32_16x16x32_bf16 v[36:39], a[100:103], v[20:23], v[36:39]
    v_mfma_f32_16x16x32_bf16 v[40:43], v[16:19], a[172:175], v[40:43]
    v_mfma_f32_16x16x32_bf16 v[44:47], v[20:23], a[172:175], v[44:47]
    v_mfma_f32_16x16x32_bf16 v[48:51], v[16:19], a[244:247], v[48:51]
    v_mfma_f32_16x16x32_bf16 v[52:55], v[20:23], a[244:247], v[52:55]
    s_waitcnt lgkmcnt(1)
    ds_read_b128 v[16:19], v6 offset:9216
    ds_read_b128 v[20:23], v6 offset:27648
    v_mfma_f32_16x16x32_bf16 v[24:27], a[32:35], v[8:11], v[24:27]
    s_waitcnt lgkmcnt(2)
    v_mfma_f32_16x16x32_bf16 v[28:31], a[32:35], v[12:15], v[28:31]
    v_mfma_f32_16x16x32_bf16 v[32:35], a[104:107], v[8:11], v[32:35]
    v_mfma_f32_16x16x32_bf16 v[36:39], a[104:107], v[12:15], v[36:39]
    v_mfma_f32_16x16x32_bf16 v[40:43], v[8:11], a[176:179], v[40:43]
    v_mfma_f32_16x16x32_bf16 v[44:47], v[12:15], a[176:179], v[44:47]
    v_mfma_f32_16x16x32_bf16 v[48:51], v[8:11], a[248:251], v[48:51]
    v_mfma_f32_16x16x32_bf16 v[52:55], v[12:15], a[248:251], v[52:55]
    s_waitcnt lgkmcnt(1)
    ds_read_b128 v[8:11], v6 offset:10240
    ds_read_b128 v[12:15], v6 offset:28672
    v_mfma_f32_16x16x32_bf16 v[24:27], a[36:39], v[16:19], v[24:27]
    s_waitcnt lgkmcnt(2)
    v_mfma_f32_16x16x32_bf16 v[28:31], a[36:39], v[20:23], v[28:31]
    v_mfma_f32_16x16x32_bf16 v[32:35], a[108:111], v[16:19], v[32:35]
    v_mfma_f32_16x16x32_bf16 v[36:39], a[108:111], v[20:23], v[36:39]
    v_mfma_f32_16x16x32_bf16 v[40:43], v[16:19], a[180:183], v[40:43]
    v_mfma_f32_16x16x32_bf16 v[44:47], v[20:23], a[180:183], v[44:47]
    v_mfma_f32_16x16x32_bf16 v[48:51], v[16:19], a[252:255], v[48:51]
    v_mfma_f32_16x16x32_bf16 v[52:55], v[20:23], a[252:255], v[52:55]
    s_waitcnt lgkmcnt(1)
    ds_read_b128 v[16:19], v6 offset:11264
    ds_read_b128 v[20:23], v6 offset:29696
    v_mfma_f32_16x16x32_bf16 v[24:27], a[40:43], v[8:11], v[24:27]
    s_waitcnt lgkmcnt(2)
    v_mfma_f32_16x16x32_bf16 v[28:31], a[40:43], v[12:15], v[28:31]
    v_mfma_f32_16x16x32_bf16 v[32:35], a[112:115], v[8:11], v[32:35]
    v_mfma_f32_16x16x32_bf16 v[36:39], a[112:115], v[12:15], v[36:39]
    v_mfma_f32_16x16x32_bf16 v[40:43], v[8:11], a[184:187], v[40:43]
    v_mfma_f32_16x16x32_bf16 v[44:47], v[12:15], a[184:187], v[44:47]
    v_mfma_f32_16x16x32_bf16 v[48:51], v[8:11], v[80:83], v[48:51]
    v_mfma_f32_16x16x32_bf16 v[52:55], v[12:15], v[80:83], v[52:55]
    s_waitcnt lgkmcnt(1)
    ds_read_b128 v[8:11], v6 offset:12288
    ds_read_b128 v[12:15], v6 offset:30720
    v_mfma_f32_16x16x32_bf16 v[24:27], a[44:47], v[16:19], v[24:27]
    s_waitcnt lgkmcnt(2)
    v_mfma_f32_16x16x32_bf16 v[28:31], a[44:47], v[20:23], v[28:31]
    v_mfma_f32_16x16x32_bf16 v[32:35], a[116:119], v[16:19], v[32:35]
    v_mfma_f32_16x16x32_bf16 v[36:39], a[116:119], v[20:23], v[36:39]
    v_mfma_f32_16x16x32_bf16 v[40:43], v[16:19], a[188:191], v[40:43]
    v_mfma_f32_16x16x32_bf16 v[44:47], v[20:23], a[188:191], v[44:47]
    v_mfma_f32_16x16x32_bf16 v[48:51], v[16:19], v[84:87], v[48:51]
    v_mfma_f32_16x16x32_bf16 v[52:55], v[20:23], v[84:87], v[52:55]
    s_waitcnt lgkmcnt(1)
    ds_read_b128 v[16:19], v6 offset:13312
    ds_read_b128 v[20:23], v6 offset:31744
    v_mfma_f32_16x16x32_bf16 v[24:27], a[48:51], v[8:11], v[24:27]
    s_waitcnt lgkmcnt(2)
    v_mfma_f32_16x16x32_bf16 v[28:31], a[48:51], v[12:15], v[28:31]
    v_mfma_f32_16x16x32_bf16 v[32:35], a[120:123], v[8:11], v[32:35]
    v_mfma_f32_16x16x32_bf16 v[36:39], a[120:123], v[12:15], v[36:39]
    v_mfma_f32_16x16x32_bf16 v[40:43], v[8:11], a[192:195], v[40:43]
    v_mfma_f32_16x16x32_bf16 v[44:47], v[12:15], a[192:195], v[44:47]
    v_mfma_f32_16x16x32_bf16 v[48:51], v[8:11], v[88:91], v[48:51]
    v_mfma_f32_16x16x32_bf16 v[52:55], v[12:15], v[88:91], v[52:55]
    s_waitcnt lgkmcnt(1)
    ds_read_b128 v[8:11], v6 offset:14336
    ds_read_b128 v[12:15], v6 offset:32768
    v_mfma_f32_16x16x32_bf16 v[24:27], a[52:55], v[16:19], v[24:27]
    s_waitcnt lgkmcnt(2)
    v_mfma_f32_16x16x32_bf16 v[28:31], a[52:55], v[20:23], v[28:31]
    v_mfma_f32_16x16x32_bf16 v[32:35], a[124:127], v[16:19], v[32:35]
    v_mfma_f32_16x16x32_bf16 v[36:39], a[124:127], v[20:23], v[36:39]
    v_mfma_f32_16x16x32_bf16 v[40:43], v[16:19], a[196:199], v[40:43]
    v_mfma_f32_16x16x32_bf16 v[44:47], v[20:23], a[196:199], v[44:47]
    v_mfma_f32_16x16x32_bf16 v[48:51], v[16:19], v[92:95], v[48:51]
    v_mfma_f32_16x16x32_bf16 v[52:55], v[20:23], v[92:95], v[52:55]
    s_waitcnt lgkmcnt(1)
    ds_read_b128 v[16:19], v6 offset:15360
    ds_read_b128 v[20:23], v6 offset:33792
    v_mfma_f32_16x16x32_bf16 v[24:27], a[56:59], v[8:11], v[24:27]
    s_waitcnt lgkmcnt(2)
    v_mfma_f32_16x16x32_bf16 v[28:31], a[56:59], v[12:15], v[28:31]
    v_mfma_f32_16x16x32_bf16 v[32:35], a[128:131], v[8:11], v[32:35]
    v_mfma_f32_16x16x32_bf16 v[36:39], a[128:131], v[12:15], v[36:39]
    v_mfma_f32_16x16x32_bf16 v[40:43], v[8:11], a[200:203], v[40:43]
    v_mfma_f32_16x16x32_bf16 v[44:47], v[12:15], a[200:203], v[44:47]
    v_mfma_f32_16x16x32_bf16 v[48:51], v[8:11], v[96:99], v[48:51]
    v_mfma_f32_16x16x32_bf16 v[52:55], v[12:15], v[96:99], v[52:55]
    s_waitcnt lgkmcnt(1)
    ds_read_b128 v[8:11], v6 offset:16384
    ds_read_b128 v[12:15], v6 offset:34816
    v_mfma_f32_16x16x32_bf16 v[24:27], a[60:63], v[16:19], v[24:27]
    s_waitcnt lgkmcnt(2)
    v_mfma_f32_16x16x32_bf16 v[28:31], a[60:63], v[20:23], v[28:31]
    v_mfma_f32_16x16x32_bf16 v[32:35], a[132:135], v[16:19], v[32:35]
    v_mfma_f32_16x16x32_bf16 v[36:39], a[132:135], v[20:23], v[36:39]
    v_mfma_f32_16x16x32_bf16 v[40:43], v[16:19], a[204:207], v[40:43]
    v_mfma_f32_16x16x32_bf16 v[44:47], v[20:23], a[204:207], v[44:47]
    v_mfma_f32_16x16x32_bf16 v[48:51], v[16:19], v[100:103], v[48:51]
    v_mfma_f32_16x16x32_bf16 v[52:55], v[20:23], v[100:103], v[52:55]
    s_waitcnt lgkmcnt(1)
    ds_read_b128 v[16:19], v6 offset:17408
    ds_read_b128 v[20:23], v6 offset:35840
    v_mfma_f32_16x16x32_bf16 v[24:27], a[64:67], v[8:11], v[24:27]
    s_waitcnt lgkmcnt(2)
    v_mfma_f32_16x16x32_bf16 v[28:31], a[64:67], v[12:15], v[28:31]
    v_mfma_f32_16x16x32_bf16 v[32:35], a[136:139], v[8:11], v[32:35]
    v_mfma_f32_16x16x32_bf16 v[36:39], a[136:139], v[12:15], v[36:39]
    v_mfma_f32_16x16x32_bf16 v[40:43], v[8:11], a[208:211], v[40:43]
    v_mfma_f32_16x16x32_bf16 v[44:47], v[12:15], a[208:211], v[44:47]
    v_mfma_f32_16x16x32_bf16 v[48:51], v[8:11], v[104:107], v[48:51]
    v_mfma_f32_16x16x32_bf16 v[52:55], v[12:15], v[104:107], v[52:55]
    s_waitcnt lgkmcnt(1)
    v_mfma_f32_16x16x32_bf16 v[24:27], a[68:71], v[16:19], v[24:27]
    s_waitcnt lgkmcnt(0)
    v_mfma_f32_16x16x32_bf16 v[28:31], a[68:71], v[20:23], v[28:31]
    v_mfma_f32_16x16x32_bf16 v[32:35], a[140:143], v[16:19], v[32:35]
    v_mfma_f32_16x16x32_bf16 v[36:39], a[140:143], v[20:23], v[36:39]
    v_mfma_f32_16x16x32_bf16 v[40:43], v[16:19], a[212:215], v[40:43]
    v_mfma_f32_16x16x32_bf16 v[44:47], v[20:23], a[212:215], v[44:47]
    v_mfma_f32_16x16x32_bf16 v[48:51], v[16:19], v[108:111], v[48:51]
    v_mfma_f32_16x16x32_bf16 v[52:55], v[20:23], v[108:111], v[52:55]
    s_lshl_b32 s32, s3, 6
    s_add_u32 s32, s32, s37
    s_lshl_b32 s32, s32, 14
    s_lshl_b32 s33, s4, 10
    s_add_u32 s43, s32, s33
    s_add_u32 s34, s43, 4096
    s_add_u32 s33, s43, s33
    s_add_u32 s33, s33, 8192
    v_mul_f32 v24, s42, v24
    v_mul_f32 v25, s42, v25
    v_mul_f32 v26, s42, v26
    v_mul_f32 v27, s42, v27
    v_cvt_pk_bf16_f32 v56, v24, v25
    v_cvt_pk_bf16_f32 v57, v26, v27
    v_mul_f32 v32, s42, v32
    v_mul_f32 v33, s42, v33
    v_mul_f32 v34, s42, v34
    v_mul_f32 v35, s42, v35
    v_cvt_pk_bf16_f32 v58, v32, v33
    v_cvt_pk_bf16_f32 v59, v34, v35
    buffer_store_dwordx4 v[56:59], v1, s[24:27], s43 offen sc1
    v_mul_f32 v28, s42, v28
    v_mul_f32 v29, s42, v29
    v_mul_f32 v30, s42, v30
    v_mul_f32 v31, s42, v31
    v_cvt_pk_bf16_f32 v60, v28, v29
    v_cvt_pk_bf16_f32 v61, v30, v31
    v_mul_f32 v36, s42, v36
    v_mul_f32 v37, s42, v37
    v_mul_f32 v38, s42, v38
    v_mul_f32 v39, s42, v39
    v_cvt_pk_bf16_f32 v62, v36, v37
    v_cvt_pk_bf16_f32 v63, v38, v39
    buffer_store_dwordx4 v[60:63], v1, s[24:27], s34 offen sc1
    v_cvt_pk_bf16_f32 v64, v40, v41
    v_cvt_pk_bf16_f32 v65, v42, v43
    v_cvt_pk_bf16_f32 v66, v44, v45
    v_cvt_pk_bf16_f32 v67, v46, v47
    buffer_store_dwordx4 v[64:67], v1, s[24:27], s33 offen offset:0 sc1
    v_cvt_pk_bf16_f32 v68, v48, v49
    v_cvt_pk_bf16_f32 v69, v50, v51
    v_cvt_pk_bf16_f32 v70, v52, v53
    v_cvt_pk_bf16_f32 v71, v54, v55
    buffer_store_dwordx4 v[68:71], v1, s[24:27], s33 offen offset:1024 sc1
    s_lshr_b32 s32, s43, 1
    s_add_u32 s32, s32, 33554432
    s_add_u32 s33, s32, 4096
    buffer_store_dwordx2 v[72:73], v78, s[24:27], s32 offen sc1
    buffer_store_dwordx2 v[72:73], v78, s[24:27], s33 offen sc1
    s_mov_b32 s47, s37
    s_add_u32 s37, s37, 3
    s_add_u32 s39, s39, 36864
    s_cmp_eq_u32 s39, 110592
    s_cselect_b32 s39, 0, s39
    s_cmp_lt_u32 s37, 64
    s_cbranch_scc1 B_kv
    s_waitcnt vmcnt(0)
    s_lshl_b32 s33, s47, 2
    s_add_u32 s33, s33, s48
    s_mov_b64 exec, 1
    buffer_store_byte v7, v1, s[24:27], s33 offen sc1
    s_mov_b64 exec, -1
    s_barrier
    s_mov_b32 s37, s5
    s_mov_b32 s39, 0
    s_add_u32 s45, s5, 3
    s_mov_b32 s46, 36864
    s_min_u32 s33, s37, 63
    s_mul_i32 s33, s33, 36864
    s_add_u32 s33, s33, s40
    s_add_u32 s34, s39, s41
    s_add_u32 m0, s34, 0
    s_add_u32 s32, s33, 0
    buffer_load_dwordx4 v5, s[20:23], s32 offen lds
    s_add_u32 m0, s34, 1024
    s_add_u32 s32, s33, 64
    buffer_load_dwordx4 v5, s[20:23], s32 offen lds
    s_add_u32 m0, s34, 2048
    s_add_u32 s32, s33, 128
    buffer_load_dwordx4 v5, s[20:23], s32 offen lds
    s_add_u32 m0, s34, 3072
    s_add_u32 s32, s33, 192
    buffer_load_dwordx4 v5, s[20:23], s32 offen lds
    s_add_u32 m0, s34, 4096
    s_add_u32 s32, s33, 256
    buffer_load_dwordx4 v5, s[20:23], s32 offen lds
    s_add_u32 m0, s34, 5120
    s_add_u32 s32, s33, 320
    buffer_load_dwordx4 v5, s[20:23], s32 offen lds
    s_add_u32 m0, s34, 6144
    s_add_u32 s32, s33, 384
    buffer_load_dwordx4 v5, s[20:23], s32 offen lds
    s_add_u32 m0, s34, 7168
    s_add_u32 s32, s33, 448
    buffer_load_dwordx4 v5, s[20:23], s32 offen lds
    s_add_u32 m0, s34, 8192
    s_add_u32 s32, s33, 512
    buffer_load_dwordx4 v5, s[20:23], s32 offen lds
    s_add_u32 m0, s35, 0
    s_add_u32 s32, s36, 0
    buffer_load_dwordx4 v4, s[8:11], s32 offen lds
    s_add_u32 m0, s35, 1024
    s_add_u32 s32, s36, 131072
    buffer_load_dwordx4 v4, s[8:11], s32 offen lds
    s_add_u32 m0, s35, 2048
    s_add_u32 s32, s36, 262144
    buffer_load_dwordx4 v4, s[8:11], s32 offen lds
    s_add_u32 m0, s35, 3072
    s_add_u32 s32, s36, 393216
    buffer_load_dwordx4 v4, s[8:11], s32 offen lds
    s_add_u32 m0, s35, 4096
    s_add_u32 s32, s36, 524288
    buffer_load_dwordx4 v4, s[8:11], s32 offen lds
    s_add_u32 m0, s35, 5120
    s_add_u32 s32, s36, 655360
    buffer_load_dwordx4 v4, s[8:11], s32 offen lds
    s_add_u32 m0, s35, 6144
    s_add_u32 s32, s36, 786432
    buffer_load_dwordx4 v4, s[8:11], s32 offen lds
    s_add_u32 m0, s35, 7168
    s_add_u32 s32, s36, 917504
    buffer_load_dwordx4 v4, s[8:11], s32 offen lds
    s_add_u32 m0, s35, 8192
    s_add_u32 s32, s36, 1048576
    buffer_load_dwordx4 v4, s[8:11], s32 offen lds
    s_add_u32 m0, s35, 9216
    s_add_u32 s32, s36, 1179648
    buffer_load_dwordx4 v4, s[8:11], s32 offen lds
    s_add_u32 m0, s35, 10240
    s_add_u32 s32, s36, 1310720
    buffer_load_dwordx4 v4, s[8:11], s32 offen lds
    s_add_u32 m0, s35, 11264
    s_add_u32 s32, s36, 1441792
    buffer_load_dwordx4 v4, s[8:11], s32 offen lds
    s_add_u32 m0, s35, 12288
    s_add_u32 s32, s36, 1572864
    buffer_load_dwordx4 v4, s[8:11], s32 offen lds
    s_add_u32 m0, s35, 13312
    s_add_u32 s32, s36, 1703936
    buffer_load_dwordx4 v4, s[8:11], s32 offen lds
    s_add_u32 m0, s35, 14336
    s_add_u32 s32, s36, 1835008
    buffer_load_dwordx4 v4, s[8:11], s32 offen lds
    s_add_u32 m0, s35, 15360
    s_add_u32 s32, s36, 1966080
    buffer_load_dwordx4 v4, s[8:11], s32 offen lds
    s_add_u32 m0, s35, 16384
    s_add_u32 s32, s36, 2097152
    buffer_load_dwordx4 v4, s[8:11], s32 offen lds
    s_add_u32 m0, s35, 17408
    s_add_u32 s32, s36, 2228224
    buffer_load_dwordx4 v4, s[8:11], s32 offen lds
    s_add_u32 m0, s35, 18432
    s_add_u32 s32, s36, 2359296
    buffer_load_dwordx4 v4, s[8:11], s32 offen lds
    s_add_u32 m0, s35, 19456
    s_add_u32 s32, s36, 2490368
    buffer_load_dwordx4 v4, s[8:11], s32 offen lds
    s_add_u32 m0, s35, 20480
    s_add_u32 s32, s36, 2621440
    buffer_load_dwordx4 v4, s[8:11], s32 offen lds
    s_add_u32 m0, s35, 21504
    s_add_u32 s32, s36, 2752512
    buffer_load_dwordx4 v4, s[8:11], s32 offen lds
    s_add_u32 m0, s35, 22528
    s_add_u32 s32, s36, 2883584
    buffer_load_dwordx4 v4, s[8:11], s32 offen lds
    s_add_u32 m0, s35, 23552
    s_add_u32 s32, s36, 3014656
    buffer_load_dwordx4 v4, s[8:11], s32 offen lds
    s_waitcnt vmcnt(16)
    ds_read_b64_tr_b16 v[112:113], v2 offset:0
    ds_read_b64_tr_b16 v[114:115], v2 offset:512
    ds_read_b64_tr_b16 v[184:185], v3 offset:0
    ds_read_b64_tr_b16 v[186:187], v3 offset:512
    ds_read_b64_tr_b16 v[116:117], v2 offset:2048
    ds_read_b64_tr_b16 v[118:119], v2 offset:2560
    ds_read_b64_tr_b16 v[188:189], v3 offset:2048
    ds_read_b64_tr_b16 v[190:191], v3 offset:2560
    ds_read_b64_tr_b16 v[120:121], v2 offset:4096
    ds_read_b64_tr_b16 v[122:123], v2 offset:4608
    ds_read_b64_tr_b16 v[192:193], v3 offset:4096
    ds_read_b64_tr_b16 v[194:195], v3 offset:4608
    ds_read_b64_tr_b16 v[124:125], v2 offset:6144
    ds_read_b64_tr_b16 v[126:127], v2 offset:6656
    ds_read_b64_tr_b16 v[196:197], v3 offset:6144
    ds_read_b64_tr_b16 v[198:199], v3 offset:6656
    s_waitcnt lgkmcnt(0)
    s_add_u32 m0, s35, 0
    s_add_u32 s32, s36, 3145728
    buffer_load_dwordx4 v4, s[8:11], s32 offen lds
    s_add_u32 m0, s35, 1024
    s_add_u32 s32, s36, 3276800
    buffer_load_dwordx4 v4, s[8:11], s32 offen lds
    s_add_u32 m0, s35, 2048
    s_add_u32 s32, s36, 3407872
    buffer_load_dwordx4 v4, s[8:11], s32 offen lds
    s_add_u32 m0, s35, 3072
    s_add_u32 s32, s36, 3538944
    buffer_load_dwordx4 v4, s[8:11], s32 offen lds
    s_add_u32 m0, s35, 4096
    s_add_u32 s32, s36, 3670016
    buffer_load_dwordx4 v4, s[8:11], s32 offen lds
    s_add_u32 m0, s35, 5120
    s_add_u32 s32, s36, 3801088
    buffer_load_dwordx4 v4, s[8:11], s32 offen lds
    s_add_u32 m0, s35, 6144
    s_add_u32 s32, s36, 3932160
    buffer_load_dwordx4 v4, s[8:11], s32 offen lds
    s_add_u32 m0, s35, 7168
    s_add_u32 s32, s36, 4063232
    buffer_load_dwordx4 v4, s[8:11], s32 offen lds
    s_waitcnt vmcnt(16)
    ds_read_b64_tr_b16 v[128:129], v2 offset:8192
    ds_read_b64_tr_b16 v[130:131], v2 offset:8704
    ds_read_b64_tr_b16 v[200:201], v3 offset:8192
    ds_read_b64_tr_b16 v[202:203], v3 offset:8704
    ds_read_b64_tr_b16 v[132:133], v2 offset:10240
    ds_read_b64_tr_b16 v[134:135], v2 offset:10752
    ds_read_b64_tr_b16 v[204:205], v3 offset:10240
    ds_read_b64_tr_b16 v[206:207], v3 offset:10752
    ds_read_b64_tr_b16 v[136:137], v2 offset:12288
    ds_read_b64_tr_b16 v[138:139], v2 offset:12800
    ds_read_b64_tr_b16 v[208:209], v3 offset:12288
    ds_read_b64_tr_b16 v[210:211], v3 offset:12800
    ds_read_b64_tr_b16 v[140:141], v2 offset:14336
    ds_read_b64_tr_b16 v[142:143], v2 offset:14848
    ds_read_b64_tr_b16 v[212:213], v3 offset:14336
    ds_read_b64_tr_b16 v[214:215], v3 offset:14848
    s_waitcnt lgkmcnt(0)
    s_add_u32 m0, s35, 8192
    s_add_u32 s32, s36, 4194304
    buffer_load_dwordx4 v4, s[8:11], s32 offen lds
    s_add_u32 m0, s35, 9216
    s_add_u32 s32, s36, 4325376
    buffer_load_dwordx4 v4, s[8:11], s32 offen lds
    s_add_u32 m0, s35, 10240
    s_add_u32 s32, s36, 4456448
    buffer_load_dwordx4 v4, s[8:11], s32 offen lds
    s_add_u32 m0, s35, 11264
    s_add_u32 s32, s36, 4587520
    buffer_load_dwordx4 v4, s[8:11], s32 offen lds
    s_waitcnt vmcnt(12)
    ds_read_b64_tr_b16 v[144:145], v2 offset:16384
    ds_read_b64_tr_b16 v[146:147], v2 offset:16896
    ds_read_b64_tr_b16 v[216:217], v3 offset:16384
    ds_read_b64_tr_b16 v[218:219], v3 offset:16896
    ds_read_b64_tr_b16 v[148:149], v2 offset:18432
    ds_read_b64_tr_b16 v[150:151], v2 offset:18944
    ds_read_b64_tr_b16 v[220:221], v3 offset:18432
    ds_read_b64_tr_b16 v[222:223], v3 offset:18944
    ds_read_b64_tr_b16 v[152:153], v2 offset:20480
    ds_read_b64_tr_b16 v[154:155], v2 offset:20992
    ds_read_b64_tr_b16 v[224:225], v3 offset:20480
    ds_read_b64_tr_b16 v[226:227], v3 offset:20992
    ds_read_b64_tr_b16 v[156:157], v2 offset:22528
    ds_read_b64_tr_b16 v[158:159], v2 offset:23040
    ds_read_b64_tr_b16 v[228:229], v3 offset:22528
    ds_read_b64_tr_b16 v[230:231], v3 offset:23040
    s_waitcnt lgkmcnt(0)
    s_waitcnt vmcnt(4)
    ds_read_b64_tr_b16 v[160:161], v2 offset:0
    ds_read_b64_tr_b16 v[162:163], v2 offset:512
    ds_read_b64_tr_b16 v[232:233], v3 offset:0
    ds_read_b64_tr_b16 v[234:235], v3 offset:512
    ds_read_b64_tr_b16 v[164:165], v2 offset:2048
    ds_read_b64_tr_b16 v[166:167], v2 offset:2560
    ds_read_b64_tr_b16 v[236:237], v3 offset:2048
    ds_read_b64_tr_b16 v[238:239], v3 offset:2560
    ds_read_b64_tr_b16 v[168:169], v2 offset:4096
    ds_read_b64_tr_b16 v[170:171], v2 offset:4608
    ds_read_b64_tr_b16 v[240:241], v3 offset:4096
    ds_read_b64_tr_b16 v[242:243], v3 offset:4608
    ds_read_b64_tr_b16 v[172:173], v2 offset:6144
    ds_read_b64_tr_b16 v[174:175], v2 offset:6656
    ds_read_b64_tr_b16 v[244:245], v3 offset:6144
    ds_read_b64_tr_b16 v[246:247], v3 offset:6656
    s_waitcnt lgkmcnt(0)
    s_waitcnt vmcnt(0)
    ds_read_b64_tr_b16 v[176:177], v2 offset:8192
    ds_read_b64_tr_b16 v[178:179], v2 offset:8704
    ds_read_b64_tr_b16 v[248:249], v3 offset:8192
    ds_read_b64_tr_b16 v[250:251], v3 offset:8704
    ds_read_b64_tr_b16 v[180:181], v2 offset:10240
    ds_read_b64_tr_b16 v[182:183], v2 offset:10752
    ds_read_b64_tr_b16 v[252:253], v3 offset:10240
    ds_read_b64_tr_b16 v[254:255], v3 offset:10752
    s_waitcnt lgkmcnt(0)
    s_barrier
    s_min_u32 s33, s45, 63
    s_mul_i32 s33, s33, 36864
    s_add_u32 s33, s33, s40
    s_add_u32 s34, s46, s41
    s_add_u32 m0, s34, 0
    s_add_u32 s32, s33, 0
    buffer_load_dwordx4 v5, s[20:23], s32 offen lds
    s_add_u32 m0, s34, 1024
    s_add_u32 s32, s33, 64
    buffer_load_dwordx4 v5, s[20:23], s32 offen lds
    s_add_u32 m0, s34, 2048
    s_add_u32 s32, s33, 128
    buffer_load_dwordx4 v5, s[20:23], s32 offen lds
    s_add_u32 m0, s34, 3072
    s_add_u32 s32, s33, 192
    buffer_load_dwordx4 v5, s[20:23], s32 offen lds
    s_add_u32 m0, s34, 4096
    s_add_u32 s32, s33, 256
    buffer_load_dwordx4 v5, s[20:23], s32 offen lds
    s_add_u32 m0, s34, 5120
    s_add_u32 s32, s33, 320
    buffer_load_dwordx4 v5, s[20:23], s32 offen lds
    s_add_u32 m0, s34, 6144
    s_add_u32 s32, s33, 384
    buffer_load_dwordx4 v5, s[20:23], s32 offen lds
    s_add_u32 m0, s34, 7168
    s_add_u32 s32, s33, 448
    buffer_load_dwordx4 v5, s[20:23], s32 offen lds
    s_add_u32 m0, s34, 8192
    s_add_u32 s32, s33, 512
    buffer_load_dwordx4 v5, s[20:23], s32 offen lds
    s_and_b32 s50, s4, 1
    s_lshr_b32 s51, s4, 1
    v_and_b32 v10, 15, v0
    v_lshrrev_b32 v11, 4, v0
    v_lshlrev_b32 v11, 2, v11
    s_lshl_b32 s32, s50, 4
    v_add_u32 v10, s32, v10
    v_mov_b32 v12, 0xf149f2ca
    v_add_u32 v13, 0, v11
    v_cmp_le_u32 vcc, v13, v10
    s_nop 1
    v_cndmask_b32 v80, v12, 0, vcc
    v_add_u32 v13, 1, v11
    v_cmp_le_u32 vcc, v13, v10
    s_nop 1
    v_cndmask_b32 v81, v12, 0, vcc
    v_add_u32 v13, 2, v11
    v_cmp_le_u32 vcc, v13, v10
    s_nop 1
    v_cndmask_b32 v82, v12, 0, vcc
    v_add_u32 v13, 3, v11
    v_cmp_le_u32 vcc, v13, v10
    s_nop 1
    v_cndmask_b32 v83, v12, 0, vcc
    v_add_u32 v13, 16, v11
    v_cmp_le_u32 vcc, v13, v10
    s_nop 1
    v_cndmask_b32 v84, v12, 0, vcc
    v_add_u32 v13, 17, v11
    v_cmp_le_u32 vcc, v13, v10
    s_nop 1
    v_cndmask_b32 v85, v12, 0, vcc
    v_add_u32 v13, 18, v11
    v_cmp_le_u32 vcc, v13, v10
    s_nop 1
    v_cndmask_b32 v86, v12, 0, vcc
    v_add_u32 v13, 19, v11
    v_cmp_le_u32 vcc, v13, v10
    s_nop 1
    v_cndmask_b32 v87, v12, 0, vcc
    v_mov_b32 v88, 0x3f803f80
    v_mov_b32 v89, 0x3f803f80
    v_mov_b32 v90, 0x3f803f80
    v_mov_b32 v91, 0x3f803f80
    v_lshrrev_b32 v92, 1, v1
    s_lshl_b32 s32, s4, 10
    s_add_u32 s32, s32, 110592
    v_add_u32 v93, s32, v1
    s_lshl_b32 s32, s50, 12
    s_add_u32 s32, s32, 110592
    v_add_u32 v94, s32, v1
    s_lshl_b32 s32, s4, 12
    s_add_u32 s32, s32, 118784
    v_add_u32 v96, s32, v92
    v_and_b32 v10, 15, v0
    v_lshlrev_b32 v10, 5, v10
    v_lshrrev_b32 v11, 4, v0
    v_lshl_add_u32 v10, v11, 3, v10
    v_add_u32 v95, s32, v10
    s_waitcnt vmcnt(9)
B_at:
    s_barrier
    s_lshl_b32 s32, s3, 6
    s_add_u32 s32, s32, s37
    s_lshl_b32 s52, s32, 14
    s_add_u32 s33, s52, 4096
    s_lshl_b32 s34, s51, 12
    s_add_u32 s53, s52, s34
    s_add_u32 s53, s53, 8192
    s_lshl_b32 s54, s32, 13
    s_add_u32 s54, s54, 33554432
    s_lshl_b32 s34, s51, 10
    s_add_u32 s55, s54, s34
    s_add_u32 s55, s55, 4096
    buffer_load_dwordx4 a[0:3], v1, s[24:27], s52 offen offset:0 sc1
    buffer_load_dwordx4 a[4:7], v1, s[24:27], s52 offen offset:1024 sc1
    buffer_load_dwordx4 a[8:11], v1, s[24:27], s52 offen offset:2048 sc1
    buffer_load_dwordx4 a[12:15], v1, s[24:27], s52 offen offset:3072 sc1
    buffer_load_dwordx4 a[16:19], v1, s[24:27], s33 offen offset:0 sc1
    buffer_load_dwordx4 a[20:23], v1, s[24:27], s33 offen offset:1024 sc1
    buffer_load_dwordx4 a[24:27], v1, s[24:27], s33 offen offset:2048 sc1
    buffer_load_dwordx4 a[28:31], v1, s[24:27], s33 offen offset:3072 sc1
    buffer_load_dwordx4 a[32:35], v1, s[24:27], s53 offen offset:0 sc1
    buffer_load_dwordx4 a[36:39], v1, s[24:27], s53 offen offset:1024 sc1
    buffer_load_dwordx4 a[40:43], v1, s[24:27], s53 offen offset:2048 sc1
    buffer_load_dwordx4 a[44:47], v1, s[24:27], s53 offen offset:3072 sc1
    s_add_u32 s45, s45, 3
    s_add_u32 s46, s46, 36864
    s_cmp_eq_u32 s46, 110592
    s_cselect_b32 s46, 0, s46
    s_min_u32 s33, s45, 63
    s_mul_i32 s33, s33, 36864
    s_add_u32 s33, s33, s40
    s_add_u32 s34, s46, s41
    s_add_u32 m0, s34, 0
    s_add_u32 s32, s33, 0
    buffer_load_dwordx4 v5, s[20:23], s32 offen lds
    s_add_u32 m0, s34, 1024
    s_add_u32 s32, s33, 64
    buffer_load_dwordx4 v5, s[20:23], s32 offen lds
    s_add_u32 m0, s34, 2048
    s_add_u32 s32, s33, 128
    buffer_load_dwordx4 v5, s[20:23], s32 offen lds
    s_add_u32 m0, s34, 3072
    s_add_u32 s32, s33, 192
    buffer_load_dwordx4 v5, s[20:23], s32 offen lds
    s_add_u32 m0, s34, 4096
    s_add_u32 s32, s33, 256
    buffer_load_dwordx4 v5, s[20:23], s32 offen lds
    s_add_u32 m0, s34, 5120
    s_add_u32 s32, s33, 320
    buffer_load_dwordx4 v5, s[20:23], s32 offen lds
    s_add_u32 m0, s34, 6144
    s_add_u32 s32, s33, 384
    buffer_load_dwordx4 v5, s[20:23], s32 offen lds
    s_add_u32 m0, s34, 7168
    s_add_u32 s32, s33, 448
    buffer_load_dwordx4 v5, s[20:23], s32 offen lds
    s_add_u32 m0, s34, 8192
    s_add_u32 s32, s33, 512
    buffer_load_dwordx4 v5, s[20:23], s32 offen lds
    v_add_u32 v6, s39, v1
    ds_read_b128 v[8:11], v6 offset:0
    ds_read_b128 v[12:15], v6 offset:18432
    ds_read_b128 v[16:19], v6 offset:1024
    ds_read_b128 v[20:23], v6 offset:19456
    s_waitcnt lgkmcnt(3)
    v_mfma_f32_16x16x32_bf16 v[24:27], v[112:115], v[8:11], 0
    s_waitcnt lgkmcnt(2)
    v_mfma_f32_16x16x32_bf16 v[28:31], v[112:115], v[12:15], 0
    v_mfma_f32_16x16x32_bf16 v[32:35], v[184:187], v[8:11], 0
    v_mfma_f32_16x16x32_bf16 v[36:39], v[184:187], v[12:15], 0
    s_waitcnt lgkmcnt(1)
    ds_read_b128 v[8:11], v6 offset:2048
    ds_read_b128 v[12:15], v6 offset:20480
    v_mfma_f32_16x16x32_bf16 v[24:27], v[116:119], v[16:19], v[24:27]
    s_waitcnt lgkmcnt(2)
    v_mfma_f32_16x16x32_bf16 v[28:31], v[116:119], v[20:23], v[28:31]
    v_mfma_f32_16x16x32_bf16 v[32:35], v[188:191], v[16:19], v[32:35]
    v_mfma_f32_16x16x32_bf16 v[36:39], v[188:191], v[20:23], v[36:39]
    s_waitcnt lgkmcnt(1)
    ds_read_b128 v[16:19], v6 offset:3072
    ds_read_b128 v[20:23], v6 offset:21504
    v_mfma_f32_16x16x32_bf16 v[24:27], v[120:123], v[8:11], v[24:27]
    s_waitcnt lgkmcnt(2)
    v_mfma_f32_16x16x32_bf16 v[28:31], v[120:123], v[12:15], v[28:31]
    v_mfma_f32_16x16x32_bf16 v[32:35], v[192:195], v[8:11], v[32:35]
    v_mfma_f32_16x16x32_bf16 v[36:39], v[192:195], v[12:15], v[36:39]
    s_waitcnt lgkmcnt(1)
    ds_read_b128 v[8:11], v6 offset:4096
    ds_read_b128 v[12:15], v6 offset:22528
    v_mfma_f32_16x16x32_bf16 v[24:27], v[124:127], v[16:19], v[24:27]
    s_waitcnt lgkmcnt(2)
    v_mfma_f32_16x16x32_bf16 v[28:31], v[124:127], v[20:23], v[28:31]
    v_mfma_f32_16x16x32_bf16 v[32:35], v[196:199], v[16:19], v[32:35]
    v_mfma_f32_16x16x32_bf16 v[36:39], v[196:199], v[20:23], v[36:39]
    s_waitcnt lgkmcnt(1)
    ds_read_b128 v[16:19], v6 offset:5120
    ds_read_b128 v[20:23], v6 offset:23552
    v_mfma_f32_16x16x32_bf16 v[24:27], v[128:131], v[8:11], v[24:27]
    s_waitcnt lgkmcnt(2)
    v_mfma_f32_16x16x32_bf16 v[28:31], v[128:131], v[12:15], v[28:31]
    v_mfma_f32_16x16x32_bf16 v[32:35], v[200:203], v[8:11], v[32:35]
    v_mfma_f32_16x16x32_bf16 v[36:39], v[200:203], v[12:15], v[36:39]
    s_waitcnt lgkmcnt(1)
    ds_read_b128 v[8:11], v6 offset:6144
    ds_read_b128 v[12:15], v6 offset:24576
    v_mfma_f32_16x16x32_bf16 v[24:27], v[132:135], v[16:19], v[24:27]
    s_waitcnt lgkmcnt(2)
    v_mfma_f32_16x16x32_bf16 v[28:31], v[132:135], v[20:23], v[28:31]
    v_mfma_f32_16x16x32_bf16 v[32:35], v[204:207], v[16:19], v[32:35]
    v_mfma_f32_16x16x32_bf16 v[36:39], v[204:207], v[20:23], v[36:39]
    s_waitcnt lgkmcnt(1)
    ds_read_b128 v[16:19], v6 offset:7168
    ds_read_b128 v[20:23], v6 offset:25600
    v_mfma_f32_16x16x32_bf16 v[24:27], v[136:139], v[8:11], v[24:27]
    s_waitcnt lgkmcnt(2)
    v_mfma_f32_16x16x32_bf16 v[28:31], v[136:139], v[12:15], v[28:31]
    v_mfma_f32_16x16x32_bf16 v[32:35], v[208:211], v[8:11], v[32:35]
    v_mfma_f32_16x16x32_bf16 v[36:39], v[208:211], v[12:15], v[36:39]
    s_waitcnt lgkmcnt(1)
    ds_read_b128 v[8:11], v6 offset:8192
    ds_read_b128 v[12:15], v6 offset:26624
    v_mfma_f32_16x16x32_bf16 v[24:27], v[140:143], v[16:19], v[24:27]
    s_waitcnt lgkmcnt(2)
    v_mfma_f32_16x16x32_bf16 v[28:31], v[140:143], v[20:23], v[28:31]
    v_mfma_f32_16x16x32_bf16 v[32:35], v[212:215], v[16:19], v[32:35]
    v_mfma_f32_16x16x32_bf16 v[36:39], v[212:215], v[20:23], v[36:39]
    s_waitcnt lgkmcnt(1)
    ds_read_b128 v[16:19], v6 offset:9216
    ds_read_b128 v[20:23], v6 offset:27648
    v_mfma_f32_16x16x32_bf16 v[24:27], v[144:147], v[8:11], v[24:27]
    s_waitcnt lgkmcnt(2)
    v_mfma_f32_16x16x32_bf16 v[28:31], v[144:147], v[12:15], v[28:31]
    v_mfma_f32_16x16x32_bf16 v[32:35], v[216:219], v[8:11], v[32:35]
    v_mfma_f32_16x16x32_bf16 v[36:39], v[216:219], v[12:15], v[36:39]
    s_waitcnt lgkmcnt(1)
    ds_read_b128 v[8:11], v6 offset:10240
    ds_read_b128 v[12:15], v6 offset:28672
    v_mfma_f32_16x16x32_bf16 v[24:27], v[148:151], v[16:19], v[24:27]
    s_waitcnt lgkmcnt(2)
    v_mfma_f32_16x16x32_bf16 v[28:31], v[148:151], v[20:23], v[28:31]
    v_mfma_f32_16x16x32_bf16 v[32:35], v[220:223], v[16:19], v[32:35]
    v_mfma_f32_16x16x32_bf16 v[36:39], v[220:223], v[20:23], v[36:39]
    s_waitcnt lgkmcnt(1)
    ds_read_b128 v[16:19], v6 offset:11264
    ds_read_b128 v[20:23], v6 offset:29696
    v_mfma_f32_16x16x32_bf16 v[24:27], v[152:155], v[8:11], v[24:27]
    s_waitcnt lgkmcnt(2)
    v_mfma_f32_16x16x32_bf16 v[28:31], v[152:155], v[12:15], v[28:31]
    v_mfma_f32_16x16x32_bf16 v[32:35], v[224:227], v[8:11], v[32:35]
    v_mfma_f32_16x16x32_bf16 v[36:39], v[224:227], v[12:15], v[36:39]
    s_waitcnt lgkmcnt(1)
    ds_read_b128 v[8:11], v6 offset:12288
    ds_read_b128 v[12:15], v6 offset:30720
    v_mfma_f32_16x16x32_bf16 v[24:27], v[156:159], v[16:19], v[24:27]
    s_waitcnt lgkmcnt(2)
    v_mfma_f32_16x16x32_bf16 v[28:31], v[156:159], v[20:23], v[28:31]
    v_mfma_f32_16x16x32_bf16 v[32:35], v[228:231], v[16:19], v[32:35]
    v_mfma_f32_16x16x32_bf16 v[36:39], v[228:231], v[20:23], v[36:39]
    s_waitcnt lgkmcnt(1)
    ds_read_b128 v[16:19], v6 offset:13312
    ds_read_b128 v[20:23], v6 offset:31744
    v_mfma_f32_16x16x32_bf16 v[24:27], v[160:163], v[8:11], v[24:27]
    s_waitcnt lgkmcnt(2)
    v_mfma_f32_16x16x32_bf16 v[28:31], v[160:163], v[12:15], v[28:31]
    v_mfma_f32_16x16x32_bf16 v[32:35], v[232:235], v[8:11], v[32:35]
    v_mfma_f32_16x16x32_bf16 v[36:39], v[232:235], v[12:15], v[36:39]
    s_waitcnt lgkmcnt(1)
    ds_read_b128 v[8:11], v6 offset:14336
    ds_read_b128 v[12:15], v6 offset:32768
    v_mfma_f32_16x16x32_bf16 v[24:27], v[164:167], v[16:19], v[24:27]
    s_waitcnt lgkmcnt(2)
    v_mfma_f32_16x16x32_bf16 v[28:31], v[164:167], v[20:23], v[28:31]
    v_mfma_f32_16x16x32_bf16 v[32:35], v[236:239], v[16:19], v[32:35]
    v_mfma_f32_16x16x32_bf16 v[36:39], v[236:239], v[20:23], v[36:39]
    s_waitcnt lgkmcnt(1)
    ds_read_b128 v[16:19], v6 offset:15360
    ds_read_b128 v[20:23], v6 offset:33792
    v_mfma_f32_16x16x32_bf16 v[24:27], v[168:171], v[8:11], v[24:27]
    s_waitcnt lgkmcnt(2)
    v_mfma_f32_16x16x32_bf16 v[28:31], v[168:171], v[12:15], v[28:31]
    v_mfma_f32_16x16x32_bf16 v[32:35], v[240:243], v[8:11], v[32:35]
    v_mfma_f32_16x16x32_bf16 v[36:39], v[240:243], v[12:15], v[36:39]
    s_waitcnt lgkmcnt(1)
    ds_read_b128 v[8:11], v6 offset:16384
    ds_read_b128 v[12:15], v6 offset:34816
    v_mfma_f32_16x16x32_bf16 v[24:27], v[172:175], v[16:19], v[24:27]
    s_waitcnt lgkmcnt(2)
    v_mfma_f32_16x16x32_bf16 v[28:31], v[172:175], v[20:23], v[28:31]
    v_mfma_f32_16x16x32_bf16 v[32:35], v[244:247], v[16:19], v[32:35]
    v_mfma_f32_16x16x32_bf16 v[36:39], v[244:247], v[20:23], v[36:39]
    s_waitcnt lgkmcnt(1)
    ds_read_b128 v[16:19], v6 offset:17408
    ds_read_b128 v[20:23], v6 offset:35840
    v_mfma_f32_16x16x32_bf16 v[24:27], v[176:179], v[8:11], v[24:27]
    s_waitcnt lgkmcnt(2)
    v_mfma_f32_16x16x32_bf16 v[28:31], v[176:179], v[12:15], v[28:31]
    v_mfma_f32_16x16x32_bf16 v[32:35], v[248:251], v[8:11], v[32:35]
    v_mfma_f32_16x16x32_bf16 v[36:39], v[248:251], v[12:15], v[36:39]
    s_waitcnt lgkmcnt(1)
    v_mfma_f32_16x16x32_bf16 v[24:27], v[180:183], v[16:19], v[24:27]
    s_waitcnt lgkmcnt(0)
    v_mfma_f32_16x16x32_bf16 v[28:31], v[180:183], v[20:23], v[28:31]
    v_mfma_f32_16x16x32_bf16 v[32:35], v[252:255], v[16:19], v[32:35]
    v_mfma_f32_16x16x32_bf16 v[36:39], v[252:255], v[20:23], v[36:39]
    v_cvt_pk_bf16_f32 v56, v24, v25
    v_cvt_pk_bf16_f32 v57, v26, v27
    s_nop 1
    v_cvt_pk_bf16_f32 v58, v32, v33
    v_cvt_pk_bf16_f32 v59, v34, v35
    ds_write_b128 v93, v[56:59] offset:0
    v_cvt_pk_bf16_f32 v60, v28, v29
    v_cvt_pk_bf16_f32 v61, v30, v31
    v_cvt_pk_bf16_f32 v62, v36, v37
    v_cvt_pk_bf16_f32 v63, v38, v39
    ds_write_b128 v93, v[60:63] offset:4096
    s_waitcnt lgkmcnt(0)
    s_barrier
    ds_read_b128 v[8:11], v94 offset:0
    ds_read_b128 v[12:15], v94 offset:1024
    ds_read_b128 v[16:19], v94 offset:2048
    ds_read_b128 v[20:23], v94 offset:3072
    s_waitcnt lgkmcnt(3) vmcnt(20)
    v_mfma_f32_16x16x32_bf16 v[24:27], a[0:3], v[8:11], v[80:83]
    s_waitcnt vmcnt(16)
    v_mfma_f32_16x16x32_bf16 v[28:31], a[16:19], v[8:11], v[84:87]
    s_waitcnt lgkmcnt(2)
    v_mfma_f32_16x16x32_bf16 v[24:27], a[4:7], v[12:15], v[24:27]
    s_waitcnt vmcnt(15)
    v_mfma_f32_16x16x32_bf16 v[28:31], a[20:23], v[12:15], v[28:31]
    s_waitcnt lgkmcnt(1)
    v_mfma_f32_16x16x32_bf16 v[24:27], a[8:11], v[16:19], v[24:27]
    s_waitcnt vmcnt(14)
    v_mfma_f32_16x16x32_bf16 v[28:31], a[24:27], v[16:19], v[28:31]
    s_waitcnt lgkmcnt(0)
    v_mfma_f32_16x16x32_bf16 v[24:27], a[12:15], v[20:23], v[24:27]
    s_waitcnt vmcnt(13)
    v_mfma_f32_16x16x32_bf16 v[28:31], a[28:31], v[20:23], v[28:31]
    s_mov_b32 s44, 0
    s_waitcnt vmcnt(9)
B_mp:
    buffer_load_dwordx4 v[64:67], v1, s[24:27], s54 offen offset:0 sc1
    buffer_load_dwordx4 v[68:71], v1, s[24:27], s54 offen offset:1024 sc1
    s_add_u32 s44, s44, 1
    s_waitcnt vmcnt(0)
    v_max3_u32 v60, v64, v67, v68
    v_max_u32 v60, v60, v71
    v_cmp_eq_u32 vcc, 0xffbfffbf, v60
    s_cmp_gt_u32 s44, 200000
    s_cbranch_scc1 B_mg
    s_cbranch_vccz B_mg
    s_sleep 3
    s_branch B_mp
B_mg:
    buffer_load_dwordx2 v[56:57], v92, s[24:27], s55 offen sc1
    buffer_load_dwordx2 v[58:59], v92, s[24:27], s55 offen offset:512 sc1
    ds_write_b32 v95, v64 offset:0
    ds_write_b32 v95, v65 offset:512
    ds_write_b32 v95, v66 offset:1024
    ds_write_b32 v95, v67 offset:1536
    ds_write_b32 v95, v68 offset:2048
    ds_write_b32 v95, v69 offset:2560
    ds_write_b32 v95, v70 offset:3072
    ds_write_b32 v95, v71 offset:3584
    ds_read_b64_tr_b16 v[40:41], v96 offset:0
    ds_read_b64_tr_b16 v[42:43], v96 offset:512
    ds_read_b64_tr_b16 v[44:45], v96 offset:1024
    ds_read_b64_tr_b16 v[46:47], v96 offset:1536
    ds_read_b64_tr_b16 v[48:49], v96 offset:2048
    ds_read_b64_tr_b16 v[50:51], v96 offset:2560
    ds_read_b64_tr_b16 v[52:53], v96 offset:3072
    ds_read_b64_tr_b16 v[54:55], v96 offset:3584
    s_waitcnt lgkmcnt(6)
    v_mfma_f32_16x16x32_bf16 v[32:35], v[40:43], v[8:11], 0
    s_waitcnt lgkmcnt(4)
    v_mfma_f32_16x16x32_bf16 v[32:35], v[44:47], v[12:15], v[32:35]
    s_waitcnt lgkmcnt(2)
    v_mfma_f32_16x16x32_bf16 v[32:35], v[48:51], v[16:19], v[32:35]
    s_waitcnt lgkmcnt(0)
    v_mfma_f32_16x16x32_bf16 v[32:35], v[52:55], v[20:23], v[32:35]
    v_max3_f32 v60, v24, v25, v26
    v_max3_f32 v61, v27, v28, v29
    v_max3_f32 v60, v60, v30, v31
    s_nop 4
    v_mul_f32 v32, s42, v32
    v_mul_f32 v33, s42, v33
    v_max3_f32 v61, v61, v32, v33
    v_max_f32 v60, v60, v61
    v_mov_b32 v61, v60
    s_nop 1
    v_permlane32_swap_b32 v60, v61
    v_max_f32 v60, v60, v61
    v_mov_b32 v61, v60
    s_nop 1
    v_permlane16_swap_b32 v60, v61
    v_max_f32 v60, v60, v61
    v_sub_f32 v24, v24, v60
    v_sub_f32 v25, v25, v60
    v_sub_f32 v26, v26, v60
    v_sub_f32 v27, v27, v60
    v_sub_f32 v28, v28, v60
    v_sub_f32 v29, v29, v60
    v_sub_f32 v30, v30, v60
    v_sub_f32 v31, v31, v60
    v_sub_f32 v32, v32, v60
    v_sub_f32 v33, v33, v60
    v_exp_f32 v24, v24
    v_exp_f32 v25, v25
    v_exp_f32 v26, v26
    v_exp_f32 v27, v27
    v_exp_f32 v28, v28
    v_exp_f32 v29, v29
    v_exp_f32 v30, v30
    v_exp_f32 v31, v31
    v_exp_f32 v32, v32
    v_exp_f32 v33, v33
    v_cvt_pk_bf16_f32 v64, v24, v25
    v_cvt_pk_bf16_f32 v65, v26, v27
    v_cvt_pk_bf16_f32 v66, v28, v29
    v_cvt_pk_bf16_f32 v67, v30, v31
    v_cvt_pk_bf16_f32 v68, v32, v33
    v_mov_b32 v69, 0
    v_mov_b32 v70, 0
    v_cvt_pk_bf16_f32 v71, v32, v33
    v_mfma_f32_16x16x32_bf16 v[36:39], v[88:91], v[64:67], 0
    v_mfma_f32_16x16x32_bf16 v[40:43], a[32:35], v[64:67], 0
    v_mfma_f32_16x16x32_bf16 v[44:47], a[36:39], v[64:67], 0
    v_mfma_f32_16x16x32_bf16 v[48:51], a[40:43], v[64:67], 0
    v_mfma_f32_16x16x32_bf16 v[52:55], a[44:47], v[64:67], 0
    v_mfma_f32_16x16x16_bf16 v[36:39], v[88:89], v[68:69], v[36:39]
    s_waitcnt vmcnt(0)
    v_max_u32 v60, v56, v58
    v_cmp_eq_u32 vcc, 0xffbfffbf, v60
    s_nop 4
    s_cbranch_vccz B_vg
    s_mov_b32 s44, 0
B_vp:
    buffer_load_dwordx2 v[56:57], v92, s[24:27], s55 offen sc1
    buffer_load_dwordx2 v[58:59], v92, s[24:27], s55 offen offset:512 sc1
    s_add_u32 s44, s44, 1
    s_waitcnt vmcnt(0)
    v_max_u32 v60, v56, v58
    v_cmp_eq_u32 vcc, 0xffbfffbf, v60
    s_cmp_gt_u32 s44, 200000
    s_nop 3
    s_cbranch_scc1 B_vg
    s_cbranch_vccnz B_vp
B_vg:
    v_mfma_f32_16x16x16_bf16 v[40:43], v[56:57], v[68:69], v[40:43]
    v_mfma_f32_16x16x16_bf16 v[44:47], v[56:57], v[70:71], v[44:47]
    v_mfma_f32_16x16x16_bf16 v[48:51], v[58:59], v[68:69], v[48:51]
    v_mfma_f32_16x16x16_bf16 v[52:55], v[58:59], v[70:71], v[52:55]
    v_rcp_f32 v60, v36
    s_lshl_b32 s32, s37, 1
    s_add_u32 s32, s32, s50
    s_lshl_b32 s32, s32, 17
    s_lshl_b32 s33, s3, 12
    s_add_u32 s32, s32, s33
    s_lshl_b32 s33, s51, 11
    s_add_u32 s32, s32, s33
    s_add_u32 s32, s32, 58720256
    v_mul_f32 v40, v40, v60
    v_mul_f32 v41, v41, v60
    v_cvt_pk_bf16_f32 v24, v40, v41
    v_mul_f32 v42, v42, v60
    v_mul_f32 v43, v43, v60
    v_cvt_pk_bf16_f32 v25, v42, v43
    v_mul_f32 v44, v44, v60
    v_mul_f32 v45, v45, v60
    v_cvt_pk_bf16_f32 v26, v44, v45
    v_mul_f32 v46, v46, v60
    v_mul_f32 v47, v47, v60
    v_cvt_pk_bf16_f32 v27, v46, v47
    buffer_store_dwordx4 v[24:27], v1, s[24:27], s32 offen offset:0 sc1
    v_mul_f32 v48, v48, v60
    v_mul_f32 v49, v49, v60
    v_cvt_pk_bf16_f32 v28, v48, v49
    v_mul_f32 v50, v50, v60
    v_mul_f32 v51, v51, v60
    v_cvt_pk_bf16_f32 v29, v50, v51
    v_mul_f32 v52, v52, v60
    v_mul_f32 v53, v53, v60
    v_cvt_pk_bf16_f32 v30, v52, v53
    v_mul_f32 v54, v54, v60
    v_mul_f32 v55, v55, v60
    v_cvt_pk_bf16_f32 v31, v54, v55
    buffer_store_dwordx4 v[28:31], v1, s[24:27], s32 offen offset:1024 sc1
    s_waitcnt vmcnt(0)
    s_lshr_b32 s33, s37, 1
    s_lshl_b32 s33, s33, 12
    s_and_b32 s34, s37, 1
    s_lshl_b32 s34, s34, 9
    s_add_u32 s33, s33, s34
    s_add_u32 s33, s33, s49
    s_mov_b64 exec, 1
    buffer_store_dword v7, v1, s[24:27], s33 offen sc1
    s_mov_b64 exec, -1
    s_mov_b32 s47, s37
    s_add_u32 s37, s37, 3
    s_add_u32 s39, s39, 36864
    s_cmp_eq_u32 s39, 110592
    s_cselect_b32 s39, 0, s39
    s_cmp_lt_u32 s37, 64
    s_cbranch_scc1 B_at
    s_endpgm
K_exit:
    s_endpgm
K_ra:
    s_sub_u32 s6, s6, 4
    s_lshl_b32 s6, s6, 5
    s_add_u32 s3, s6, s7
    s_load_dwordx4 s[60:63], s[0:1], 0
    s_load_dwordx2 s[64:65], s[0:1], 16
    s_load_dwordx2 s[66:67], s[0:1], 64
    s_load_dwordx2 s[68:69], s[0:1], 80
    s_load_dwordx4 s[72:75], s[0:1], 88
    v_lshrrev_b32 v10, 6, v0
    v_and_b32 v0, 63, v0
    v_readfirstlane_b32 s4, v10
    s_waitcnt lgkmcnt(0)
    s_mov_b32 s8, s60
    s_and_b32 s9, s61, 0xffff
    s_mov_b32 s10, 2359296
    s_mov_b32 s11, 0x20000
    s_mov_b32 s12, s62
    s_and_b32 s13, s63, 0xffff
    s_mov_b32 s14, 1990656
    s_mov_b32 s15, 0x20000
    s_mov_b32 s16, s64
    s_and_b32 s17, s65, 0xffff
    s_mov_b32 s18, 663552
    s_mov_b32 s19, 0x20000
    s_mov_b32 s20, s66
    s_and_b32 s21, s67, 0xffff
    s_mov_b32 s22, 4718592
    s_mov_b32 s23, 0x20000
    s_mov_b32 s24, s74
    s_and_b32 s25, s75, 0xffff
    s_mov_b32 s26, 268435456
    s_mov_b32 s27, 0x20000
    s_mov_b32 s76, s68
    s_and_b32 s77, s69, 0xffff
    s_mov_b32 s78, 4718592
    s_mov_b32 s79, 0x20000
    s_mov_b32 s28, s72
    s_mov_b32 s29, s73
    v_lshlrev_b32 v1, 4, v0
    v_lshrrev_b32 v10, 5, v0
    v_lshlrev_b32 v7, 10, v10
    v_bfe_u32 v10, v0, 4, 1
    v_lshl_add_u32 v7, v10, 8, v7
    v_lshl_add_u32 v7, v10, 5, v7
    v_bfe_u32 v10, v0, 2, 2
    v_lshl_add_u32 v7, v10, 6, v7
    v_and_b32 v10, 3, v0
    v_lshl_add_u32 v7, v10, 3, v7
    s_load_dwordx4 s[80:83], s[0:1], 40
    s_load_dwordx2 s[84:85], s[0:1], 56
    s_lshl_b32 s32, s3, 2
    s_add_u32 s32, s32, s4
    s_mul_i32 s32, s32, 9216
    v_add_u32 v10, s32, v1
    v_add_u32 v11, 4096, v10
    v_add_u32 v12, 8192, v10
    s_waitcnt lgkmcnt(0)
    global_load_dwordx4 v[100:103], v10, s[80:81] offset:0
    global_load_dwordx4 v[104:107], v10, s[80:81] offset:1024
    global_load_dwordx4 v[108:111], v10, s[80:81] offset:2048
    global_load_dwordx4 v[112:115], v10, s[80:81] offset:3072
    global_load_dwordx4 v[116:119], v11, s[80:81] offset:0
    global_load_dwordx4 v[120:123], v11, s[80:81] offset:1024
    global_load_dwordx4 v[124:127], v11, s[80:81] offset:2048
    global_load_dwordx4 v[128:131], v11, s[80:81] offset:3072
    global_load_dwordx4 v[132:135], v12, s[80:81] offset:0
    global_load_dwordx4 v[136:139], v10, s[82:83] offset:0
    global_load_dwordx4 v[140:143], v10, s[82:83] offset:1024
    global_load_dwordx4 v[144:147], v10, s[82:83] offset:2048
    global_load_dwordx4 v[148:151], v10, s[82:83] offset:3072
    global_load_dwordx4 v[152:155], v11, s[82:83] offset:0
    global_load_dwordx4 v[156:159], v11, s[82:83] offset:1024
    global_load_dwordx4 v[160:163], v11, s[82:83] offset:2048
    global_load_dwordx4 v[164:167], v11, s[82:83] offset:3072
    global_load_dwordx4 v[168:171], v12, s[82:83] offset:0
    global_load_dwordx4 v[172:175], v10, s[84:85] offset:0
    global_load_dwordx4 v[176:179], v10, s[84:85] offset:1024
    global_load_dwordx4 v[180:183], v10, s[84:85] offset:2048
    global_load_dwordx4 v[184:187], v10, s[84:85] offset:3072
    global_load_dwordx4 v[188:191], v11, s[84:85] offset:0
    global_load_dwordx4 v[192:195], v11, s[84:85] offset:1024
    global_load_dwordx4 v[196:199], v11, s[84:85] offset:2048
    global_load_dwordx4 v[200:203], v11, s[84:85] offset:3072
    global_load_dwordx4 v[204:207], v12, s[84:85] offset:0
    global_load_dwordx4 v[208:211], v10, s[66:67] offset:0
    global_load_dwordx4 v[212:215], v10, s[66:67] offset:1024
    global_load_dwordx4 v[216:219], v10, s[66:67] offset:2048
    global_load_dwordx4 v[220:223], v10, s[66:67] offset:3072
    global_load_dwordx4 v[224:227], v11, s[66:67] offset:0
    global_load_dwordx4 v[228:231], v11, s[66:67] offset:1024
    global_load_dwordx4 v[232:235], v11, s[66:67] offset:2048
    global_load_dwordx4 v[236:239], v11, s[66:67] offset:3072
    global_load_dwordx4 v[240:243], v12, s[66:67] offset:0
    v_and_b32 v10, 15, v0
    v_mul_u32_u24 v10, 1152, v10
    v_lshrrev_b32 v5, 4, v0
    v_lshl_add_u32 v5, v5, 4, v10
    s_lshr_b32 s32, s4, 1
    s_mul_i32 s40, s32, 18432
    s_and_b32 s32, s4, 1
    s_mul_i32 s32, s32, 576
    s_add_u32 s40, s40, s32
    s_mul_i32 s41, s4, 9216
    s_cmp_ge_u32 s3, 126
    s_cbranch_scc1 A1_skip
    s_mul_i32 s33, s3, 7282
    s_lshr_b32 s33, s33, 16
    s_mul_i32 s32, s33, 9
    s_sub_u32 s47, s3, s32
    s_lshl_b32 s38, s33, 2
    s_add_u32 s38, s38, s4
    s_min_u32 s38, s38, 53
    s_cmp_lt_u32 s38, 18
    s_cselect_b32 s42, 0x3eae1a93, 1.0
    s_cmp_ge_u32 s33, 9
    s_cbranch_scc1 A1_v
    v_and_b32 v10, 15, v0
    v_mul_u32_u24 v10, 2304, v10
    v_lshrrev_b32 v11, 4, v0
    v_lshl_add_u32 v56, v11, 3, v10
    v_bfe_u32 v10, v0, 2, 2
    v_bfe_u32 v11, v0, 4, 1
    v_lshl_add_u32 v10, v11, 3, v10
    v_lshrrev_b32 v11, 5, v0
    v_lshl_add_u32 v10, v11, 2, v10
    v_mul_u32_u24 v10, 3456, v10
    v_bfe_u32 v11, v0, 4, 1
    v_lshlrev_b32 v11, 1, v11
    v_xor_b32 v11, v11, v0
    v_and_b32 v11, 3, v11
    v_lshl_add_u32 v4, v11, 4, v10
    s_mul_i32 s35, s4, 24576
    v_add_u32 v2, s35, v7
    v_xor_b32 v3, 32, v2
    s_lshl_b32 s36, s38, 6
    s_mov_b32 s37, s47
    s_mov_b32 s39, 110592
    s_add_u32 s45, s47, 9
    s_mov_b32 s46, 0
    s_min_u32 s33, s37, 63
    s_mul_i32 s33, s33, 36864
    s_add_u32 s33, s33, s40
    s_add_u32 s33, s33, 0
    s_add_u32 s34, s39, s41
    s_add_u32 m0, s34, 0
    s_add_u32 s32, s33, 0
    buffer_load_dwordx4 v5, s[8:11], s32 offen lds
    s_add_u32 m0, s34, 1024
    s_add_u32 s32, s33, 64
    buffer_load_dwordx4 v5, s[8:11], s32 offen lds
    s_add_u32 m0, s34, 2048
    s_add_u32 s32, s33, 128
    buffer_load_dwordx4 v5, s[8:11], s32 offen lds
    s_add_u32 m0, s34, 3072
    s_add_u32 s32, s33, 192
    buffer_load_dwordx4 v5, s[8:11], s32 offen lds
    s_add_u32 m0, s34, 4096
    s_add_u32 s32, s33, 256
    buffer_load_dwordx4 v5, s[8:11], s32 offen lds
    s_add_u32 m0, s34, 5120
    s_add_u32 s32, s33, 320
    buffer_load_dwordx4 v5, s[8:11], s32 offen lds
    s_add_u32 m0, s34, 6144
    s_add_u32 s32, s33, 384
    buffer_load_dwordx4 v5, s[8:11], s32 offen lds
    s_add_u32 m0, s34, 7168
    s_add_u32 s32, s33, 448
    buffer_load_dwordx4 v5, s[8:11], s32 offen lds
    s_add_u32 m0, s34, 8192
    s_add_u32 s32, s33, 512
    buffer_load_dwordx4 v5, s[8:11], s32 offen lds
    s_add_u32 m0, s35, 0
    s_add_u32 s32, s36, 0
    buffer_load_dwordx4 v4, s[12:15], s32 offen lds
    s_add_u32 m0, s35, 1024
    s_add_u32 s32, s36, 55296
    buffer_load_dwordx4 v4, s[12:15], s32 offen lds
    s_add_u32 m0, s35, 2048
    s_add_u32 s32, s36, 110592
    buffer_load_dwordx4 v4, s[12:15], s32 offen lds
    s_add_u32 m0, s35, 3072
    s_add_u32 s32, s36, 165888
    buffer_load_dwordx4 v4, s[12:15], s32 offen lds
    s_add_u32 m0, s35, 4096
    s_add_u32 s32, s36, 221184
    buffer_load_dwordx4 v4, s[12:15], s32 offen lds
    s_add_u32 m0, s35, 5120
    s_add_u32 s32, s36, 276480
    buffer_load_dwordx4 v4, s[12:15], s32 offen lds
    s_add_u32 m0, s35, 6144
    s_add_u32 s32, s36, 331776
    buffer_load_dwordx4 v4, s[12:15], s32 offen lds
    s_add_u32 m0, s35, 7168
    s_add_u32 s32, s36, 387072
    buffer_load_dwordx4 v4, s[12:15], s32 offen lds
    s_add_u32 m0, s35, 8192
    s_add_u32 s32, s36, 442368
    buffer_load_dwordx4 v4, s[12:15], s32 offen lds
    s_add_u32 m0, s35, 9216
    s_add_u32 s32, s36, 497664
    buffer_load_dwordx4 v4, s[12:15], s32 offen lds
    s_add_u32 m0, s35, 10240
    s_add_u32 s32, s36, 552960
    buffer_load_dwordx4 v4, s[12:15], s32 offen lds
    s_add_u32 m0, s35, 11264
    s_add_u32 s32, s36, 608256
    buffer_load_dwordx4 v4, s[12:15], s32 offen lds
    s_add_u32 m0, s35, 12288
    s_add_u32 s32, s36, 663552
    buffer_load_dwordx4 v4, s[12:15], s32 offen lds
    s_add_u32 m0, s35, 13312
    s_add_u32 s32, s36, 718848
    buffer_load_dwordx4 v4, s[12:15], s32 offen lds
    s_add_u32 m0, s35, 14336
    s_add_u32 s32, s36, 774144
    buffer_load_dwordx4 v4, s[12:15], s32 offen lds
    s_add_u32 m0, s35, 15360
    s_add_u32 s32, s36, 829440
    buffer_load_dwordx4 v4, s[12:15], s32 offen lds
    s_add_u32 m0, s35, 16384
    s_add_u32 s32, s36, 884736
    buffer_load_dwordx4 v4, s[12:15], s32 offen lds
    s_add_u32 m0, s35, 17408
    s_add_u32 s32, s36, 940032
    buffer_load_dwordx4 v4, s[12:15], s32 offen lds
    s_add_u32 m0, s35, 18432
    s_add_u32 s32, s36, 995328
    buffer_load_dwordx4 v4, s[12:15], s32 offen lds
    s_add_u32 m0, s35, 19456
    s_add_u32 s32, s36, 1050624
    buffer_load_dwordx4 v4, s[12:15], s32 offen lds
    s_add_u32 m0, s35, 20480
    s_add_u32 s32, s36, 1105920
    buffer_load_dwordx4 v4, s[12:15], s32 offen lds
    s_add_u32 m0, s35, 21504
    s_add_u32 s32, s36, 1161216
    buffer_load_dwordx4 v4, s[12:15], s32 offen lds
    s_add_u32 m0, s35, 22528
    s_add_u32 s32, s36, 1216512
    buffer_load_dwordx4 v4, s[12:15], s32 offen lds
    s_add_u32 m0, s35, 23552
    s_add_u32 s32, s36, 1271808
    buffer_load_dwordx4 v4, s[12:15], s32 offen lds
    s_waitcnt vmcnt(16)
    ds_read_b64_tr_b16 a[0:1], v2 offset:0
    ds_read_b64_tr_b16 a[2:3], v2 offset:512
    ds_read_b64_tr_b16 a[72:73], v3 offset:0
    ds_read_b64_tr_b16 a[74:75], v3 offset:512
    ds_read_b64_tr_b16 a[4:5], v2 offset:2048
    ds_read_b64_tr_b16 a[6:7], v2 offset:2560
    ds_read_b64_tr_b16 a[76:77], v3 offset:2048
    ds_read_b64_tr_b16 a[78:79], v3 offset:2560
    ds_read_b64_tr_b16 a[8:9], v2 offset:4096
    ds_read_b64_tr_b16 a[10:11], v2 offset:4608
    ds_read_b64_tr_b16 a[80:81], v3 offset:4096
    ds_read_b64_tr_b16 a[82:83], v3 offset:4608
    ds_read_b64_tr_b16 a[12:13], v2 offset:6144
    ds_read_b64_tr_b16 a[14:15], v2 offset:6656
    ds_read_b64_tr_b16 a[84:85], v3 offset:6144
    ds_read_b64_tr_b16 a[86:87], v3 offset:6656
    s_waitcnt lgkmcnt(0)
    s_add_u32 m0, s35, 0
    s_add_u32 s32, s36, 1327104
    buffer_load_dwordx4 v4, s[12:15], s32 offen lds
    s_add_u32 m0, s35, 1024
    s_add_u32 s32, s36, 1382400
    buffer_load_dwordx4 v4, s[12:15], s32 offen lds
    s_add_u32 m0, s35, 2048
    s_add_u32 s32, s36, 1437696
    buffer_load_dwordx4 v4, s[12:15], s32 offen lds
    s_add_u32 m0, s35, 3072
    s_add_u32 s32, s36, 1492992
    buffer_load_dwordx4 v4, s[12:15], s32 offen lds
    s_add_u32 m0, s35, 4096
    s_add_u32 s32, s36, 1548288
    buffer_load_dwordx4 v4, s[12:15], s32 offen lds
    s_add_u32 m0, s35, 5120
    s_add_u32 s32, s36, 1603584
    buffer_load_dwordx4 v4, s[12:15], s32 offen lds
    s_add_u32 m0, s35, 6144
    s_add_u32 s32, s36, 1658880
    buffer_load_dwordx4 v4, s[12:15], s32 offen lds
    s_add_u32 m0, s35, 7168
    s_add_u32 s32, s36, 1714176
    buffer_load_dwordx4 v4, s[12:15], s32 offen lds
    s_waitcnt vmcnt(16)
    ds_read_b64_tr_b16 a[16:17], v2 offset:8192
    ds_read_b64_tr_b16 a[18:19], v2 offset:8704
    ds_read_b64_tr_b16 a[88:89], v3 offset:8192
    ds_read_b64_tr_b16 a[90:91], v3 offset:8704
    ds_read_b64_tr_b16 a[20:21], v2 offset:10240
    ds_read_b64_tr_b16 a[22:23], v2 offset:10752
    ds_read_b64_tr_b16 a[92:93], v3 offset:10240
    ds_read_b64_tr_b16 a[94:95], v3 offset:10752
    ds_read_b64_tr_b16 a[24:25], v2 offset:12288
    ds_read_b64_tr_b16 a[26:27], v2 offset:12800
    ds_read_b64_tr_b16 a[96:97], v3 offset:12288
    ds_read_b64_tr_b16 a[98:99], v3 offset:12800
    ds_read_b64_tr_b16 a[28:29], v2 offset:14336
    ds_read_b64_tr_b16 a[30:31], v2 offset:14848
    ds_read_b64_tr_b16 a[100:101], v3 offset:14336
    ds_read_b64_tr_b16 a[102:103], v3 offset:14848
    s_waitcnt lgkmcnt(0)
    s_add_u32 m0, s35, 8192
    s_add_u32 s32, s36, 1769472
    buffer_load_dwordx4 v4, s[12:15], s32 offen lds
    s_add_u32 m0, s35, 9216
    s_add_u32 s32, s36, 1824768
    buffer_load_dwordx4 v4, s[12:15], s32 offen lds
    s_add_u32 m0, s35, 10240
    s_add_u32 s32, s36, 1880064
    buffer_load_dwordx4 v4, s[12:15], s32 offen lds
    s_add_u32 m0, s35, 11264
    s_add_u32 s32, s36, 1935360
    buffer_load_dwordx4 v4, s[12:15], s32 offen lds
    s_waitcnt vmcnt(12)
    ds_read_b64_tr_b16 a[32:33], v2 offset:16384
    ds_read_b64_tr_b16 a[34:35], v2 offset:16896
    ds_read_b64_tr_b16 a[104:105], v3 offset:16384
    ds_read_b64_tr_b16 a[106:107], v3 offset:16896
    ds_read_b64_tr_b16 a[36:37], v2 offset:18432
    ds_read_b64_tr_b16 a[38:39], v2 offset:18944
    ds_read_b64_tr_b16 a[108:109], v3 offset:18432
    ds_read_b64_tr_b16 a[110:111], v3 offset:18944
    ds_read_b64_tr_b16 a[40:41], v2 offset:20480
    ds_read_b64_tr_b16 a[42:43], v2 offset:20992
    ds_read_b64_tr_b16 a[112:113], v3 offset:20480
    ds_read_b64_tr_b16 a[114:115], v3 offset:20992
    ds_read_b64_tr_b16 a[44:45], v2 offset:22528
    ds_read_b64_tr_b16 a[46:47], v2 offset:23040
    ds_read_b64_tr_b16 a[116:117], v3 offset:22528
    ds_read_b64_tr_b16 a[118:119], v3 offset:23040
    s_waitcnt lgkmcnt(0)
    s_waitcnt vmcnt(4)
    ds_read_b64_tr_b16 a[48:49], v2 offset:0
    ds_read_b64_tr_b16 a[50:51], v2 offset:512
    ds_read_b64_tr_b16 a[120:121], v3 offset:0
    ds_read_b64_tr_b16 a[122:123], v3 offset:512
    ds_read_b64_tr_b16 a[52:53], v2 offset:2048
    ds_read_b64_tr_b16 a[54:55], v2 offset:2560
    ds_read_b64_tr_b16 a[124:125], v3 offset:2048
    ds_read_b64_tr_b16 a[126:127], v3 offset:2560
    ds_read_b64_tr_b16 a[56:57], v2 offset:4096
    ds_read_b64_tr_b16 a[58:59], v2 offset:4608
    ds_read_b64_tr_b16 a[128:129], v3 offset:4096
    ds_read_b64_tr_b16 a[130:131], v3 offset:4608
    ds_read_b64_tr_b16 a[60:61], v2 offset:6144
    ds_read_b64_tr_b16 a[62:63], v2 offset:6656
    ds_read_b64_tr_b16 a[132:133], v3 offset:6144
    ds_read_b64_tr_b16 a[134:135], v3 offset:6656
    s_waitcnt lgkmcnt(0)
    s_waitcnt vmcnt(0)
    ds_read_b64_tr_b16 a[64:65], v2 offset:8192
    ds_read_b64_tr_b16 a[66:67], v2 offset:8704
    ds_read_b64_tr_b16 a[136:137], v3 offset:8192
    ds_read_b64_tr_b16 a[138:139], v3 offset:8704
    ds_read_b64_tr_b16 a[68:69], v2 offset:10240
    ds_read_b64_tr_b16 a[70:71], v2 offset:10752
    ds_read_b64_tr_b16 a[140:141], v3 offset:10240
    ds_read_b64_tr_b16 a[142:143], v3 offset:10752
    s_waitcnt lgkmcnt(0)
    s_barrier
    s_min_u32 s33, s45, 63
    s_mul_i32 s33, s33, 36864
    s_add_u32 s33, s33, s40
    s_add_u32 s33, s33, 0
    s_add_u32 s34, s46, s41
    s_add_u32 m0, s34, 0
    s_add_u32 s32, s33, 0
    buffer_load_dwordx4 v5, s[8:11], s32 offen lds
    s_add_u32 m0, s34, 1024
    s_add_u32 s32, s33, 64
    buffer_load_dwordx4 v5, s[8:11], s32 offen lds
    s_add_u32 m0, s34, 2048
    s_add_u32 s32, s33, 128
    buffer_load_dwordx4 v5, s[8:11], s32 offen lds
    s_add_u32 m0, s34, 3072
    s_add_u32 s32, s33, 192
    buffer_load_dwordx4 v5, s[8:11], s32 offen lds
    s_add_u32 m0, s34, 4096
    s_add_u32 s32, s33, 256
    buffer_load_dwordx4 v5, s[8:11], s32 offen lds
    s_add_u32 m0, s34, 5120
    s_add_u32 s32, s33, 320
    buffer_load_dwordx4 v5, s[8:11], s32 offen lds
    s_add_u32 m0, s34, 6144
    s_add_u32 s32, s33, 384
    buffer_load_dwordx4 v5, s[8:11], s32 offen lds
    s_add_u32 m0, s34, 7168
    s_add_u32 s32, s33, 448
    buffer_load_dwordx4 v5, s[8:11], s32 offen lds
    s_add_u32 m0, s34, 8192
    s_add_u32 s32, s33, 512
    buffer_load_dwordx4 v5, s[8:11], s32 offen lds
    s_waitcnt vmcnt(9)
A1q_loop:
    s_barrier
    s_add_u32 s45, s45, 9
    s_add_u32 s46, s46, 36864
    s_cmp_eq_u32 s46, 147456
    s_cselect_b32 s46, 0, s46
    s_min_u32 s33, s45, 63
    s_mul_i32 s33, s33, 36864
    s_add_u32 s33, s33, s40
    s_add_u32 s33, s33, 0
    s_add_u32 s34, s46, s41
    s_add_u32 m0, s34, 0
    s_add_u32 s32, s33, 0
    buffer_load_dwordx4 v5, s[8:11], s32 offen lds
    s_add_u32 m0, s34, 1024
    s_add_u32 s32, s33, 64
    buffer_load_dwordx4 v5, s[8:11], s32 offen lds
    s_add_u32 m0, s34, 2048
    s_add_u32 s32, s33, 128
    buffer_load_dwordx4 v5, s[8:11], s32 offen lds
    s_add_u32 m0, s34, 3072
    s_add_u32 s32, s33, 192
    buffer_load_dwordx4 v5, s[8:11], s32 offen lds
    s_add_u32 m0, s34, 4096
    s_add_u32 s32, s33, 256
    buffer_load_dwordx4 v5, s[8:11], s32 offen lds
    s_add_u32 m0, s34, 5120
    s_add_u32 s32, s33, 320
    buffer_load_dwordx4 v5, s[8:11], s32 offen lds
    s_add_u32 m0, s34, 6144
    s_add_u32 s32, s33, 384
    buffer_load_dwordx4 v5, s[8:11], s32 offen lds
    s_add_u32 m0, s34, 7168
    s_add_u32 s32, s33, 448
    buffer_load_dwordx4 v5, s[8:11], s32 offen lds
    s_add_u32 m0, s34, 8192
    s_add_u32 s32, s33, 512
    buffer_load_dwordx4 v5, s[8:11], s32 offen lds
    v_add_u32 v6, s39, v1
    ds_read_b128 v[8:11], v6 offset:0
    ds_read_b128 v[12:15], v6 offset:18432
    ds_read_b128 v[16:19], v6 offset:1024
    ds_read_b128 v[20:23], v6 offset:19456
    s_waitcnt lgkmcnt(3)
    v_mfma_f32_16x16x32_bf16 v[24:27], a[0:3], v[8:11], 0
    s_waitcnt lgkmcnt(2)
    v_mfma_f32_16x16x32_bf16 v[28:31], a[0:3], v[12:15], 0
    v_mfma_f32_16x16x32_bf16 v[32:35], a[72:75], v[8:11], 0
    v_mfma_f32_16x16x32_bf16 v[36:39], a[72:75], v[12:15], 0
    s_waitcnt lgkmcnt(1)
    ds_read_b128 v[8:11], v6 offset:2048
    ds_read_b128 v[12:15], v6 offset:20480
    v_mfma_f32_16x16x32_bf16 v[24:27], a[4:7], v[16:19], v[24:27]
    s_waitcnt lgkmcnt(2)
    v_mfma_f32_16x16x32_bf16 v[28:31], a[4:7], v[20:23], v[28:31]
    v_mfma_f32_16x16x32_bf16 v[32:35], a[76:79], v[16:19], v[32:35]
    v_mfma_f32_16x16x32_bf16 v[36:39], a[76:79], v[20:23], v[36:39]
    s_waitcnt lgkmcnt(1)
    ds_read_b128 v[16:19], v6 offset:3072
    ds_read_b128 v[20:23], v6 offset:21504
    v_mfma_f32_16x16x32_bf16 v[24:27], a[8:11], v[8:11], v[24:27]
    s_waitcnt lgkmcnt(2)
    v_mfma_f32_16x16x32_bf16 v[28:31], a[8:11], v[12:15], v[28:31]
    v_mfma_f32_16x16x32_bf16 v[32:35], a[80:83], v[8:11], v[32:35]
    v_mfma_f32_16x16x32_bf16 v[36:39], a[80:83], v[12:15], v[36:39]
    s_waitcnt lgkmcnt(1)
    ds_read_b128 v[8:11], v6 offset:4096
    ds_read_b128 v[12:15], v6 offset:22528
    v_mfma_f32_16x16x32_bf16 v[24:27], a[12:15], v[16:19], v[24:27]
    s_waitcnt lgkmcnt(2)
    v_mfma_f32_16x16x32_bf16 v[28:31], a[12:15], v[20:23], v[28:31]
    v_mfma_f32_16x16x32_bf16 v[32:35], a[84:87], v[16:19], v[32:35]
    v_mfma_f32_16x16x32_bf16 v[36:39], a[84:87], v[20:23], v[36:39]
    s_waitcnt lgkmcnt(1)
    ds_read_b128 v[16:19], v6 offset:5120
    ds_read_b128 v[20:23], v6 offset:23552
    v_mfma_f32_16x16x32_bf16 v[24:27], a[16:19], v[8:11], v[24:27]
    s_waitcnt lgkmcnt(2)
    v_mfma_f32_16x16x32_bf16 v[28:31], a[16:19], v[12:15], v[28:31]
    v_mfma_f32_16x16x32_bf16 v[32:35], a[88:91], v[8:11], v[32:35]
    v_mfma_f32_16x16x32_bf16 v[36:39], a[88:91], v[12:15], v[36:39]
    s_waitcnt lgkmcnt(1)
    ds_read_b128 v[8:11], v6 offset:6144
    ds_read_b128 v[12:15], v6 offset:24576
    v_mfma_f32_16x16x32_bf16 v[24:27], a[20:23], v[16:19], v[24:27]
    s_waitcnt lgkmcnt(2)
    v_mfma_f32_16x16x32_bf16 v[28:31], a[20:23], v[20:23], v[28:31]
    v_mfma_f32_16x16x32_bf16 v[32:35], a[92:95], v[16:19], v[32:35]
    v_mfma_f32_16x16x32_bf16 v[36:39], a[92:95], v[20:23], v[36:39]
    s_waitcnt lgkmcnt(1)
    ds_read_b128 v[16:19], v6 offset:7168
    ds_read_b128 v[20:23], v6 offset:25600
    v_mfma_f32_16x16x32_bf16 v[24:27], a[24:27], v[8:11], v[24:27]
    s_waitcnt lgkmcnt(2)
    v_mfma_f32_16x16x32_bf16 v[28:31], a[24:27], v[12:15], v[28:31]
    v_mfma_f32_16x16x32_bf16 v[32:35], a[96:99], v[8:11], v[32:35]
    v_mfma_f32_16x16x32_bf16 v[36:39], a[96:99], v[12:15], v[36:39]
    s_waitcnt lgkmcnt(1)
    ds_read_b128 v[8:11], v6 offset:8192
    ds_read_b128 v[12:15], v6 offset:26624
    v_mfma_f32_16x16x32_bf16 v[24:27], a[28:31], v[16:19], v[24:27]
    s_waitcnt lgkmcnt(2)
    v_mfma_f32_16x16x32_bf16 v[28:31], a[28:31], v[20:23], v[28:31]
    v_mfma_f32_16x16x32_bf16 v[32:35], a[100:103], v[16:19], v[32:35]
    v_mfma_f32_16x16x32_bf16 v[36:39], a[100:103], v[20:23], v[36:39]
    s_waitcnt lgkmcnt(1)
    ds_read_b128 v[16:19], v6 offset:9216
    ds_read_b128 v[20:23], v6 offset:27648
    v_mfma_f32_16x16x32_bf16 v[24:27], a[32:35], v[8:11], v[24:27]
    s_waitcnt lgkmcnt(2)
    v_mfma_f32_16x16x32_bf16 v[28:31], a[32:35], v[12:15], v[28:31]
    v_mfma_f32_16x16x32_bf16 v[32:35], a[104:107], v[8:11], v[32:35]
    v_mfma_f32_16x16x32_bf16 v[36:39], a[104:107], v[12:15], v[36:39]
    s_waitcnt lgkmcnt(1)
    ds_read_b128 v[8:11], v6 offset:10240
    ds_read_b128 v[12:15], v6 offset:28672
    v_mfma_f32_16x16x32_bf16 v[24:27], a[36:39], v[16:19], v[24:27]
    s_waitcnt lgkmcnt(2)
    v_mfma_f32_16x16x32_bf16 v[28:31], a[36:39], v[20:23], v[28:31]
    v_mfma_f32_16x16x32_bf16 v[32:35], a[108:111], v[16:19], v[32:35]
    v_mfma_f32_16x16x32_bf16 v[36:39], a[108:111], v[20:23], v[36:39]
    s_waitcnt lgkmcnt(1)
    ds_read_b128 v[16:19], v6 offset:11264
    ds_read_b128 v[20:23], v6 offset:29696
    v_mfma_f32_16x16x32_bf16 v[24:27], a[40:43], v[8:11], v[24:27]
    s_waitcnt lgkmcnt(2)
    v_mfma_f32_16x16x32_bf16 v[28:31], a[40:43], v[12:15], v[28:31]
    v_mfma_f32_16x16x32_bf16 v[32:35], a[112:115], v[8:11], v[32:35]
    v_mfma_f32_16x16x32_bf16 v[36:39], a[112:115], v[12:15], v[36:39]
    s_waitcnt lgkmcnt(1)
    ds_read_b128 v[8:11], v6 offset:12288
    ds_read_b128 v[12:15], v6 offset:30720
    v_mfma_f32_16x16x32_bf16 v[24:27], a[44:47], v[16:19], v[24:27]
    s_waitcnt lgkmcnt(2)
    v_mfma_f32_16x16x32_bf16 v[28:31], a[44:47], v[20:23], v[28:31]
    v_mfma_f32_16x16x32_bf16 v[32:35], a[116:119], v[16:19], v[32:35]
    v_mfma_f32_16x16x32_bf16 v[36:39], a[116:119], v[20:23], v[36:39]
    s_waitcnt lgkmcnt(1)
    ds_read_b128 v[16:19], v6 offset:13312
    ds_read_b128 v[20:23], v6 offset:31744
    v_mfma_f32_16x16x32_bf16 v[24:27], a[48:51], v[8:11], v[24:27]
    s_waitcnt lgkmcnt(2)
    v_mfma_f32_16x16x32_bf16 v[28:31], a[48:51], v[12:15], v[28:31]
    v_mfma_f32_16x16x32_bf16 v[32:35], a[120:123], v[8:11], v[32:35]
    v_mfma_f32_16x16x32_bf16 v[36:39], a[120:123], v[12:15], v[36:39]
    s_waitcnt lgkmcnt(1)
    ds_read_b128 v[8:11], v6 offset:14336
    ds_read_b128 v[12:15], v6 offset:32768
    v_mfma_f32_16x16x32_bf16 v[24:27], a[52:55], v[16:19], v[24:27]
    s_waitcnt lgkmcnt(2)
    v_mfma_f32_16x16x32_bf16 v[28:31], a[52:55], v[20:23], v[28:31]
    v_mfma_f32_16x16x32_bf16 v[32:35], a[124:127], v[16:19], v[32:35]
    v_mfma_f32_16x16x32_bf16 v[36:39], a[124:127], v[20:23], v[36:39]
    s_waitcnt lgkmcnt(1)
    ds_read_b128 v[16:19], v6 offset:15360
    ds_read_b128 v[20:23], v6 offset:33792
    v_mfma_f32_16x16x32_bf16 v[24:27], a[56:59], v[8:11], v[24:27]
    s_waitcnt lgkmcnt(2)
    v_mfma_f32_16x16x32_bf16 v[28:31], a[56:59], v[12:15], v[28:31]
    v_mfma_f32_16x16x32_bf16 v[32:35], a[128:131], v[8:11], v[32:35]
    v_mfma_f32_16x16x32_bf16 v[36:39], a[128:131], v[12:15], v[36:39]
    s_waitcnt lgkmcnt(1)
    ds_read_b128 v[8:11], v6 offset:16384
    ds_read_b128 v[12:15], v6 offset:34816
    v_mfma_f32_16x16x32_bf16 v[24:27], a[60:63], v[16:19], v[24:27]
    s_waitcnt lgkmcnt(2)
    v_mfma_f32_16x16x32_bf16 v[28:31], a[60:63], v[20:23], v[28:31]
    v_mfma_f32_16x16x32_bf16 v[32:35], a[132:135], v[16:19], v[32:35]
    v_mfma_f32_16x16x32_bf16 v[36:39], a[132:135], v[20:23], v[36:39]
    s_waitcnt lgkmcnt(1)
    ds_read_b128 v[16:19], v6 offset:17408
    ds_read_b128 v[20:23], v6 offset:35840
    v_mfma_f32_16x16x32_bf16 v[24:27], a[64:67], v[8:11], v[24:27]
    s_waitcnt lgkmcnt(2)
    v_mfma_f32_16x16x32_bf16 v[28:31], a[64:67], v[12:15], v[28:31]
    v_mfma_f32_16x16x32_bf16 v[32:35], a[136:139], v[8:11], v[32:35]
    v_mfma_f32_16x16x32_bf16 v[36:39], a[136:139], v[12:15], v[36:39]
    s_waitcnt lgkmcnt(1)
    v_mfma_f32_16x16x32_bf16 v[24:27], a[68:71], v[16:19], v[24:27]
    s_waitcnt lgkmcnt(0)
    v_mfma_f32_16x16x32_bf16 v[28:31], a[68:71], v[20:23], v[28:31]
    v_mfma_f32_16x16x32_bf16 v[32:35], a[140:143], v[16:19], v[32:35]
    v_mfma_f32_16x16x32_bf16 v[36:39], a[140:143], v[20:23], v[36:39]
    s_waitcnt vmcnt(9)
    s_mul_i32 s43, s37, 73728
    s_add_u32 s43, s43, s36
    s_add_u32 s43, s43, 75497472
    s_add_u32 s32, s43, 36864
    v_mul_f32 v24, s42, v24
    v_mul_f32 v25, s42, v25
    v_mul_f32 v26, s42, v26
    v_mul_f32 v27, s42, v27
    v_cvt_pk_bf16_f32 v58, v24, v25
    v_cvt_pk_bf16_f32 v59, v26, v27
    buffer_store_dwordx2 v[58:59], v56, s[24:27], s43 offen offset:0 sc1
    v_mul_f32 v28, s42, v28
    v_mul_f32 v29, s42, v29
    v_mul_f32 v30, s42, v30
    v_mul_f32 v31, s42, v31
    v_cvt_pk_bf16_f32 v60, v28, v29
    v_cvt_pk_bf16_f32 v61, v30, v31
    buffer_store_dwordx2 v[60:61], v56, s[24:27], s32 offen offset:0 sc1
    v_mul_f32 v32, s42, v32
    v_mul_f32 v33, s42, v33
    v_mul_f32 v34, s42, v34
    v_mul_f32 v35, s42, v35
    v_cvt_pk_bf16_f32 v62, v32, v33
    v_cvt_pk_bf16_f32 v63, v34, v35
    buffer_store_dwordx2 v[62:63], v56, s[24:27], s43 offen offset:32 sc1
    v_mul_f32 v36, s42, v36
    v_mul_f32 v37, s42, v37
    v_mul_f32 v38, s42, v38
    v_mul_f32 v39, s42, v39
    v_cvt_pk_bf16_f32 v64, v36, v37
    v_cvt_pk_bf16_f32 v65, v38, v39
    buffer_store_dwordx2 v[64:65], v56, s[24:27], s32 offen offset:32 sc1
    s_add_u32 s37, s37, 9
    s_add_u32 s39, s39, 36864
    s_cmp_eq_u32 s39, 147456
    s_cselect_b32 s39, 0, s39
    s_cmp_lt_u32 s37, 64
    s_cbranch_scc1 A1q_loop
    s_waitcnt vmcnt(0)
    s_branch A1_done
A1_v:
    v_and_b32 v10, 15, v0
    v_lshlrev_b32 v10, 12, v10
    v_bfe_u32 v11, v0, 4, 1
    v_lshl_add_u32 v10, v11, 4, v10
    v_lshrrev_b32 v11, 5, v0
    v_lshl_add_u32 v56, v11, 3, v10
    v_bfe_u32 v10, v0, 2, 2
    v_bfe_u32 v11, v0, 4, 1
    v_lshl_add_u32 v10, v11, 3, v10
    v_lshrrev_b32 v11, 5, v0
    v_lshl_add_u32 v10, v11, 2, v10
    v_mul_u32_u24 v10, 3456, v10
    v_bfe_u32 v11, v0, 4, 1
    v_lshlrev_b32 v11, 1, v11
    v_xor_b32 v11, v11, v0
    v_and_b32 v11, 3, v11
    v_lshl_add_u32 v4, v11, 4, v10
    s_mul_i32 s35, s4, 24576
    v_add_u32 v2, s35, v7
    v_xor_b32 v3, 32, v2
    s_lshl_b32 s36, s38, 6
    s_mov_b32 s37, s47
    s_mov_b32 s39, 110592
    s_add_u32 s45, s47, 9
    s_mov_b32 s46, 0
    s_min_u32 s33, s37, 63
    s_mul_i32 s33, s33, 36864
    s_add_u32 s33, s33, s40
    s_add_u32 s33, s33, 0
    s_add_u32 s34, s39, s41
    s_add_u32 m0, s34, 0
    s_add_u32 s32, s33, 0
    buffer_load_dwordx4 v5, s[8:11], s32 offen lds
    s_add_u32 m0, s34, 1024
    s_add_u32 s32, s33, 64
    buffer_load_dwordx4 v5, s[8:11], s32 offen lds
    s_add_u32 m0, s34, 2048
    s_add_u32 s32, s33, 128
    buffer_load_dwordx4 v5, s[8:11], s32 offen lds
    s_add_u32 m0, s34, 3072
    s_add_u32 s32, s33, 192
    buffer_load_dwordx4 v5, s[8:11], s32 offen lds
    s_add_u32 m0, s34, 4096
    s_add_u32 s32, s33, 256
    buffer_load_dwordx4 v5, s[8:11], s32 offen lds
    s_add_u32 m0, s34, 5120
    s_add_u32 s32, s33, 320
    buffer_load_dwordx4 v5, s[8:11], s32 offen lds
    s_add_u32 m0, s34, 6144
    s_add_u32 s32, s33, 384
    buffer_load_dwordx4 v5, s[8:11], s32 offen lds
    s_add_u32 m0, s34, 7168
    s_add_u32 s32, s33, 448
    buffer_load_dwordx4 v5, s[8:11], s32 offen lds
    s_add_u32 m0, s34, 8192
    s_add_u32 s32, s33, 512
    buffer_load_dwordx4 v5, s[8:11], s32 offen lds
    s_add_u32 m0, s35, 0
    s_add_u32 s32, s36, 0
    buffer_load_dwordx4 v4, s[12:15], s32 offen lds
    s_add_u32 m0, s35, 1024
    s_add_u32 s32, s36, 55296
    buffer_load_dwordx4 v4, s[12:15], s32 offen lds
    s_add_u32 m0, s35, 2048
    s_add_u32 s32, s36, 110592
    buffer_load_dwordx4 v4, s[12:15], s32 offen lds
    s_add_u32 m0, s35, 3072
    s_add_u32 s32, s36, 165888
    buffer_load_dwordx4 v4, s[12:15], s32 offen lds
    s_add_u32 m0, s35, 4096
    s_add_u32 s32, s36, 221184
    buffer_load_dwordx4 v4, s[12:15], s32 offen lds
    s_add_u32 m0, s35, 5120
    s_add_u32 s32, s36, 276480
    buffer_load_dwordx4 v4, s[12:15], s32 offen lds
    s_add_u32 m0, s35, 6144
    s_add_u32 s32, s36, 331776
    buffer_load_dwordx4 v4, s[12:15], s32 offen lds
    s_add_u32 m0, s35, 7168
    s_add_u32 s32, s36, 387072
    buffer_load_dwordx4 v4, s[12:15], s32 offen lds
    s_add_u32 m0, s35, 8192
    s_add_u32 s32, s36, 442368
    buffer_load_dwordx4 v4, s[12:15], s32 offen lds
    s_add_u32 m0, s35, 9216
    s_add_u32 s32, s36, 497664
    buffer_load_dwordx4 v4, s[12:15], s32 offen lds
    s_add_u32 m0, s35, 10240
    s_add_u32 s32, s36, 552960
    buffer_load_dwordx4 v4, s[12:15], s32 offen lds
    s_add_u32 m0, s35, 11264
    s_add_u32 s32, s36, 608256
    buffer_load_dwordx4 v4, s[12:15], s32 offen lds
    s_add_u32 m0, s35, 12288
    s_add_u32 s32, s36, 663552
    buffer_load_dwordx4 v4, s[12:15], s32 offen lds
    s_add_u32 m0, s35, 13312
    s_add_u32 s32, s36, 718848
    buffer_load_dwordx4 v4, s[12:15], s32 offen lds
    s_add_u32 m0, s35, 14336
    s_add_u32 s32, s36, 774144
    buffer_load_dwordx4 v4, s[12:15], s32 offen lds
    s_add_u32 m0, s35, 15360
    s_add_u32 s32, s36, 829440
    buffer_load_dwordx4 v4, s[12:15], s32 offen lds
    s_add_u32 m0, s35, 16384
    s_add_u32 s32, s36, 884736
    buffer_load_dwordx4 v4, s[12:15], s32 offen lds
    s_add_u32 m0, s35, 17408
    s_add_u32 s32, s36, 940032
    buffer_load_dwordx4 v4, s[12:15], s32 offen lds
    s_add_u32 m0, s35, 18432
    s_add_u32 s32, s36, 995328
    buffer_load_dwordx4 v4, s[12:15], s32 offen lds
    s_add_u32 m0, s35, 19456
    s_add_u32 s32, s36, 1050624
    buffer_load_dwordx4 v4, s[12:15], s32 offen lds
    s_add_u32 m0, s35, 20480
    s_add_u32 s32, s36, 1105920
    buffer_load_dwordx4 v4, s[12:15], s32 offen lds
    s_add_u32 m0, s35, 21504
    s_add_u32 s32, s36, 1161216
    buffer_load_dwordx4 v4, s[12:15], s32 offen lds
    s_add_u32 m0, s35, 22528
    s_add_u32 s32, s36, 1216512
    buffer_load_dwordx4 v4, s[12:15], s32 offen lds
    s_add_u32 m0, s35, 23552
    s_add_u32 s32, s36, 1271808
    buffer_load_dwordx4 v4, s[12:15], s32 offen lds
    s_waitcnt vmcnt(16)
    ds_read_b64_tr_b16 a[0:1], v2 offset:0
    ds_read_b64_tr_b16 a[2:3], v2 offset:512
    ds_read_b64_tr_b16 a[72:73], v3 offset:0
    ds_read_b64_tr_b16 a[74:75], v3 offset:512
    ds_read_b64_tr_b16 a[4:5], v2 offset:2048
    ds_read_b64_tr_b16 a[6:7], v2 offset:2560
    ds_read_b64_tr_b16 a[76:77], v3 offset:2048
    ds_read_b64_tr_b16 a[78:79], v3 offset:2560
    ds_read_b64_tr_b16 a[8:9], v2 offset:4096
    ds_read_b64_tr_b16 a[10:11], v2 offset:4608
    ds_read_b64_tr_b16 a[80:81], v3 offset:4096
    ds_read_b64_tr_b16 a[82:83], v3 offset:4608
    ds_read_b64_tr_b16 a[12:13], v2 offset:6144
    ds_read_b64_tr_b16 a[14:15], v2 offset:6656
    ds_read_b64_tr_b16 a[84:85], v3 offset:6144
    ds_read_b64_tr_b16 a[86:87], v3 offset:6656
    s_waitcnt lgkmcnt(0)
    s_add_u32 m0, s35, 0
    s_add_u32 s32, s36, 1327104
    buffer_load_dwordx4 v4, s[12:15], s32 offen lds
    s_add_u32 m0, s35, 1024
    s_add_u32 s32, s36, 1382400
    buffer_load_dwordx4 v4, s[12:15], s32 offen lds
    s_add_u32 m0, s35, 2048
    s_add_u32 s32, s36, 1437696
    buffer_load_dwordx4 v4, s[12:15], s32 offen lds
    s_add_u32 m0, s35, 3072
    s_add_u32 s32, s36, 1492992
    buffer_load_dwordx4 v4, s[12:15], s32 offen lds
    s_add_u32 m0, s35, 4096
    s_add_u32 s32, s36, 1548288
    buffer_load_dwordx4 v4, s[12:15], s32 offen lds
    s_add_u32 m0, s35, 5120
    s_add_u32 s32, s36, 1603584
    buffer_load_dwordx4 v4, s[12:15], s32 offen lds
    s_add_u32 m0, s35, 6144
    s_add_u32 s32, s36, 1658880
    buffer_load_dwordx4 v4, s[12:15], s32 offen lds
    s_add_u32 m0, s35, 7168
    s_add_u32 s32, s36, 1714176
    buffer_load_dwordx4 v4, s[12:15], s32 offen lds
    s_waitcnt vmcnt(16)
    ds_read_b64_tr_b16 a[16:17], v2 offset:8192
    ds_read_b64_tr_b16 a[18:19], v2 offset:8704
    ds_read_b64_tr_b16 a[88:89], v3 offset:8192
    ds_read_b64_tr_b16 a[90:91], v3 offset:8704
    ds_read_b64_tr_b16 a[20:21], v2 offset:10240
    ds_read_b64_tr_b16 a[22:23], v2 offset:10752
    ds_read_b64_tr_b16 a[92:93], v3 offset:10240
    ds_read_b64_tr_b16 a[94:95], v3 offset:10752
    ds_read_b64_tr_b16 a[24:25], v2 offset:12288
    ds_read_b64_tr_b16 a[26:27], v2 offset:12800
    ds_read_b64_tr_b16 a[96:97], v3 offset:12288
    ds_read_b64_tr_b16 a[98:99], v3 offset:12800
    ds_read_b64_tr_b16 a[28:29], v2 offset:14336
    ds_read_b64_tr_b16 a[30:31], v2 offset:14848
    ds_read_b64_tr_b16 a[100:101], v3 offset:14336
    ds_read_b64_tr_b16 a[102:103], v3 offset:14848
    s_waitcnt lgkmcnt(0)
    s_add_u32 m0, s35, 8192
    s_add_u32 s32, s36, 1769472
    buffer_load_dwordx4 v4, s[12:15], s32 offen lds
    s_add_u32 m0, s35, 9216
    s_add_u32 s32, s36, 1824768
    buffer_load_dwordx4 v4, s[12:15], s32 offen lds
    s_add_u32 m0, s35, 10240
    s_add_u32 s32, s36, 1880064
    buffer_load_dwordx4 v4, s[12:15], s32 offen lds
    s_add_u32 m0, s35, 11264
    s_add_u32 s32, s36, 1935360
    buffer_load_dwordx4 v4, s[12:15], s32 offen lds
    s_waitcnt vmcnt(12)
    ds_read_b64_tr_b16 a[32:33], v2 offset:16384
    ds_read_b64_tr_b16 a[34:35], v2 offset:16896
    ds_read_b64_tr_b16 a[104:105], v3 offset:16384
    ds_read_b64_tr_b16 a[106:107], v3 offset:16896
    ds_read_b64_tr_b16 a[36:37], v2 offset:18432
    ds_read_b64_tr_b16 a[38:39], v2 offset:18944
    ds_read_b64_tr_b16 a[108:109], v3 offset:18432
    ds_read_b64_tr_b16 a[110:111], v3 offset:18944
    ds_read_b64_tr_b16 a[40:41], v2 offset:20480
    ds_read_b64_tr_b16 a[42:43], v2 offset:20992
    ds_read_b64_tr_b16 a[112:113], v3 offset:20480
    ds_read_b64_tr_b16 a[114:115], v3 offset:20992
    ds_read_b64_tr_b16 a[44:45], v2 offset:22528
    ds_read_b64_tr_b16 a[46:47], v2 offset:23040
    ds_read_b64_tr_b16 a[116:117], v3 offset:22528
    ds_read_b64_tr_b16 a[118:119], v3 offset:23040
    s_waitcnt lgkmcnt(0)
    s_waitcnt vmcnt(4)
    ds_read_b64_tr_b16 a[48:49], v2 offset:0
    ds_read_b64_tr_b16 a[50:51], v2 offset:512
    ds_read_b64_tr_b16 a[120:121], v3 offset:0
    ds_read_b64_tr_b16 a[122:123], v3 offset:512
    ds_read_b64_tr_b16 a[52:53], v2 offset:2048
    ds_read_b64_tr_b16 a[54:55], v2 offset:2560
    ds_read_b64_tr_b16 a[124:125], v3 offset:2048
    ds_read_b64_tr_b16 a[126:127], v3 offset:2560
    ds_read_b64_tr_b16 a[56:57], v2 offset:4096
    ds_read_b64_tr_b16 a[58:59], v2 offset:4608
    ds_read_b64_tr_b16 a[128:129], v3 offset:4096
    ds_read_b64_tr_b16 a[130:131], v3 offset:4608
    ds_read_b64_tr_b16 a[60:61], v2 offset:6144
    ds_read_b64_tr_b16 a[62:63], v2 offset:6656
    ds_read_b64_tr_b16 a[132:133], v3 offset:6144
    ds_read_b64_tr_b16 a[134:135], v3 offset:6656
    s_waitcnt lgkmcnt(0)
    s_waitcnt vmcnt(0)
    ds_read_b64_tr_b16 a[64:65], v2 offset:8192
    ds_read_b64_tr_b16 a[66:67], v2 offset:8704
    ds_read_b64_tr_b16 a[136:137], v3 offset:8192
    ds_read_b64_tr_b16 a[138:139], v3 offset:8704
    ds_read_b64_tr_b16 a[68:69], v2 offset:10240
    ds_read_b64_tr_b16 a[70:71], v2 offset:10752
    ds_read_b64_tr_b16 a[140:141], v3 offset:10240
    ds_read_b64_tr_b16 a[142:143], v3 offset:10752
    s_waitcnt lgkmcnt(0)
    s_barrier
    s_min_u32 s33, s45, 63
    s_mul_i32 s33, s33, 36864
    s_add_u32 s33, s33, s40
    s_add_u32 s33, s33, 0
    s_add_u32 s34, s46, s41
    s_add_u32 m0, s34, 0
    s_add_u32 s32, s33, 0
    buffer_load_dwordx4 v5, s[8:11], s32 offen lds
    s_add_u32 m0, s34, 1024
    s_add_u32 s32, s33, 64
    buffer_load_dwordx4 v5, s[8:11], s32 offen lds
    s_add_u32 m0, s34, 2048
    s_add_u32 s32, s33, 128
    buffer_load_dwordx4 v5, s[8:11], s32 offen lds
    s_add_u32 m0, s34, 3072
    s_add_u32 s32, s33, 192
    buffer_load_dwordx4 v5, s[8:11], s32 offen lds
    s_add_u32 m0, s34, 4096
    s_add_u32 s32, s33, 256
    buffer_load_dwordx4 v5, s[8:11], s32 offen lds
    s_add_u32 m0, s34, 5120
    s_add_u32 s32, s33, 320
    buffer_load_dwordx4 v5, s[8:11], s32 offen lds
    s_add_u32 m0, s34, 6144
    s_add_u32 s32, s33, 384
    buffer_load_dwordx4 v5, s[8:11], s32 offen lds
    s_add_u32 m0, s34, 7168
    s_add_u32 s32, s33, 448
    buffer_load_dwordx4 v5, s[8:11], s32 offen lds
    s_add_u32 m0, s34, 8192
    s_add_u32 s32, s33, 512
    buffer_load_dwordx4 v5, s[8:11], s32 offen lds
    s_waitcnt vmcnt(9)
A1v_loop:
    s_barrier
    s_add_u32 s45, s45, 9
    s_add_u32 s46, s46, 36864
    s_cmp_eq_u32 s46, 147456
    s_cselect_b32 s46, 0, s46
    s_min_u32 s33, s45, 63
    s_mul_i32 s33, s33, 36864
    s_add_u32 s33, s33, s40
    s_add_u32 s33, s33, 0
    s_add_u32 s34, s46, s41
    s_add_u32 m0, s34, 0
    s_add_u32 s32, s33, 0
    buffer_load_dwordx4 v5, s[8:11], s32 offen lds
    s_add_u32 m0, s34, 1024
    s_add_u32 s32, s33, 64
    buffer_load_dwordx4 v5, s[8:11], s32 offen lds
    s_add_u32 m0, s34, 2048
    s_add_u32 s32, s33, 128
    buffer_load_dwordx4 v5, s[8:11], s32 offen lds
    s_add_u32 m0, s34, 3072
    s_add_u32 s32, s33, 192
    buffer_load_dwordx4 v5, s[8:11], s32 offen lds
    s_add_u32 m0, s34, 4096
    s_add_u32 s32, s33, 256
    buffer_load_dwordx4 v5, s[8:11], s32 offen lds
    s_add_u32 m0, s34, 5120
    s_add_u32 s32, s33, 320
    buffer_load_dwordx4 v5, s[8:11], s32 offen lds
    s_add_u32 m0, s34, 6144
    s_add_u32 s32, s33, 384
    buffer_load_dwordx4 v5, s[8:11], s32 offen lds
    s_add_u32 m0, s34, 7168
    s_add_u32 s32, s33, 448
    buffer_load_dwordx4 v5, s[8:11], s32 offen lds
    s_add_u32 m0, s34, 8192
    s_add_u32 s32, s33, 512
    buffer_load_dwordx4 v5, s[8:11], s32 offen lds
    v_add_u32 v6, s39, v1
    ds_read_b128 v[8:11], v6 offset:0
    ds_read_b128 v[12:15], v6 offset:18432
    ds_read_b128 v[16:19], v6 offset:1024
    ds_read_b128 v[20:23], v6 offset:19456
    s_waitcnt lgkmcnt(3)
    v_mfma_f32_16x16x32_bf16 v[24:27], v[8:11], a[0:3], 0
    s_waitcnt lgkmcnt(2)
    v_mfma_f32_16x16x32_bf16 v[28:31], v[12:15], a[0:3], 0
    v_mfma_f32_16x16x32_bf16 v[32:35], v[8:11], a[72:75], 0
    v_mfma_f32_16x16x32_bf16 v[36:39], v[12:15], a[72:75], 0
    s_waitcnt lgkmcnt(1)
    ds_read_b128 v[8:11], v6 offset:2048
    ds_read_b128 v[12:15], v6 offset:20480
    v_mfma_f32_16x16x32_bf16 v[24:27], v[16:19], a[4:7], v[24:27]
    s_waitcnt lgkmcnt(2)
    v_mfma_f32_16x16x32_bf16 v[28:31], v[20:23], a[4:7], v[28:31]
    v_mfma_f32_16x16x32_bf16 v[32:35], v[16:19], a[76:79], v[32:35]
    v_mfma_f32_16x16x32_bf16 v[36:39], v[20:23], a[76:79], v[36:39]
    s_waitcnt lgkmcnt(1)
    ds_read_b128 v[16:19], v6 offset:3072
    ds_read_b128 v[20:23], v6 offset:21504
    v_mfma_f32_16x16x32_bf16 v[24:27], v[8:11], a[8:11], v[24:27]
    s_waitcnt lgkmcnt(2)
    v_mfma_f32_16x16x32_bf16 v[28:31], v[12:15], a[8:11], v[28:31]
    v_mfma_f32_16x16x32_bf16 v[32:35], v[8:11], a[80:83], v[32:35]
    v_mfma_f32_16x16x32_bf16 v[36:39], v[12:15], a[80:83], v[36:39]
    s_waitcnt lgkmcnt(1)
    ds_read_b128 v[8:11], v6 offset:4096
    ds_read_b128 v[12:15], v6 offset:22528
    v_mfma_f32_16x16x32_bf16 v[24:27], v[16:19], a[12:15], v[24:27]
    s_waitcnt lgkmcnt(2)
    v_mfma_f32_16x16x32_bf16 v[28:31], v[20:23], a[12:15], v[28:31]
    v_mfma_f32_16x16x32_bf16 v[32:35], v[16:19], a[84:87], v[32:35]
    v_mfma_f32_16x16x32_bf16 v[36:39], v[20:23], a[84:87], v[36:39]
    s_waitcnt lgkmcnt(1)
    ds_read_b128 v[16:19], v6 offset:5120
    ds_read_b128 v[20:23], v6 offset:23552
    v_mfma_f32_16x16x32_bf16 v[24:27], v[8:11], a[16:19], v[24:27]
    s_waitcnt lgkmcnt(2)
    v_mfma_f32_16x16x32_bf16 v[28:31], v[12:15], a[16:19], v[28:31]
    v_mfma_f32_16x16x32_bf16 v[32:35], v[8:11], a[88:91], v[32:35]
    v_mfma_f32_16x16x32_bf16 v[36:39], v[12:15], a[88:91], v[36:39]
    s_waitcnt lgkmcnt(1)
    ds_read_b128 v[8:11], v6 offset:6144
    ds_read_b128 v[12:15], v6 offset:24576
    v_mfma_f32_16x16x32_bf16 v[24:27], v[16:19], a[20:23], v[24:27]
    s_waitcnt lgkmcnt(2)
    v_mfma_f32_16x16x32_bf16 v[28:31], v[20:23], a[20:23], v[28:31]
    v_mfma_f32_16x16x32_bf16 v[32:35], v[16:19], a[92:95], v[32:35]
    v_mfma_f32_16x16x32_bf16 v[36:39], v[20:23], a[92:95], v[36:39]
    s_waitcnt lgkmcnt(1)
    ds_read_b128 v[16:19], v6 offset:7168
    ds_read_b128 v[20:23], v6 offset:25600
    v_mfma_f32_16x16x32_bf16 v[24:27], v[8:11], a[24:27], v[24:27]
    s_waitcnt lgkmcnt(2)
    v_mfma_f32_16x16x32_bf16 v[28:31], v[12:15], a[24:27], v[28:31]
    v_mfma_f32_16x16x32_bf16 v[32:35], v[8:11], a[96:99], v[32:35]
    v_mfma_f32_16x16x32_bf16 v[36:39], v[12:15], a[96:99], v[36:39]
    s_waitcnt lgkmcnt(1)
    ds_read_b128 v[8:11], v6 offset:8192
    ds_read_b128 v[12:15], v6 offset:26624
    v_mfma_f32_16x16x32_bf16 v[24:27], v[16:19], a[28:31], v[24:27]
    s_waitcnt lgkmcnt(2)
    v_mfma_f32_16x16x32_bf16 v[28:31], v[20:23], a[28:31], v[28:31]
    v_mfma_f32_16x16x32_bf16 v[32:35], v[16:19], a[100:103], v[32:35]
    v_mfma_f32_16x16x32_bf16 v[36:39], v[20:23], a[100:103], v[36:39]
    s_waitcnt lgkmcnt(1)
    ds_read_b128 v[16:19], v6 offset:9216
    ds_read_b128 v[20:23], v6 offset:27648
    v_mfma_f32_16x16x32_bf16 v[24:27], v[8:11], a[32:35], v[24:27]
    s_waitcnt lgkmcnt(2)
    v_mfma_f32_16x16x32_bf16 v[28:31], v[12:15], a[32:35], v[28:31]
    v_mfma_f32_16x16x32_bf16 v[32:35], v[8:11], a[104:107], v[32:35]
    v_mfma_f32_16x16x32_bf16 v[36:39], v[12:15], a[104:107], v[36:39]
    s_waitcnt lgkmcnt(1)
    ds_read_b128 v[8:11], v6 offset:10240
    ds_read_b128 v[12:15], v6 offset:28672
    v_mfma_f32_16x16x32_bf16 v[24:27], v[16:19], a[36:39], v[24:27]
    s_waitcnt lgkmcnt(2)
    v_mfma_f32_16x16x32_bf16 v[28:31], v[20:23], a[36:39], v[28:31]
    v_mfma_f32_16x16x32_bf16 v[32:35], v[16:19], a[108:111], v[32:35]
    v_mfma_f32_16x16x32_bf16 v[36:39], v[20:23], a[108:111], v[36:39]
    s_waitcnt lgkmcnt(1)
    ds_read_b128 v[16:19], v6 offset:11264
    ds_read_b128 v[20:23], v6 offset:29696
    v_mfma_f32_16x16x32_bf16 v[24:27], v[8:11], a[40:43], v[24:27]
    s_waitcnt lgkmcnt(2)
    v_mfma_f32_16x16x32_bf16 v[28:31], v[12:15], a[40:43], v[28:31]
    v_mfma_f32_16x16x32_bf16 v[32:35], v[8:11], a[112:115], v[32:35]
    v_mfma_f32_16x16x32_bf16 v[36:39], v[12:15], a[112:115], v[36:39]
    s_waitcnt lgkmcnt(1)
    ds_read_b128 v[8:11], v6 offset:12288
    ds_read_b128 v[12:15], v6 offset:30720
    v_mfma_f32_16x16x32_bf16 v[24:27], v[16:19], a[44:47], v[24:27]
    s_waitcnt lgkmcnt(2)
    v_mfma_f32_16x16x32_bf16 v[28:31], v[20:23], a[44:47], v[28:31]
    v_mfma_f32_16x16x32_bf16 v[32:35], v[16:19], a[116:119], v[32:35]
    v_mfma_f32_16x16x32_bf16 v[36:39], v[20:23], a[116:119], v[36:39]
    s_waitcnt lgkmcnt(1)
    ds_read_b128 v[16:19], v6 offset:13312
    ds_read_b128 v[20:23], v6 offset:31744
    v_mfma_f32_16x16x32_bf16 v[24:27], v[8:11], a[48:51], v[24:27]
    s_waitcnt lgkmcnt(2)
    v_mfma_f32_16x16x32_bf16 v[28:31], v[12:15], a[48:51], v[28:31]
    v_mfma_f32_16x16x32_bf16 v[32:35], v[8:11], a[120:123], v[32:35]
    v_mfma_f32_16x16x32_bf16 v[36:39], v[12:15], a[120:123], v[36:39]
    s_waitcnt lgkmcnt(1)
    ds_read_b128 v[8:11], v6 offset:14336
    ds_read_b128 v[12:15], v6 offset:32768
    v_mfma_f32_16x16x32_bf16 v[24:27], v[16:19], a[52:55], v[24:27]
    s_waitcnt lgkmcnt(2)
    v_mfma_f32_16x16x32_bf16 v[28:31], v[20:23], a[52:55], v[28:31]
    v_mfma_f32_16x16x32_bf16 v[32:35], v[16:19], a[124:127], v[32:35]
    v_mfma_f32_16x16x32_bf16 v[36:39], v[20:23], a[124:127], v[36:39]
    s_waitcnt lgkmcnt(1)
    ds_read_b128 v[16:19], v6 offset:15360
    ds_read_b128 v[20:23], v6 offset:33792
    v_mfma_f32_16x16x32_bf16 v[24:27], v[8:11], a[56:59], v[24:27]
    s_waitcnt lgkmcnt(2)
    v_mfma_f32_16x16x32_bf16 v[28:31], v[12:15], a[56:59], v[28:31]
    v_mfma_f32_16x16x32_bf16 v[32:35], v[8:11], a[128:131], v[32:35]
    v_mfma_f32_16x16x32_bf16 v[36:39], v[12:15], a[128:131], v[36:39]
    s_waitcnt lgkmcnt(1)
    ds_read_b128 v[8:11], v6 offset:16384
    ds_read_b128 v[12:15], v6 offset:34816
    v_mfma_f32_16x16x32_bf16 v[24:27], v[16:19], a[60:63], v[24:27]
    s_waitcnt lgkmcnt(2)
    v_mfma_f32_16x16x32_bf16 v[28:31], v[20:23], a[60:63], v[28:31]
    v_mfma_f32_16x16x32_bf16 v[32:35], v[16:19], a[132:135], v[32:35]
    v_mfma_f32_16x16x32_bf16 v[36:39], v[20:23], a[132:135], v[36:39]
    s_waitcnt lgkmcnt(1)
    ds_read_b128 v[16:19], v6 offset:17408
    ds_read_b128 v[20:23], v6 offset:35840
    v_mfma_f32_16x16x32_bf16 v[24:27], v[8:11], a[64:67], v[24:27]
    s_waitcnt lgkmcnt(2)
    v_mfma_f32_16x16x32_bf16 v[28:31], v[12:15], a[64:67], v[28:31]
    v_mfma_f32_16x16x32_bf16 v[32:35], v[8:11], a[136:139], v[32:35]
    v_mfma_f32_16x16x32_bf16 v[36:39], v[12:15], a[136:139], v[36:39]
    s_waitcnt lgkmcnt(1)
    v_mfma_f32_16x16x32_bf16 v[24:27], v[16:19], a[68:71], v[24:27]
    s_waitcnt lgkmcnt(0)
    v_mfma_f32_16x16x32_bf16 v[28:31], v[20:23], a[68:71], v[28:31]
    v_mfma_f32_16x16x32_bf16 v[32:35], v[16:19], a[140:143], v[32:35]
    v_mfma_f32_16x16x32_bf16 v[36:39], v[20:23], a[140:143], v[36:39]
    s_waitcnt vmcnt(9)
    s_sub_u32 s43, s38, 36
    s_lshl_b32 s43, s43, 17
    s_lshl_b32 s32, s37, 6
    s_add_u32 s43, s43, s32
    s_add_u32 s43, s43, 80740352
    s_add_u32 s32, s43, 65536
    v_cvt_pk_bf16_f32 v58, v24, v25
    v_cvt_pk_bf16_f32 v59, v26, v27
    buffer_store_dwordx2 v[58:59], v56, s[24:27], s43 offen offset:0 sc1
    v_cvt_pk_bf16_f32 v60, v28, v29
    v_cvt_pk_bf16_f32 v61, v30, v31
    buffer_store_dwordx2 v[60:61], v56, s[24:27], s43 offen offset:32 sc1
    v_cvt_pk_bf16_f32 v62, v32, v33
    v_cvt_pk_bf16_f32 v63, v34, v35
    buffer_store_dwordx2 v[62:63], v56, s[24:27], s32 offen offset:0 sc1
    v_cvt_pk_bf16_f32 v64, v36, v37
    v_cvt_pk_bf16_f32 v65, v38, v39
    buffer_store_dwordx2 v[64:65], v56, s[24:27], s32 offen offset:32 sc1
    s_add_u32 s37, s37, 9
    s_add_u32 s39, s39, 36864
    s_cmp_eq_u32 s39, 147456
    s_cselect_b32 s39, 0, s39
    s_cmp_lt_u32 s37, 64
    s_cbranch_scc1 A1v_loop
    s_waitcnt vmcnt(0)
A1_done:
    s_cmp_lg_u32 s4, 0
    s_cbranch_scc1 A1_iw_d
    v_mov_b32 v10, 128
    s_mov_b32 s44, 0
A1_iw:
    global_load_dword v11, v10, s[28:29] sc1
    s_add_u32 s44, s44, 1
    s_waitcnt vmcnt(0)
    v_readfirstlane_b32 s32, v11
    s_cmp_gt_u32 s44, 400000
    s_nop 3
    s_cbranch_scc1 A1_iw_d
    s_and_b32 s32, s32, 0xff
    s_cmp_ge_u32 s32, 32
    s_cbranch_scc1 A1_iw_d
    s_sleep 8
    s_branch A1_iw
A1_iw_d:
    s_waitcnt vmcnt(0)
    s_barrier
    s_cmp_lg_u32 s4, 0
    s_cbranch_scc1 A1_sg
    s_lshl_b32 s32, s3, 2
    s_add_u32 s32, s32, 51906560
    v_mov_b32 v11, 1
    s_mov_b64 exec, 1
    buffer_store_dword v11, v1, s[24:27], s32 offen sc1
    s_mov_b64 exec, -1
A1_sg:
A1_skip:
    s_barrier
    s_lshr_b32 s37, s3, 2
    s_and_b32 s47, s3, 3
    s_lshl_b32 s47, s47, 2
    s_add_u32 s47, s47, s4
    s_lshl_b32 s47, s47, 7
    s_mul_i32 s36, s37, 36
    s_mov_b32 s42, 0x5d800000
    v_and_b32 v10, 31, v0
    v_mul_u32_u24 v10, 2304, v10
    v_lshrrev_b32 v11, 5, v0
    v_lshl_add_u32 v12, v11, 4, v10
    v_mul_u32_u24 v13, 2304, v0
    v_add_u32 v10, 0, v0
    v_mul_u32_u24 v11, 3277, v10
    v_lshrrev_b32 v11, 16, v11
    v_mul_u32_u24 v19, 20, v11
    v_sub_u32 v10, v10, v19
    v_min_u32 v10, 17, v10
    v_lshlrev_b32 v10, 12, v10
    v_lshl_add_u32 v14, v11, 4, v10
    v_add_u32 v10, 64, v0
    v_mul_u32_u24 v11, 3277, v10
    v_lshrrev_b32 v11, 16, v11
    v_mul_u32_u24 v19, 20, v11
    v_sub_u32 v10, v10, v19
    v_min_u32 v10, 17, v10
    v_lshlrev_b32 v10, 12, v10
    v_lshl_add_u32 v15, v11, 4, v10
    v_add_u32 v10, 128, v0
    v_mul_u32_u24 v11, 3277, v10
    v_lshrrev_b32 v11, 16, v11
    v_mul_u32_u24 v19, 20, v11
    v_sub_u32 v10, v10, v19
    v_min_u32 v10, 17, v10
    v_lshlrev_b32 v10, 12, v10
    v_lshl_add_u32 v16, v11, 4, v10
    v_add_u32 v10, 192, v0
    v_mul_u32_u24 v11, 3277, v10
    v_lshrrev_b32 v11, 16, v11
    v_mul_u32_u24 v19, 20, v11
    v_sub_u32 v10, v10, v19
    v_min_u32 v10, 17, v10
    v_lshlrev_b32 v10, 12, v10
    v_lshl_add_u32 v17, v11, 4, v10
    v_add_u32 v10, 256, v0
    v_mul_u32_u24 v11, 3277, v10
    v_lshrrev_b32 v11, 16, v11
    v_mul_u32_u24 v19, 20, v11
    v_sub_u32 v10, v10, v19
    v_min_u32 v10, 17, v10
    v_lshlrev_b32 v10, 12, v10
    v_lshl_add_u32 v18, v11, 4, v10
    s_cmp_lg_u32 s4, 0
    s_nop 0
    s_cbranch_scc1 A2_iw_d
    v_mov_b32 v10, 128
    s_mov_b32 s44, 0
A2_iw:
    global_load_dword v11, v10, s[28:29] sc1
    s_add_u32 s44, s44, 1
    s_waitcnt vmcnt(0)
    v_readfirstlane_b32 s32, v11
    s_cmp_gt_u32 s44, 400000
    s_nop 3
    s_cbranch_scc1 A2_iw_d
    s_and_b32 s32, s32, 0xff
    s_cmp_ge_u32 s32, 32
    s_cbranch_scc1 A2_iw_d
    s_sleep 8
    s_branch A2_iw
A2_iw_d:
    s_mov_b32 s33, 51906560
    s_cmp_lg_u32 s4, 0
    s_cbranch_scc1 A2_w_d
    v_lshrrev_b32 v10, 1, v1
    v_min_u32 v10, 496, v10
    s_mov_b32 s44, 0
A2_w:
    buffer_load_dwordx2 v[20:21], v10, s[24:27], s33 offen sc1
    s_add_u32 s44, s44, 1
    s_waitcnt vmcnt(0)
    v_and_b32 v20, v20, v21
    v_cmp_ne_u32 vcc, 1, v20
    s_cmp_gt_u32 s44, 400000
    s_nop 3
    s_cbranch_scc1 A2_w_d
    s_cbranch_vccz A2_w_d
    s_sleep 8
    s_branch A2_w
A2_w_d:
    s_barrier
    s_mul_i32 s33, s4, 1179648
    s_add_u32 s33, s33, s36
    s_add_u32 s33, s33, 75498624
    s_lshl_b32 s34, s4, 14
    s_add_u32 m0, s34, 0
    s_add_u32 s32, s33, 0
    buffer_load_dwordx4 v12, s[24:27], s32 offen sc1 lds
    s_add_u32 m0, s34, 1024
    s_add_u32 s32, s33, 73728
    buffer_load_dwordx4 v12, s[24:27], s32 offen sc1 lds
    s_add_u32 m0, s34, 2048
    s_add_u32 s32, s33, 147456
    buffer_load_dwordx4 v12, s[24:27], s32 offen sc1 lds
    s_add_u32 m0, s34, 3072
    s_add_u32 s32, s33, 221184
    buffer_load_dwordx4 v12, s[24:27], s32 offen sc1 lds
    s_add_u32 m0, s34, 4096
    s_add_u32 s32, s33, 294912
    buffer_load_dwordx4 v12, s[24:27], s32 offen sc1 lds
    s_add_u32 m0, s34, 5120
    s_add_u32 s32, s33, 368640
    buffer_load_dwordx4 v12, s[24:27], s32 offen sc1 lds
    s_add_u32 m0, s34, 6144
    s_add_u32 s32, s33, 442368
    buffer_load_dwordx4 v12, s[24:27], s32 offen sc1 lds
    s_add_u32 m0, s34, 7168
    s_add_u32 s32, s33, 516096
    buffer_load_dwordx4 v12, s[24:27], s32 offen sc1 lds
    s_add_u32 m0, s34, 8192
    s_add_u32 s32, s33, 589824
    buffer_load_dwordx4 v12, s[24:27], s32 offen sc1 lds
    s_add_u32 m0, s34, 9216
    s_add_u32 s32, s33, 663552
    buffer_load_dwordx4 v12, s[24:27], s32 offen sc1 lds
    s_add_u32 m0, s34, 10240
    s_add_u32 s32, s33, 737280
    buffer_load_dwordx4 v12, s[24:27], s32 offen sc1 lds
    s_add_u32 m0, s34, 11264
    s_add_u32 s32, s33, 811008
    buffer_load_dwordx4 v12, s[24:27], s32 offen sc1 lds
    s_add_u32 m0, s34, 12288
    s_add_u32 s32, s33, 884736
    buffer_load_dwordx4 v12, s[24:27], s32 offen sc1 lds
    s_add_u32 m0, s34, 13312
    s_add_u32 s32, s33, 958464
    buffer_load_dwordx4 v12, s[24:27], s32 offen sc1 lds
    s_add_u32 m0, s34, 14336
    s_add_u32 s32, s33, 1032192
    buffer_load_dwordx4 v12, s[24:27], s32 offen sc1 lds
    s_add_u32 m0, s34, 15360
    s_add_u32 s32, s33, 1105920
    buffer_load_dwordx4 v12, s[24:27], s32 offen sc1 lds
    s_lshl_b32 s34, s4, 11
    s_add_u32 m0, s34, 65536
    s_add_u32 s32, s33, 32
    buffer_load_dword v13, s[24:27], s32 offen sc1 lds
    s_add_u32 m0, s34, 65792
    s_add_u32 s32, s33, 147488
    buffer_load_dword v13, s[24:27], s32 offen sc1 lds
    s_add_u32 m0, s34, 66048
    s_add_u32 s32, s33, 294944
    buffer_load_dword v13, s[24:27], s32 offen sc1 lds
    s_add_u32 m0, s34, 66304
    s_add_u32 s32, s33, 442400
    buffer_load_dword v13, s[24:27], s32 offen sc1 lds
    s_add_u32 m0, s34, 66560
    s_add_u32 s32, s33, 589856
    buffer_load_dword v13, s[24:27], s32 offen sc1 lds
    s_add_u32 m0, s34, 66816
    s_add_u32 s32, s33, 737312
    buffer_load_dword v13, s[24:27], s32 offen sc1 lds
    s_add_u32 m0, s34, 67072
    s_add_u32 s32, s33, 884768
    buffer_load_dword v13, s[24:27], s32 offen sc1 lds
    s_add_u32 m0, s34, 67328
    s_add_u32 s32, s33, 1032224
    buffer_load_dword v13, s[24:27], s32 offen sc1 lds
    s_mul_i32 s33, s37, 73728
    s_lshl_b32 s32, s4, 10
    s_add_u32 s33, s33, s32
    s_add_u32 s33, s33, 80740352
    s_mul_i32 s34, s4, 20480
    s_add_u32 m0, s34, 73728
    s_add_u32 s32, s33, 0
    buffer_load_dwordx4 v14, s[24:27], s32 offen sc1 lds
    s_add_u32 m0, s34, 74752
    s_add_u32 s32, s33, 0
    buffer_load_dwordx4 v15, s[24:27], s32 offen sc1 lds
    s_add_u32 m0, s34, 75776
    s_add_u32 s32, s33, 0
    buffer_load_dwordx4 v16, s[24:27], s32 offen sc1 lds
    s_add_u32 m0, s34, 76800
    s_add_u32 s32, s33, 0
    buffer_load_dwordx4 v17, s[24:27], s32 offen sc1 lds
    s_add_u32 m0, s34, 77824
    s_add_u32 s32, s33, 0
    buffer_load_dwordx4 v18, s[24:27], s32 offen sc1 lds
    s_add_u32 m0, s34, 78848
    s_add_u32 s32, s33, 256
    buffer_load_dwordx4 v14, s[24:27], s32 offen sc1 lds
    s_add_u32 m0, s34, 79872
    s_add_u32 s32, s33, 256
    buffer_load_dwordx4 v15, s[24:27], s32 offen sc1 lds
    s_add_u32 m0, s34, 80896
    s_add_u32 s32, s33, 256
    buffer_load_dwordx4 v16, s[24:27], s32 offen sc1 lds
    s_add_u32 m0, s34, 81920
    s_add_u32 s32, s33, 256
    buffer_load_dwordx4 v17, s[24:27], s32 offen sc1 lds
    s_add_u32 m0, s34, 82944
    s_add_u32 s32, s33, 256
    buffer_load_dwordx4 v18, s[24:27], s32 offen sc1 lds
    s_add_u32 m0, s34, 83968
    s_add_u32 s32, s33, 512
    buffer_load_dwordx4 v14, s[24:27], s32 offen sc1 lds
    s_add_u32 m0, s34, 84992
    s_add_u32 s32, s33, 512
    buffer_load_dwordx4 v15, s[24:27], s32 offen sc1 lds
    s_add_u32 m0, s34, 86016
    s_add_u32 s32, s33, 512
    buffer_load_dwordx4 v16, s[24:27], s32 offen sc1 lds
    s_add_u32 m0, s34, 87040
    s_add_u32 s32, s33, 512
    buffer_load_dwordx4 v17, s[24:27], s32 offen sc1 lds
    s_add_u32 m0, s34, 88064
    s_add_u32 s32, s33, 512
    buffer_load_dwordx4 v18, s[24:27], s32 offen sc1 lds
    s_add_u32 m0, s34, 89088
    s_add_u32 s32, s33, 768
    buffer_load_dwordx4 v14, s[24:27], s32 offen sc1 lds
    s_add_u32 m0, s34, 90112
    s_add_u32 s32, s33, 768
    buffer_load_dwordx4 v15, s[24:27], s32 offen sc1 lds
    s_add_u32 m0, s34, 91136
    s_add_u32 s32, s33, 768
    buffer_load_dwordx4 v16, s[24:27], s32 offen sc1 lds
    s_add_u32 m0, s34, 92160
    s_add_u32 s32, s33, 768
    buffer_load_dwordx4 v17, s[24:27], s32 offen sc1 lds
    s_add_u32 m0, s34, 93184
    s_add_u32 s32, s33, 768
    buffer_load_dwordx4 v18, s[24:27], s32 offen sc1 lds
    s_mul_i32 s33, s47, 2304
    s_add_u32 s33, s33, s36
    s_add_u32 s33, s33, 75497472
    s_add_u32 s32, s33, 0
    buffer_load_dwordx4 v[32:35], v12, s[24:27], s32 offen sc1
    buffer_load_dword v36, v12, s[24:27], s32 offen offset:32 sc1
    v_mov_b32 v37, 0
    v_mov_b64 v[38:39], 0
    s_add_u32 s32, s33, 73728
    buffer_load_dwordx4 v[40:43], v12, s[24:27], s32 offen sc1
    buffer_load_dword v44, v12, s[24:27], s32 offen offset:32 sc1
    v_mov_b32 v45, 0
    v_mov_b64 v[46:47], 0
    s_add_u32 s32, s33, 147456
    buffer_load_dwordx4 v[48:51], v12, s[24:27], s32 offen sc1
    buffer_load_dword v52, v12, s[24:27], s32 offen offset:32 sc1
    v_mov_b32 v53, 0
    v_mov_b64 v[54:55], 0
    s_add_u32 s32, s33, 221184
    buffer_load_dwordx4 v[56:59], v12, s[24:27], s32 offen sc1
    buffer_load_dword v60, v12, s[24:27], s32 offen offset:32 sc1
    v_mov_b32 v61, 0
    v_mov_b64 v[62:63], 0
    v_cmp_gt_u32 vcc, 32, v0
    s_waitcnt vmcnt(6)
    s_nop 0
    v_cndmask_b32 v36, 0, v36, vcc
    s_waitcnt vmcnt(4)
    v_cndmask_b32 v44, 0, v44, vcc
    s_waitcnt vmcnt(2)
    v_cndmask_b32 v52, 0, v52, vcc
    s_waitcnt vmcnt(0)
    v_cndmask_b32 v60, 0, v60, vcc
    v_mul_u32_u24 v10, 320, v0
    s_add_u32 s34, s34, 74016
    v_add_u32 v10, s34, v10
    v_mov_b32 v20, 0x3f803f80
    v_mov_b32 v21, 0x3f803f80
    v_mov_b32 v22, 0x3f803f80
    v_mov_b32 v23, 0x3f803f80
    s_waitcnt vmcnt(0)
    ds_write_b128 v10, v[20:23]
    v_mov_b32 v69, 0
    v_mov_b64 v[70:71], 0
    v_mov_b32 v85, 0
    v_mov_b64 v[86:87], 0
    v_mov_b64 v[136:137], 0
    v_mov_b64 v[138:139], 0
    v_mov_b64 v[140:141], 0
    v_mov_b64 v[142:143], 0
    v_mov_b64 v[144:145], 0
    v_mov_b64 v[146:147], 0
    v_mov_b64 v[148:149], 0
    v_mov_b64 v[150:151], 0
    v_mov_b64 v[152:153], 0
    v_mov_b64 v[154:155], 0
    v_mov_b64 v[156:157], 0
    v_mov_b64 v[158:159], 0
    v_mov_b64 v[160:161], 0
    v_mov_b64 v[162:163], 0
    v_mov_b64 v[164:165], 0
    v_mov_b64 v[166:167], 0
    v_mov_b64 v[168:169], 0
    v_mov_b64 v[170:171], 0
    v_mov_b64 v[172:173], 0
    v_mov_b64 v[174:175], 0
    v_mov_b64 v[176:177], 0
    v_mov_b64 v[178:179], 0
    v_mov_b64 v[180:181], 0
    v_mov_b64 v[182:183], 0
    v_mov_b64 v[184:185], 0
    v_mov_b64 v[186:187], 0
    v_mov_b64 v[188:189], 0
    v_mov_b64 v[190:191], 0
    v_mov_b64 v[192:193], 0
    v_mov_b64 v[194:195], 0
    v_mov_b64 v[196:197], 0
    v_mov_b64 v[198:199], 0
    s_mov_b32 s46, 0
    s_waitcnt lgkmcnt(0)
    s_barrier
A2_pass:
    s_mov_b32 s32, 73728
    v_mov_b32 v24, v1
    v_and_b32 v10, 31, v0
    v_lshlrev_b32 v25, 2, v10
    v_add_u32 v25, 65536, v25
    v_min_u32 v10, 19, v10
    v_lshlrev_b32 v10, 4, v10
    v_lshrrev_b32 v11, 5, v0
    v_mul_u32_u24 v11, 320, v11
    v_add3_u32 v26, v10, v11, s32
    ds_read_b128 v[64:67], v24 offset:0
    ds_read_b32 v68, v25 offset:0
    ds_read_b128 v[72:75], v26 offset:0
    ds_read_b128 v[76:79], v26 offset:640
    ds_read_b128 v[88:91], v26 offset:0
    ds_read_b128 v[92:95], v26 offset:640
    v_accvgpr_write_b32 a0, 0
    v_accvgpr_write_b32 a1, 0
    v_accvgpr_write_b32 a2, 0
    v_accvgpr_write_b32 a3, 0
    v_accvgpr_write_b32 a4, 0
    v_accvgpr_write_b32 a5, 0
    v_accvgpr_write_b32 a6, 0
    v_accvgpr_write_b32 a7, 0
    v_accvgpr_write_b32 a8, 0
    v_accvgpr_write_b32 a9, 0
    v_accvgpr_write_b32 a10, 0
    v_accvgpr_write_b32 a11, 0
    v_accvgpr_write_b32 a12, 0
    v_accvgpr_write_b32 a13, 0
    v_accvgpr_write_b32 a14, 0
    v_accvgpr_write_b32 a15, 0
    v_accvgpr_write_b32 a16, 0
    v_accvgpr_write_b32 a17, 0
    v_accvgpr_write_b32 a18, 0
    v_accvgpr_write_b32 a19, 0
    v_accvgpr_write_b32 a20, 0
    v_accvgpr_write_b32 a21, 0
    v_accvgpr_write_b32 a22, 0
    v_accvgpr_write_b32 a23, 0
    v_accvgpr_write_b32 a24, 0
    v_accvgpr_write_b32 a25, 0
    v_accvgpr_write_b32 a26, 0
    v_accvgpr_write_b32 a27, 0
    v_accvgpr_write_b32 a28, 0
    v_accvgpr_write_b32 a29, 0
    v_accvgpr_write_b32 a30, 0
    v_accvgpr_write_b32 a31, 0
    v_accvgpr_write_b32 a32, 0
    v_accvgpr_write_b32 a33, 0
    v_accvgpr_write_b32 a34, 0
    v_accvgpr_write_b32 a35, 0
    v_accvgpr_write_b32 a36, 0
    v_accvgpr_write_b32 a37, 0
    v_accvgpr_write_b32 a38, 0
    v_accvgpr_write_b32 a39, 0
    v_accvgpr_write_b32 a40, 0
    v_accvgpr_write_b32 a41, 0
    v_accvgpr_write_b32 a42, 0
    v_accvgpr_write_b32 a43, 0
    v_accvgpr_write_b32 a44, 0
    v_accvgpr_write_b32 a45, 0
    v_accvgpr_write_b32 a46, 0
    v_accvgpr_write_b32 a47, 0
    v_accvgpr_write_b32 a48, 0
    v_accvgpr_write_b32 a49, 0
    v_accvgpr_write_b32 a50, 0
    v_accvgpr_write_b32 a51, 0
    v_accvgpr_write_b32 a52, 0
    v_accvgpr_write_b32 a53, 0
    v_accvgpr_write_b32 a54, 0
    v_accvgpr_write_b32 a55, 0
    v_accvgpr_write_b32 a56, 0
    v_accvgpr_write_b32 a57, 0
    v_accvgpr_write_b32 a58, 0
    v_accvgpr_write_b32 a59, 0
    v_accvgpr_write_b32 a60, 0
    v_accvgpr_write_b32 a61, 0
    v_accvgpr_write_b32 a62, 0
    v_accvgpr_write_b32 a63, 0
    v_mov_b64 v[132:133], 0
    v_mov_b64 v[134:135], 0
    s_waitcnt lgkmcnt(5)
    v_mfma_f32_32x32x16_bf16 v[96:111], v[64:67], v[32:35], v[136:151]
    s_waitcnt lgkmcnt(4)
    v_mfma_f32_32x32x16_bf16 v[96:111], v[68:71], v[36:39], v[96:111]
    s_mov_b32 s45, 0
    s_waitcnt lgkmcnt(0)
    s_nop 7
A2_loop:
    v_mfma_f32_32x32x16_bf16 v[112:127], v[64:67], v[40:43], v[152:167]
    ds_read_b128 v[80:83], v24 offset:1024
    ds_read_b32 v84, v25 offset:128
    v_exp_f32 v96, v96
    v_exp_f32 v97, v97
    v_exp_f32 v98, v98
    v_exp_f32 v99, v99
    v_mfma_f32_32x32x16_bf16 v[112:127], v[68:71], v[44:47], v[112:127]
    v_cvt_pk_bf16_f32 v128, v96, v97
    v_cvt_pk_bf16_f32 v129, v98, v99
    v_exp_f32 v100, v100
    v_exp_f32 v101, v101
    v_exp_f32 v102, v102
    v_exp_f32 v103, v103
    v_mfma_f32_32x32x16_bf16 a[48:63], v[92:95], v[132:135], a[48:63]
    ds_read_b128 v[88:91], v26 offset:1280
    ds_read_b128 v[92:95], v26 offset:1920
    v_cvt_pk_bf16_f32 v130, v100, v101
    v_cvt_pk_bf16_f32 v131, v102, v103
    v_exp_f32 v104, v104
    v_exp_f32 v105, v105
    v_exp_f32 v106, v106
    v_exp_f32 v107, v107
    v_mfma_f32_32x32x16_bf16 a[0:15], v[72:75], v[128:131], a[0:15]
    v_cvt_pk_bf16_f32 v132, v104, v105
    v_cvt_pk_bf16_f32 v133, v106, v107
    v_exp_f32 v108, v108
    v_exp_f32 v109, v109
    v_exp_f32 v110, v110
    v_exp_f32 v111, v111
    v_cvt_pk_bf16_f32 v134, v108, v109
    v_cvt_pk_bf16_f32 v135, v110, v111
    v_mfma_f32_32x32x16_bf16 v[96:111], v[64:67], v[48:51], v[168:183]
    v_exp_f32 v112, v112
    v_exp_f32 v113, v113
    v_exp_f32 v114, v114
    v_exp_f32 v115, v115
    v_mfma_f32_32x32x16_bf16 v[96:111], v[68:71], v[52:55], v[96:111]
    v_cvt_pk_bf16_f32 v128, v112, v113
    v_cvt_pk_bf16_f32 v129, v114, v115
    v_exp_f32 v116, v116
    v_exp_f32 v117, v117
    v_exp_f32 v118, v118
    v_exp_f32 v119, v119
    v_mfma_f32_32x32x16_bf16 a[0:15], v[76:79], v[132:135], a[0:15]
    v_cvt_pk_bf16_f32 v130, v116, v117
    v_cvt_pk_bf16_f32 v131, v118, v119
    v_exp_f32 v120, v120
    v_exp_f32 v121, v121
    v_exp_f32 v122, v122
    v_exp_f32 v123, v123
    v_mfma_f32_32x32x16_bf16 a[16:31], v[72:75], v[128:131], a[16:31]
    v_cvt_pk_bf16_f32 v132, v120, v121
    v_cvt_pk_bf16_f32 v133, v122, v123
    v_exp_f32 v124, v124
    v_exp_f32 v125, v125
    v_exp_f32 v126, v126
    v_exp_f32 v127, v127
    v_cvt_pk_bf16_f32 v134, v124, v125
    v_cvt_pk_bf16_f32 v135, v126, v127
    v_mfma_f32_32x32x16_bf16 v[112:127], v[64:67], v[56:59], v[184:199]
    v_exp_f32 v96, v96
    v_exp_f32 v97, v97
    v_exp_f32 v98, v98
    v_exp_f32 v99, v99
    v_mfma_f32_32x32x16_bf16 v[112:127], v[68:71], v[60:63], v[112:127]
    v_cvt_pk_bf16_f32 v128, v96, v97
    v_cvt_pk_bf16_f32 v129, v98, v99
    v_exp_f32 v100, v100
    v_exp_f32 v101, v101
    v_exp_f32 v102, v102
    v_exp_f32 v103, v103
    v_mfma_f32_32x32x16_bf16 a[16:31], v[76:79], v[132:135], a[16:31]
    v_cvt_pk_bf16_f32 v130, v100, v101
    v_cvt_pk_bf16_f32 v131, v102, v103
    v_exp_f32 v104, v104
    v_exp_f32 v105, v105
    v_exp_f32 v106, v106
    v_exp_f32 v107, v107
    v_mfma_f32_32x32x16_bf16 a[32:47], v[72:75], v[128:131], a[32:47]
    v_cvt_pk_bf16_f32 v132, v104, v105
    v_cvt_pk_bf16_f32 v133, v106, v107
    v_exp_f32 v108, v108
    v_exp_f32 v109, v109
    v_exp_f32 v110, v110
    v_exp_f32 v111, v111
    v_cvt_pk_bf16_f32 v134, v108, v109
    v_cvt_pk_bf16_f32 v135, v110, v111
    s_waitcnt lgkmcnt(0)
    v_mfma_f32_32x32x16_bf16 v[96:111], v[80:83], v[32:35], v[136:151]
    v_exp_f32 v112, v112
    v_exp_f32 v113, v113
    v_exp_f32 v114, v114
    v_exp_f32 v115, v115
    v_mfma_f32_32x32x16_bf16 v[96:111], v[84:87], v[36:39], v[96:111]
    v_cvt_pk_bf16_f32 v128, v112, v113
    v_cvt_pk_bf16_f32 v129, v114, v115
    v_exp_f32 v116, v116
    v_exp_f32 v117, v117
    v_exp_f32 v118, v118
    v_exp_f32 v119, v119
    v_mfma_f32_32x32x16_bf16 a[32:47], v[76:79], v[132:135], a[32:47]
    v_cvt_pk_bf16_f32 v130, v116, v117
    v_cvt_pk_bf16_f32 v131, v118, v119
    v_exp_f32 v120, v120
    v_exp_f32 v121, v121
    v_exp_f32 v122, v122
    v_exp_f32 v123, v123
    v_mfma_f32_32x32x16_bf16 a[48:63], v[72:75], v[128:131], a[48:63]
    v_cvt_pk_bf16_f32 v132, v120, v121
    v_cvt_pk_bf16_f32 v133, v122, v123
    v_exp_f32 v124, v124
    v_exp_f32 v125, v125
    v_exp_f32 v126, v126
    v_exp_f32 v127, v127
    v_cvt_pk_bf16_f32 v134, v124, v125
    v_cvt_pk_bf16_f32 v135, v126, v127
    v_mfma_f32_32x32x16_bf16 v[112:127], v[80:83], v[40:43], v[152:167]
    ds_read_b128 v[64:67], v24 offset:2048
    ds_read_b32 v68, v25 offset:256
    v_exp_f32 v96, v96
    v_exp_f32 v97, v97
    v_exp_f32 v98, v98
    v_exp_f32 v99, v99
    v_mfma_f32_32x32x16_bf16 v[112:127], v[84:87], v[44:47], v[112:127]
    v_cvt_pk_bf16_f32 v128, v96, v97
    v_cvt_pk_bf16_f32 v129, v98, v99
    v_exp_f32 v100, v100
    v_exp_f32 v101, v101
    v_exp_f32 v102, v102
    v_exp_f32 v103, v103
    v_mfma_f32_32x32x16_bf16 a[48:63], v[76:79], v[132:135], a[48:63]
    ds_read_b128 v[72:75], v26 offset:2560
    ds_read_b128 v[76:79], v26 offset:3200
    v_cvt_pk_bf16_f32 v130, v100, v101
    v_cvt_pk_bf16_f32 v131, v102, v103
    v_exp_f32 v104, v104
    v_exp_f32 v105, v105
    v_exp_f32 v106, v106
    v_exp_f32 v107, v107
    v_mfma_f32_32x32x16_bf16 a[0:15], v[88:91], v[128:131], a[0:15]
    v_cvt_pk_bf16_f32 v132, v104, v105
    v_cvt_pk_bf16_f32 v133, v106, v107
    v_exp_f32 v108, v108
    v_exp_f32 v109, v109
    v_exp_f32 v110, v110
    v_exp_f32 v111, v111
    v_cvt_pk_bf16_f32 v134, v108, v109
    v_cvt_pk_bf16_f32 v135, v110, v111
    v_mfma_f32_32x32x16_bf16 v[96:111], v[80:83], v[48:51], v[168:183]
    v_exp_f32 v112, v112
    v_exp_f32 v113, v113
    v_exp_f32 v114, v114
    v_exp_f32 v115, v115
    v_mfma_f32_32x32x16_bf16 v[96:111], v[84:87], v[52:55], v[96:111]
    v_cvt_pk_bf16_f32 v128, v112, v113
    v_cvt_pk_bf16_f32 v129, v114, v115
    v_exp_f32 v116, v116
    v_exp_f32 v117, v117
    v_exp_f32 v118, v118
    v_exp_f32 v119, v119
    v_mfma_f32_32x32x16_bf16 a[0:15], v[92:95], v[132:135], a[0:15]
    v_cvt_pk_bf16_f32 v130, v116, v117
    v_cvt_pk_bf16_f32 v131, v118, v119
    v_exp_f32 v120, v120
    v_exp_f32 v121, v121
    v_exp_f32 v122, v122
    v_exp_f32 v123, v123
    v_mfma_f32_32x32x16_bf16 a[16:31], v[88:91], v[128:131], a[16:31]
    v_cvt_pk_bf16_f32 v132, v120, v121
    v_cvt_pk_bf16_f32 v133, v122, v123
    v_exp_f32 v124, v124
    v_exp_f32 v125, v125
    v_exp_f32 v126, v126
    v_exp_f32 v127, v127
    v_cvt_pk_bf16_f32 v134, v124, v125
    v_cvt_pk_bf16_f32 v135, v126, v127
    v_mfma_f32_32x32x16_bf16 v[112:127], v[80:83], v[56:59], v[184:199]
    v_exp_f32 v96, v96
    v_exp_f32 v97, v97
    v_exp_f32 v98, v98
    v_exp_f32 v99, v99
    v_mfma_f32_32x32x16_bf16 v[112:127], v[84:87], v[60:63], v[112:127]
    v_cvt_pk_bf16_f32 v128, v96, v97
    v_cvt_pk_bf16_f32 v129, v98, v99
    v_exp_f32 v100, v100
    v_exp_f32 v101, v101
    v_exp_f32 v102, v102
    v_exp_f32 v103, v103
    v_mfma_f32_32x32x16_bf16 a[16:31], v[92:95], v[132:135], a[16:31]
    v_cvt_pk_bf16_f32 v130, v100, v101
    v_cvt_pk_bf16_f32 v131, v102, v103
    v_exp_f32 v104, v104
    v_exp_f32 v105, v105
    v_exp_f32 v106, v106
    v_exp_f32 v107, v107
    v_mfma_f32_32x32x16_bf16 a[32:47], v[88:91], v[128:131], a[32:47]
    v_cvt_pk_bf16_f32 v132, v104, v105
    v_cvt_pk_bf16_f32 v133, v106, v107
    v_exp_f32 v108, v108
    v_exp_f32 v109, v109
    v_exp_f32 v110, v110
    v_exp_f32 v111, v111
    v_cvt_pk_bf16_f32 v134, v108, v109
    v_cvt_pk_bf16_f32 v135, v110, v111
    s_waitcnt lgkmcnt(0)
    v_mfma_f32_32x32x16_bf16 v[96:111], v[64:67], v[32:35], v[136:151]
    v_exp_f32 v112, v112
    v_exp_f32 v113, v113
    v_exp_f32 v114, v114
    v_exp_f32 v115, v115
    v_mfma_f32_32x32x16_bf16 v[96:111], v[68:71], v[36:39], v[96:111]
    v_cvt_pk_bf16_f32 v128, v112, v113
    v_cvt_pk_bf16_f32 v129, v114, v115
    v_exp_f32 v116, v116
    v_exp_f32 v117, v117
    v_exp_f32 v118, v118
    v_exp_f32 v119, v119
    v_mfma_f32_32x32x16_bf16 a[32:47], v[92:95], v[132:135], a[32:47]
    v_cvt_pk_bf16_f32 v130, v116, v117
    v_cvt_pk_bf16_f32 v131, v118, v119
    v_exp_f32 v120, v120
    v_exp_f32 v121, v121
    v_exp_f32 v122, v122
    v_exp_f32 v123, v123
    v_mfma_f32_32x32x16_bf16 a[48:63], v[88:91], v[128:131], a[48:63]
    v_cvt_pk_bf16_f32 v132, v120, v121
    v_cvt_pk_bf16_f32 v133, v122, v123
    v_exp_f32 v124, v124
    v_exp_f32 v125, v125
    v_exp_f32 v126, v126
    v_exp_f32 v127, v127
    v_add_u32 v24, 2048, v24
    v_add_u32 v25, 256, v25
    v_add_u32 v26, 2560, v26
    s_add_u32 s45, s45, 1
    s_cmp_lt_u32 s45, 32
    v_cvt_pk_bf16_f32 v134, v124, v125
    v_cvt_pk_bf16_f32 v135, v126, v127
    s_cbranch_scc1 A2_loop
    s_nop 0
    v_mfma_f32_32x32x16_bf16 a[48:63], v[92:95], v[132:135], a[48:63]
    s_waitcnt lgkmcnt(0)
    v_accvgpr_read_b32 v100, a10
    v_accvgpr_read_b32 v101, a10
    s_nop 1
    v_permlane32_swap_b32 v100, v101
    v_rcp_f32 v101, v100
    v_accvgpr_read_b32 v102, a26
    v_accvgpr_read_b32 v103, a26
    s_nop 1
    v_permlane32_swap_b32 v102, v103
    v_rcp_f32 v103, v102
    v_accvgpr_read_b32 v104, a42
    v_accvgpr_read_b32 v105, a42
    s_nop 1
    v_permlane32_swap_b32 v104, v105
    v_rcp_f32 v105, v104
    v_accvgpr_read_b32 v106, a58
    v_accvgpr_read_b32 v107, a58
    s_nop 1
    v_permlane32_swap_b32 v106, v107
    v_rcp_f32 v107, v106
    v_max3_f32 v108, v100, v101, v102
    v_max3_f32 v109, v103, v104, v105
    v_max3_f32 v108, v108, v106, v107
    v_add_f32 v110, v100, v102
    v_add_f32 v111, v104, v106
    v_add_f32 v110, v110, v111
    v_max_f32 v108, v108, v109
    v_cmp_nlt_f32 vcc, v108, s42
    v_cmp_u_f32 s[50:51], v110, v110
    s_nop 0
    s_or_b64 vcc, vcc, s[50:51]
    s_cmp_lg_u32 s46, 0
    s_nop 1
    s_cbranch_scc1 A2_store
    s_cbranch_vccz A2_store
    s_mov_b32 s32, 73728
    v_mov_b32 v24, v1
    v_and_b32 v10, 31, v0
    v_lshlrev_b32 v25, 2, v10
    v_add_u32 v25, 65536, v25
    v_min_u32 v10, 19, v10
    v_lshlrev_b32 v10, 4, v10
    v_lshrrev_b32 v11, 5, v0
    v_mul_u32_u24 v11, 320, v11
    v_add3_u32 v26, v10, v11, s32
    v_mov_b32 v200, 0xff800000
    v_mov_b32 v201, 0xff800000
    v_mov_b32 v202, 0xff800000
    v_mov_b32 v203, 0xff800000
    s_mov_b32 s45, 0
A2_mx:
    ds_read_b128 v[64:67], v24 offset:0
    ds_read_b32 v68, v25 offset:0
    s_waitcnt lgkmcnt(1)
    v_mfma_f32_32x32x16_bf16 v[96:111], v[64:67], v[32:35], v[136:151]
    s_waitcnt lgkmcnt(0)
    v_mfma_f32_32x32x16_bf16 v[96:111], v[68:71], v[36:39], v[96:111]
    s_nop 11
    v_max3_f32 v200, v200, v96, v97
    v_max3_f32 v200, v200, v98, v99
    v_max3_f32 v200, v200, v100, v101
    v_max3_f32 v200, v200, v102, v103
    v_max3_f32 v200, v200, v104, v105
    v_max3_f32 v200, v200, v106, v107
    v_max3_f32 v200, v200, v108, v109
    v_max3_f32 v200, v200, v110, v111
    v_mfma_f32_32x32x16_bf16 v[112:127], v[64:67], v[40:43], v[152:167]
    v_mfma_f32_32x32x16_bf16 v[112:127], v[68:71], v[44:47], v[112:127]
    s_nop 11
    v_max3_f32 v201, v201, v112, v113
    v_max3_f32 v201, v201, v114, v115
    v_max3_f32 v201, v201, v116, v117
    v_max3_f32 v201, v201, v118, v119
    v_max3_f32 v201, v201, v120, v121
    v_max3_f32 v201, v201, v122, v123
    v_max3_f32 v201, v201, v124, v125
    v_max3_f32 v201, v201, v126, v127
    v_mfma_f32_32x32x16_bf16 v[96:111], v[64:67], v[48:51], v[168:183]
    v_mfma_f32_32x32x16_bf16 v[96:111], v[68:71], v[52:55], v[96:111]
    s_nop 11
    v_max3_f32 v202, v202, v96, v97
    v_max3_f32 v202, v202, v98, v99
    v_max3_f32 v202, v202, v100, v101
    v_max3_f32 v202, v202, v102, v103
    v_max3_f32 v202, v202, v104, v105
    v_max3_f32 v202, v202, v106, v107
    v_max3_f32 v202, v202, v108, v109
    v_max3_f32 v202, v202, v110, v111
    v_mfma_f32_32x32x16_bf16 v[112:127], v[64:67], v[56:59], v[184:199]
    v_mfma_f32_32x32x16_bf16 v[112:127], v[68:71], v[60:63], v[112:127]
    s_nop 11
    v_max3_f32 v203, v203, v112, v113
    v_max3_f32 v203, v203, v114, v115
    v_max3_f32 v203, v203, v116, v117
    v_max3_f32 v203, v203, v118, v119
    v_max3_f32 v203, v203, v120, v121
    v_max3_f32 v203, v203, v122, v123
    v_max3_f32 v203, v203, v124, v125
    v_max3_f32 v203, v203, v126, v127
    v_add_u32 v24, 1024, v24
    v_add_u32 v25, 128, v25
    s_add_u32 s45, s45, 1
    s_cmp_lt_u32 s45, 64
    s_cbranch_scc1 A2_mx
    v_mov_b32 v204, v200
    s_nop 1
    v_permlane32_swap_b32 v200, v204
    v_max_f32 v204, v204, v200
    v_sub_f32 v204, 0, v204
    v_mov_b32 v136, v204
    v_mov_b32 v137, v204
    v_mov_b32 v138, v204
    v_mov_b32 v139, v204
    v_mov_b32 v140, v204
    v_mov_b32 v141, v204
    v_mov_b32 v142, v204
    v_mov_b32 v143, v204
    v_mov_b32 v144, v204
    v_mov_b32 v145, v204
    v_mov_b32 v146, v204
    v_mov_b32 v147, v204
    v_mov_b32 v148, v204
    v_mov_b32 v149, v204
    v_mov_b32 v150, v204
    v_mov_b32 v151, v204
    v_mov_b32 v204, v201
    s_nop 1
    v_permlane32_swap_b32 v201, v204
    v_max_f32 v204, v204, v201
    v_sub_f32 v204, 0, v204
    v_mov_b32 v152, v204
    v_mov_b32 v153, v204
    v_mov_b32 v154, v204
    v_mov_b32 v155, v204
    v_mov_b32 v156, v204
    v_mov_b32 v157, v204
    v_mov_b32 v158, v204
    v_mov_b32 v159, v204
    v_mov_b32 v160, v204
    v_mov_b32 v161, v204
    v_mov_b32 v162, v204
    v_mov_b32 v163, v204
    v_mov_b32 v164, v204
    v_mov_b32 v165, v204
    v_mov_b32 v166, v204
    v_mov_b32 v167, v204
    v_mov_b32 v204, v202
    s_nop 1
    v_permlane32_swap_b32 v202, v204
    v_max_f32 v204, v204, v202
    v_sub_f32 v204, 0, v204
    v_mov_b32 v168, v204
    v_mov_b32 v169, v204
    v_mov_b32 v170, v204
    v_mov_b32 v171, v204
    v_mov_b32 v172, v204
    v_mov_b32 v173, v204
    v_mov_b32 v174, v204
    v_mov_b32 v175, v204
    v_mov_b32 v176, v204
    v_mov_b32 v177, v204
    v_mov_b32 v178, v204
    v_mov_b32 v179, v204
    v_mov_b32 v180, v204
    v_mov_b32 v181, v204
    v_mov_b32 v182, v204
    v_mov_b32 v183, v204
    v_mov_b32 v204, v203
    s_nop 1
    v_permlane32_swap_b32 v203, v204
    v_max_f32 v204, v204, v203
    v_sub_f32 v204, 0, v204
    v_mov_b32 v184, v204
    v_mov_b32 v185, v204
    v_mov_b32 v186, v204
    v_mov_b32 v187, v204
    v_mov_b32 v188, v204
    v_mov_b32 v189, v204
    v_mov_b32 v190, v204
    v_mov_b32 v191, v204
    v_mov_b32 v192, v204
    v_mov_b32 v193, v204
    v_mov_b32 v194, v204
    v_mov_b32 v195, v204
    v_mov_b32 v196, v204
    v_mov_b32 v197, v204
    v_mov_b32 v198, v204
    v_mov_b32 v199, v204
    s_mov_b32 s46, 1
    s_nop 0
    s_branch A2_pass
A2_store:
    v_and_b32 v10, 31, v0
    v_mul_u32_u24 v10, 1152, v10
    v_lshrrev_b32 v11, 5, v0
    v_lshl_add_u32 v12, v11, 3, v10
    s_mul_i32 s33, s47, 1152
    s_add_u32 s33, s33, s36
    s_add_u32 s33, s33, 83886080
    v_accvgpr_read_b32 v136, a0
    v_accvgpr_read_b32 v137, a1
    v_accvgpr_read_b32 v138, a2
    v_accvgpr_read_b32 v139, a3
    v_accvgpr_read_b32 v140, a4
    v_accvgpr_read_b32 v141, a5
    v_accvgpr_read_b32 v142, a6
    v_accvgpr_read_b32 v143, a7
    v_accvgpr_read_b32 v144, a8
    v_accvgpr_read_b32 v145, a9
    v_mul_f32 v136, v136, v101
    v_mul_f32 v137, v137, v101
    v_mul_f32 v138, v138, v101
    v_mul_f32 v139, v139, v101
    v_mul_f32 v140, v140, v101
    v_mul_f32 v141, v141, v101
    v_mul_f32 v142, v142, v101
    v_mul_f32 v143, v143, v101
    v_mul_f32 v144, v144, v101
    v_mul_f32 v145, v145, v101
    v_cvt_pk_bf16_f32 v146, v136, v137
    v_cvt_pk_bf16_f32 v147, v138, v139
    v_cvt_pk_bf16_f32 v148, v140, v141
    v_cvt_pk_bf16_f32 v149, v142, v143
    v_cvt_pk_bf16_f32 v150, v144, v145
    s_add_u32 s32, s33, 0
    buffer_store_dwordx2 v[146:147], v12, s[24:27], s32 offen sc1
    buffer_store_dwordx2 v[148:149], v12, s[24:27], s32 offen offset:16 sc1
    s_mov_b32 exec_hi, 0
    buffer_store_dword v150, v12, s[24:27], s32 offen offset:32 sc1
    s_mov_b64 exec, -1
    v_accvgpr_read_b32 v152, a16
    v_accvgpr_read_b32 v153, a17
    v_accvgpr_read_b32 v154, a18
    v_accvgpr_read_b32 v155, a19
    v_accvgpr_read_b32 v156, a20
    v_accvgpr_read_b32 v157, a21
    v_accvgpr_read_b32 v158, a22
    v_accvgpr_read_b32 v159, a23
    v_accvgpr_read_b32 v160, a24
    v_accvgpr_read_b32 v161, a25
    v_mul_f32 v152, v152, v103
    v_mul_f32 v153, v153, v103
    v_mul_f32 v154, v154, v103
    v_mul_f32 v155, v155, v103
    v_mul_f32 v156, v156, v103
    v_mul_f32 v157, v157, v103
    v_mul_f32 v158, v158, v103
    v_mul_f32 v159, v159, v103
    v_mul_f32 v160, v160, v103
    v_mul_f32 v161, v161, v103
    v_cvt_pk_bf16_f32 v162, v152, v153
    v_cvt_pk_bf16_f32 v163, v154, v155
    v_cvt_pk_bf16_f32 v164, v156, v157
    v_cvt_pk_bf16_f32 v165, v158, v159
    v_cvt_pk_bf16_f32 v166, v160, v161
    s_add_u32 s32, s33, 36864
    buffer_store_dwordx2 v[162:163], v12, s[24:27], s32 offen sc1
    buffer_store_dwordx2 v[164:165], v12, s[24:27], s32 offen offset:16 sc1
    s_mov_b32 exec_hi, 0
    buffer_store_dword v166, v12, s[24:27], s32 offen offset:32 sc1
    s_mov_b64 exec, -1
    v_accvgpr_read_b32 v168, a32
    v_accvgpr_read_b32 v169, a33
    v_accvgpr_read_b32 v170, a34
    v_accvgpr_read_b32 v171, a35
    v_accvgpr_read_b32 v172, a36
    v_accvgpr_read_b32 v173, a37
    v_accvgpr_read_b32 v174, a38
    v_accvgpr_read_b32 v175, a39
    v_accvgpr_read_b32 v176, a40
    v_accvgpr_read_b32 v177, a41
    v_mul_f32 v168, v168, v105
    v_mul_f32 v169, v169, v105
    v_mul_f32 v170, v170, v105
    v_mul_f32 v171, v171, v105
    v_mul_f32 v172, v172, v105
    v_mul_f32 v173, v173, v105
    v_mul_f32 v174, v174, v105
    v_mul_f32 v175, v175, v105
    v_mul_f32 v176, v176, v105
    v_mul_f32 v177, v177, v105
    v_cvt_pk_bf16_f32 v178, v168, v169
    v_cvt_pk_bf16_f32 v179, v170, v171
    v_cvt_pk_bf16_f32 v180, v172, v173
    v_cvt_pk_bf16_f32 v181, v174, v175
    v_cvt_pk_bf16_f32 v182, v176, v177
    s_add_u32 s32, s33, 73728
    buffer_store_dwordx2 v[178:179], v12, s[24:27], s32 offen sc1
    buffer_store_dwordx2 v[180:181], v12, s[24:27], s32 offen offset:16 sc1
    s_mov_b32 exec_hi, 0
    buffer_store_dword v182, v12, s[24:27], s32 offen offset:32 sc1
    s_mov_b64 exec, -1
    v_accvgpr_read_b32 v184, a48
    v_accvgpr_read_b32 v185, a49
    v_accvgpr_read_b32 v186, a50
    v_accvgpr_read_b32 v187, a51
    v_accvgpr_read_b32 v188, a52
    v_accvgpr_read_b32 v189, a53
    v_accvgpr_read_b32 v190, a54
    v_accvgpr_read_b32 v191, a55
    v_accvgpr_read_b32 v192, a56
    v_accvgpr_read_b32 v193, a57
    v_mul_f32 v184, v184, v107
    v_mul_f32 v185, v185, v107
    v_mul_f32 v186, v186, v107
    v_mul_f32 v187, v187, v107
    v_mul_f32 v188, v188, v107
    v_mul_f32 v189, v189, v107
    v_mul_f32 v190, v190, v107
    v_mul_f32 v191, v191, v107
    v_mul_f32 v192, v192, v107
    v_mul_f32 v193, v193, v107
    v_cvt_pk_bf16_f32 v194, v184, v185
    v_cvt_pk_bf16_f32 v195, v186, v187
    v_cvt_pk_bf16_f32 v196, v188, v189
    v_cvt_pk_bf16_f32 v197, v190, v191
    v_cvt_pk_bf16_f32 v198, v192, v193
    s_add_u32 s32, s33, 110592
    buffer_store_dwordx2 v[194:195], v12, s[24:27], s32 offen sc1
    buffer_store_dwordx2 v[196:197], v12, s[24:27], s32 offen offset:16 sc1
    s_mov_b32 exec_hi, 0
    buffer_store_dword v198, v12, s[24:27], s32 offen offset:32 sc1
    s_mov_b64 exec, -1
    s_waitcnt vmcnt(0)
    s_barrier
    s_cmp_lg_u32 s4, 0
    s_cbranch_scc1 A2_sg
    s_lshl_b32 s32, s3, 2
    s_add_u32 s32, s32, 51910656
    v_mov_b32 v11, 1
    s_mov_b64 exec, 1
    buffer_store_dword v11, v1, s[24:27], s32 offen sc1
    s_mov_b64 exec, -1
A2_sg:
    s_waitcnt vmcnt(0)
    s_barrier
    s_cmp_ge_u32 s3, 125
    s_cbranch_scc1 A3_skip
    s_mul_i32 s33, s3, 2622
    s_lshr_b32 s33, s33, 16
    s_mul_i32 s32, s33, 25
    s_sub_u32 s47, s3, s32
    s_lshl_b32 s38, s33, 2
    s_add_u32 s38, s38, s4
    s_min_u32 s38, s38, 17
    v_and_b32 v10, 15, v0
    v_mul_u32_u24 v10, 2304, v10
    v_lshrrev_b32 v11, 4, v0
    v_lshl_add_u32 v56, v11, 3, v10
    v_bfe_u32 v10, v0, 2, 2
    v_bfe_u32 v11, v0, 4, 1
    v_lshl_add_u32 v10, v11, 3, v10
    v_lshrrev_b32 v11, 5, v0
    v_lshl_add_u32 v10, v11, 2, v10
    v_mul_u32_u24 v10, 1152, v10
    v_bfe_u32 v11, v0, 4, 1
    v_lshlrev_b32 v11, 1, v11
    v_xor_b32 v11, v11, v0
    v_and_b32 v11, 3, v11
    v_lshl_add_u32 v4, v11, 4, v10
    s_mul_i32 s35, s4, 24576
    v_add_u32 v2, s35, v7
    v_xor_b32 v3, 32, v2
    s_lshl_b32 s36, s38, 6
    s_mov_b32 s37, s47
    s_mov_b32 s39, 110592
    s_add_u32 s45, s47, 25
    s_mov_b32 s46, 0
    s_add_u32 m0, s35, 0
    s_add_u32 s32, s36, 0
    buffer_load_dwordx4 v4, s[16:19], s32 offen lds
    s_add_u32 m0, s35, 1024
    s_add_u32 s32, s36, 18432
    buffer_load_dwordx4 v4, s[16:19], s32 offen lds
    s_add_u32 m0, s35, 2048
    s_add_u32 s32, s36, 36864
    buffer_load_dwordx4 v4, s[16:19], s32 offen lds
    s_add_u32 m0, s35, 3072
    s_add_u32 s32, s36, 55296
    buffer_load_dwordx4 v4, s[16:19], s32 offen lds
    s_add_u32 m0, s35, 4096
    s_add_u32 s32, s36, 73728
    buffer_load_dwordx4 v4, s[16:19], s32 offen lds
    s_add_u32 m0, s35, 5120
    s_add_u32 s32, s36, 92160
    buffer_load_dwordx4 v4, s[16:19], s32 offen lds
    s_add_u32 m0, s35, 6144
    s_add_u32 s32, s36, 110592
    buffer_load_dwordx4 v4, s[16:19], s32 offen lds
    s_add_u32 m0, s35, 7168
    s_add_u32 s32, s36, 129024
    buffer_load_dwordx4 v4, s[16:19], s32 offen lds
    s_add_u32 m0, s35, 8192
    s_add_u32 s32, s36, 147456
    buffer_load_dwordx4 v4, s[16:19], s32 offen lds
    s_add_u32 m0, s35, 9216
    s_add_u32 s32, s36, 165888
    buffer_load_dwordx4 v4, s[16:19], s32 offen lds
    s_add_u32 m0, s35, 10240
    s_add_u32 s32, s36, 184320
    buffer_load_dwordx4 v4, s[16:19], s32 offen lds
    s_add_u32 m0, s35, 11264
    s_add_u32 s32, s36, 202752
    buffer_load_dwordx4 v4, s[16:19], s32 offen lds
    s_add_u32 m0, s35, 12288
    s_add_u32 s32, s36, 221184
    buffer_load_dwordx4 v4, s[16:19], s32 offen lds
    s_add_u32 m0, s35, 13312
    s_add_u32 s32, s36, 239616
    buffer_load_dwordx4 v4, s[16:19], s32 offen lds
    s_add_u32 m0, s35, 14336
    s_add_u32 s32, s36, 258048
    buffer_load_dwordx4 v4, s[16:19], s32 offen lds
    s_add_u32 m0, s35, 15360
    s_add_u32 s32, s36, 276480
    buffer_load_dwordx4 v4, s[16:19], s32 offen lds
    s_add_u32 m0, s35, 16384
    s_add_u32 s32, s36, 294912
    buffer_load_dwordx4 v4, s[16:19], s32 offen lds
    s_add_u32 m0, s35, 17408
    s_add_u32 s32, s36, 313344
    buffer_load_dwordx4 v4, s[16:19], s32 offen lds
    s_add_u32 m0, s35, 18432
    s_add_u32 s32, s36, 331776
    buffer_load_dwordx4 v4, s[16:19], s32 offen lds
    s_add_u32 m0, s35, 19456
    s_add_u32 s32, s36, 350208
    buffer_load_dwordx4 v4, s[16:19], s32 offen lds
    s_add_u32 m0, s35, 20480
    s_add_u32 s32, s36, 368640
    buffer_load_dwordx4 v4, s[16:19], s32 offen lds
    s_add_u32 m0, s35, 21504
    s_add_u32 s32, s36, 387072
    buffer_load_dwordx4 v4, s[16:19], s32 offen lds
    s_add_u32 m0, s35, 22528
    s_add_u32 s32, s36, 405504
    buffer_load_dwordx4 v4, s[16:19], s32 offen lds
    s_add_u32 m0, s35, 23552
    s_add_u32 s32, s36, 423936
    buffer_load_dwordx4 v4, s[16:19], s32 offen lds
    s_waitcnt vmcnt(16)
    ds_read_b64_tr_b16 a[0:1], v2 offset:0
    ds_read_b64_tr_b16 a[2:3], v2 offset:512
    ds_read_b64_tr_b16 a[72:73], v3 offset:0
    ds_read_b64_tr_b16 a[74:75], v3 offset:512
    ds_read_b64_tr_b16 a[4:5], v2 offset:2048
    ds_read_b64_tr_b16 a[6:7], v2 offset:2560
    ds_read_b64_tr_b16 a[76:77], v3 offset:2048
    ds_read_b64_tr_b16 a[78:79], v3 offset:2560
    ds_read_b64_tr_b16 a[8:9], v2 offset:4096
    ds_read_b64_tr_b16 a[10:11], v2 offset:4608
    ds_read_b64_tr_b16 a[80:81], v3 offset:4096
    ds_read_b64_tr_b16 a[82:83], v3 offset:4608
    ds_read_b64_tr_b16 a[12:13], v2 offset:6144
    ds_read_b64_tr_b16 a[14:15], v2 offset:6656
    ds_read_b64_tr_b16 a[84:85], v3 offset:6144
    ds_read_b64_tr_b16 a[86:87], v3 offset:6656
    s_waitcnt lgkmcnt(0)
    s_add_u32 m0, s35, 0
    s_add_u32 s32, s36, 442368
    buffer_load_dwordx4 v4, s[16:19], s32 offen lds
    s_add_u32 m0, s35, 1024
    s_add_u32 s32, s36, 460800
    buffer_load_dwordx4 v4, s[16:19], s32 offen lds
    s_add_u32 m0, s35, 2048
    s_add_u32 s32, s36, 479232
    buffer_load_dwordx4 v4, s[16:19], s32 offen lds
    s_add_u32 m0, s35, 3072
    s_add_u32 s32, s36, 497664
    buffer_load_dwordx4 v4, s[16:19], s32 offen lds
    s_add_u32 m0, s35, 4096
    s_add_u32 s32, s36, 516096
    buffer_load_dwordx4 v4, s[16:19], s32 offen lds
    s_add_u32 m0, s35, 5120
    s_add_u32 s32, s36, 534528
    buffer_load_dwordx4 v4, s[16:19], s32 offen lds
    s_add_u32 m0, s35, 6144
    s_add_u32 s32, s36, 552960
    buffer_load_dwordx4 v4, s[16:19], s32 offen lds
    s_add_u32 m0, s35, 7168
    s_add_u32 s32, s36, 571392
    buffer_load_dwordx4 v4, s[16:19], s32 offen lds
    s_waitcnt vmcnt(16)
    ds_read_b64_tr_b16 a[16:17], v2 offset:8192
    ds_read_b64_tr_b16 a[18:19], v2 offset:8704
    ds_read_b64_tr_b16 a[88:89], v3 offset:8192
    ds_read_b64_tr_b16 a[90:91], v3 offset:8704
    ds_read_b64_tr_b16 a[20:21], v2 offset:10240
    ds_read_b64_tr_b16 a[22:23], v2 offset:10752
    ds_read_b64_tr_b16 a[92:93], v3 offset:10240
    ds_read_b64_tr_b16 a[94:95], v3 offset:10752
    ds_read_b64_tr_b16 a[24:25], v2 offset:12288
    ds_read_b64_tr_b16 a[26:27], v2 offset:12800
    ds_read_b64_tr_b16 a[96:97], v3 offset:12288
    ds_read_b64_tr_b16 a[98:99], v3 offset:12800
    ds_read_b64_tr_b16 a[28:29], v2 offset:14336
    ds_read_b64_tr_b16 a[30:31], v2 offset:14848
    ds_read_b64_tr_b16 a[100:101], v3 offset:14336
    ds_read_b64_tr_b16 a[102:103], v3 offset:14848
    s_waitcnt lgkmcnt(0)
    s_add_u32 m0, s35, 8192
    s_add_u32 s32, s36, 589824
    buffer_load_dwordx4 v4, s[16:19], s32 offen lds
    s_add_u32 m0, s35, 9216
    s_add_u32 s32, s36, 608256
    buffer_load_dwordx4 v4, s[16:19], s32 offen lds
    s_add_u32 m0, s35, 10240
    s_add_u32 s32, s36, 626688
    buffer_load_dwordx4 v4, s[16:19], s32 offen lds
    s_add_u32 m0, s35, 11264
    s_add_u32 s32, s36, 645120
    buffer_load_dwordx4 v4, s[16:19], s32 offen lds
    s_waitcnt vmcnt(12)
    ds_read_b64_tr_b16 a[32:33], v2 offset:16384
    ds_read_b64_tr_b16 a[34:35], v2 offset:16896
    ds_read_b64_tr_b16 a[104:105], v3 offset:16384
    ds_read_b64_tr_b16 a[106:107], v3 offset:16896
    ds_read_b64_tr_b16 a[36:37], v2 offset:18432
    ds_read_b64_tr_b16 a[38:39], v2 offset:18944
    ds_read_b64_tr_b16 a[108:109], v3 offset:18432
    ds_read_b64_tr_b16 a[110:111], v3 offset:18944
    ds_read_b64_tr_b16 a[40:41], v2 offset:20480
    ds_read_b64_tr_b16 a[42:43], v2 offset:20992
    ds_read_b64_tr_b16 a[112:113], v3 offset:20480
    ds_read_b64_tr_b16 a[114:115], v3 offset:20992
    ds_read_b64_tr_b16 a[44:45], v2 offset:22528
    ds_read_b64_tr_b16 a[46:47], v2 offset:23040
    ds_read_b64_tr_b16 a[116:117], v3 offset:22528
    ds_read_b64_tr_b16 a[118:119], v3 offset:23040
    s_waitcnt lgkmcnt(0)
    s_waitcnt vmcnt(4)
    ds_read_b64_tr_b16 a[48:49], v2 offset:0
    ds_read_b64_tr_b16 a[50:51], v2 offset:512
    ds_read_b64_tr_b16 a[120:121], v3 offset:0
    ds_read_b64_tr_b16 a[122:123], v3 offset:512
    ds_read_b64_tr_b16 a[52:53], v2 offset:2048
    ds_read_b64_tr_b16 a[54:55], v2 offset:2560
    ds_read_b64_tr_b16 a[124:125], v3 offset:2048
    ds_read_b64_tr_b16 a[126:127], v3 offset:2560
    ds_read_b64_tr_b16 a[56:57], v2 offset:4096
    ds_read_b64_tr_b16 a[58:59], v2 offset:4608
    ds_read_b64_tr_b16 a[128:129], v3 offset:4096
    ds_read_b64_tr_b16 a[130:131], v3 offset:4608
    ds_read_b64_tr_b16 a[60:61], v2 offset:6144
    ds_read_b64_tr_b16 a[62:63], v2 offset:6656
    ds_read_b64_tr_b16 a[132:133], v3 offset:6144
    ds_read_b64_tr_b16 a[134:135], v3 offset:6656
    s_waitcnt lgkmcnt(0)
    s_waitcnt vmcnt(0)
    ds_read_b64_tr_b16 a[64:65], v2 offset:8192
    ds_read_b64_tr_b16 a[66:67], v2 offset:8704
    ds_read_b64_tr_b16 a[136:137], v3 offset:8192
    ds_read_b64_tr_b16 a[138:139], v3 offset:8704
    ds_read_b64_tr_b16 a[68:69], v2 offset:10240
    ds_read_b64_tr_b16 a[70:71], v2 offset:10752
    ds_read_b64_tr_b16 a[140:141], v3 offset:10240
    ds_read_b64_tr_b16 a[142:143], v3 offset:10752
    s_waitcnt lgkmcnt(0)
    s_mov_b32 s33, 51910656
    s_cmp_lg_u32 s4, 0
    s_cbranch_scc1 A3_w_d
    v_lshrrev_b32 v10, 1, v1
    v_min_u32 v10, 504, v10
    s_mov_b32 s44, 0
A3_w:
    buffer_load_dwordx2 v[20:21], v10, s[24:27], s33 offen sc1
    s_add_u32 s44, s44, 1
    s_waitcnt vmcnt(0)
    v_and_b32 v20, v20, v21
    v_cmp_ne_u32 vcc, 1, v20
    s_cmp_gt_u32 s44, 400000
    s_nop 3
    s_cbranch_scc1 A3_w_d
    s_cbranch_vccz A3_w_d
    s_sleep 8
    s_branch A3_w
A3_w_d:
    s_barrier
    s_min_u32 s33, s37, 63
    s_mul_i32 s33, s33, 36864
    s_add_u32 s33, s33, s40
    s_add_u32 s33, s33, 83886080
    s_add_u32 s34, s39, s41
    s_add_u32 m0, s34, 0
    s_add_u32 s32, s33, 0
    buffer_load_dwordx4 v5, s[24:27], s32 offen sc1 lds
    s_add_u32 m0, s34, 1024
    s_add_u32 s32, s33, 64
    buffer_load_dwordx4 v5, s[24:27], s32 offen sc1 lds
    s_add_u32 m0, s34, 2048
    s_add_u32 s32, s33, 128
    buffer_load_dwordx4 v5, s[24:27], s32 offen sc1 lds
    s_add_u32 m0, s34, 3072
    s_add_u32 s32, s33, 192
    buffer_load_dwordx4 v5, s[24:27], s32 offen sc1 lds
    s_add_u32 m0, s34, 4096
    s_add_u32 s32, s33, 256
    buffer_load_dwordx4 v5, s[24:27], s32 offen sc1 lds
    s_add_u32 m0, s34, 5120
    s_add_u32 s32, s33, 320
    buffer_load_dwordx4 v5, s[24:27], s32 offen sc1 lds
    s_add_u32 m0, s34, 6144
    s_add_u32 s32, s33, 384
    buffer_load_dwordx4 v5, s[24:27], s32 offen sc1 lds
    s_add_u32 m0, s34, 7168
    s_add_u32 s32, s33, 448
    buffer_load_dwordx4 v5, s[24:27], s32 offen sc1 lds
    s_add_u32 m0, s34, 8192
    s_add_u32 s32, s33, 512
    buffer_load_dwordx4 v5, s[24:27], s32 offen sc1 lds
    s_barrier
    s_min_u32 s33, s45, 63
    s_mul_i32 s33, s33, 36864
    s_add_u32 s33, s33, s40
    s_add_u32 s33, s33, 83886080
    s_add_u32 s34, s46, s41
    s_add_u32 m0, s34, 0
    s_add_u32 s32, s33, 0
    buffer_load_dwordx4 v5, s[24:27], s32 offen sc1 lds
    s_add_u32 m0, s34, 1024
    s_add_u32 s32, s33, 64
    buffer_load_dwordx4 v5, s[24:27], s32 offen sc1 lds
    s_add_u32 m0, s34, 2048
    s_add_u32 s32, s33, 128
    buffer_load_dwordx4 v5, s[24:27], s32 offen sc1 lds
    s_add_u32 m0, s34, 3072
    s_add_u32 s32, s33, 192
    buffer_load_dwordx4 v5, s[24:27], s32 offen sc1 lds
    s_add_u32 m0, s34, 4096
    s_add_u32 s32, s33, 256
    buffer_load_dwordx4 v5, s[24:27], s32 offen sc1 lds
    s_add_u32 m0, s34, 5120
    s_add_u32 s32, s33, 320
    buffer_load_dwordx4 v5, s[24:27], s32 offen sc1 lds
    s_add_u32 m0, s34, 6144
    s_add_u32 s32, s33, 384
    buffer_load_dwordx4 v5, s[24:27], s32 offen sc1 lds
    s_add_u32 m0, s34, 7168
    s_add_u32 s32, s33, 448
    buffer_load_dwordx4 v5, s[24:27], s32 offen sc1 lds
    s_add_u32 m0, s34, 8192
    s_add_u32 s32, s33, 512
    buffer_load_dwordx4 v5, s[24:27], s32 offen sc1 lds
    s_waitcnt vmcnt(9)
A3_loop:
    s_barrier
    s_add_u32 s45, s45, 25
    s_add_u32 s46, s46, 36864
    s_cmp_eq_u32 s46, 147456
    s_cselect_b32 s46, 0, s46
    s_min_u32 s33, s45, 63
    s_mul_i32 s33, s33, 36864
    s_add_u32 s33, s33, s40
    s_add_u32 s33, s33, 83886080
    s_add_u32 s34, s46, s41
    s_add_u32 m0, s34, 0
    s_add_u32 s32, s33, 0
    buffer_load_dwordx4 v5, s[24:27], s32 offen sc1 lds
    s_add_u32 m0, s34, 1024
    s_add_u32 s32, s33, 64
    buffer_load_dwordx4 v5, s[24:27], s32 offen sc1 lds
    s_add_u32 m0, s34, 2048
    s_add_u32 s32, s33, 128
    buffer_load_dwordx4 v5, s[24:27], s32 offen sc1 lds
    s_add_u32 m0, s34, 3072
    s_add_u32 s32, s33, 192
    buffer_load_dwordx4 v5, s[24:27], s32 offen sc1 lds
    s_add_u32 m0, s34, 4096
    s_add_u32 s32, s33, 256
    buffer_load_dwordx4 v5, s[24:27], s32 offen sc1 lds
    s_add_u32 m0, s34, 5120
    s_add_u32 s32, s33, 320
    buffer_load_dwordx4 v5, s[24:27], s32 offen sc1 lds
    s_add_u32 m0, s34, 6144
    s_add_u32 s32, s33, 384
    buffer_load_dwordx4 v5, s[24:27], s32 offen sc1 lds
    s_add_u32 m0, s34, 7168
    s_add_u32 s32, s33, 448
    buffer_load_dwordx4 v5, s[24:27], s32 offen sc1 lds
    s_add_u32 m0, s34, 8192
    s_add_u32 s32, s33, 512
    buffer_load_dwordx4 v5, s[24:27], s32 offen sc1 lds
    v_add_u32 v6, s39, v1
    ds_read_b128 v[8:11], v6 offset:0
    ds_read_b128 v[12:15], v6 offset:18432
    ds_read_b128 v[16:19], v6 offset:1024
    ds_read_b128 v[20:23], v6 offset:19456
    s_waitcnt lgkmcnt(3)
    v_mfma_f32_16x16x32_bf16 v[24:27], a[0:3], v[8:11], 0
    s_waitcnt lgkmcnt(2)
    v_mfma_f32_16x16x32_bf16 v[28:31], a[0:3], v[12:15], 0
    v_mfma_f32_16x16x32_bf16 v[32:35], a[72:75], v[8:11], 0
    v_mfma_f32_16x16x32_bf16 v[36:39], a[72:75], v[12:15], 0
    s_waitcnt lgkmcnt(1)
    ds_read_b128 v[8:11], v6 offset:2048
    ds_read_b128 v[12:15], v6 offset:20480
    v_mfma_f32_16x16x32_bf16 v[24:27], a[4:7], v[16:19], v[24:27]
    s_waitcnt lgkmcnt(2)
    v_mfma_f32_16x16x32_bf16 v[28:31], a[4:7], v[20:23], v[28:31]
    v_mfma_f32_16x16x32_bf16 v[32:35], a[76:79], v[16:19], v[32:35]
    v_mfma_f32_16x16x32_bf16 v[36:39], a[76:79], v[20:23], v[36:39]
    s_waitcnt lgkmcnt(1)
    ds_read_b128 v[16:19], v6 offset:3072
    ds_read_b128 v[20:23], v6 offset:21504
    v_mfma_f32_16x16x32_bf16 v[24:27], a[8:11], v[8:11], v[24:27]
    s_waitcnt lgkmcnt(2)
    v_mfma_f32_16x16x32_bf16 v[28:31], a[8:11], v[12:15], v[28:31]
    v_mfma_f32_16x16x32_bf16 v[32:35], a[80:83], v[8:11], v[32:35]
    v_mfma_f32_16x16x32_bf16 v[36:39], a[80:83], v[12:15], v[36:39]
    s_waitcnt lgkmcnt(1)
    ds_read_b128 v[8:11], v6 offset:4096
    ds_read_b128 v[12:15], v6 offset:22528
    v_mfma_f32_16x16x32_bf16 v[24:27], a[12:15], v[16:19], v[24:27]
    s_waitcnt lgkmcnt(2)
    v_mfma_f32_16x16x32_bf16 v[28:31], a[12:15], v[20:23], v[28:31]
    v_mfma_f32_16x16x32_bf16 v[32:35], a[84:87], v[16:19], v[32:35]
    v_mfma_f32_16x16x32_bf16 v[36:39], a[84:87], v[20:23], v[36:39]
    s_waitcnt lgkmcnt(1)
    ds_read_b128 v[16:19], v6 offset:5120
    ds_read_b128 v[20:23], v6 offset:23552
    v_mfma_f32_16x16x32_bf16 v[24:27], a[16:19], v[8:11], v[24:27]
    s_waitcnt lgkmcnt(2)
    v_mfma_f32_16x16x32_bf16 v[28:31], a[16:19], v[12:15], v[28:31]
    v_mfma_f32_16x16x32_bf16 v[32:35], a[88:91], v[8:11], v[32:35]
    v_mfma_f32_16x16x32_bf16 v[36:39], a[88:91], v[12:15], v[36:39]
    s_waitcnt lgkmcnt(1)
    ds_read_b128 v[8:11], v6 offset:6144
    ds_read_b128 v[12:15], v6 offset:24576
    v_mfma_f32_16x16x32_bf16 v[24:27], a[20:23], v[16:19], v[24:27]
    s_waitcnt lgkmcnt(2)
    v_mfma_f32_16x16x32_bf16 v[28:31], a[20:23], v[20:23], v[28:31]
    v_mfma_f32_16x16x32_bf16 v[32:35], a[92:95], v[16:19], v[32:35]
    v_mfma_f32_16x16x32_bf16 v[36:39], a[92:95], v[20:23], v[36:39]
    s_waitcnt lgkmcnt(1)
    ds_read_b128 v[16:19], v6 offset:7168
    ds_read_b128 v[20:23], v6 offset:25600
    v_mfma_f32_16x16x32_bf16 v[24:27], a[24:27], v[8:11], v[24:27]
    s_waitcnt lgkmcnt(2)
    v_mfma_f32_16x16x32_bf16 v[28:31], a[24:27], v[12:15], v[28:31]
    v_mfma_f32_16x16x32_bf16 v[32:35], a[96:99], v[8:11], v[32:35]
    v_mfma_f32_16x16x32_bf16 v[36:39], a[96:99], v[12:15], v[36:39]
    s_waitcnt lgkmcnt(1)
    ds_read_b128 v[8:11], v6 offset:8192
    ds_read_b128 v[12:15], v6 offset:26624
    v_mfma_f32_16x16x32_bf16 v[24:27], a[28:31], v[16:19], v[24:27]
    s_waitcnt lgkmcnt(2)
    v_mfma_f32_16x16x32_bf16 v[28:31], a[28:31], v[20:23], v[28:31]
    v_mfma_f32_16x16x32_bf16 v[32:35], a[100:103], v[16:19], v[32:35]
    v_mfma_f32_16x16x32_bf16 v[36:39], a[100:103], v[20:23], v[36:39]
    s_waitcnt lgkmcnt(1)
    ds_read_b128 v[16:19], v6 offset:9216
    ds_read_b128 v[20:23], v6 offset:27648
    v_mfma_f32_16x16x32_bf16 v[24:27], a[32:35], v[8:11], v[24:27]
    s_waitcnt lgkmcnt(2)
    v_mfma_f32_16x16x32_bf16 v[28:31], a[32:35], v[12:15], v[28:31]
    v_mfma_f32_16x16x32_bf16 v[32:35], a[104:107], v[8:11], v[32:35]
    v_mfma_f32_16x16x32_bf16 v[36:39], a[104:107], v[12:15], v[36:39]
    s_waitcnt lgkmcnt(1)
    ds_read_b128 v[8:11], v6 offset:10240
    ds_read_b128 v[12:15], v6 offset:28672
    v_mfma_f32_16x16x32_bf16 v[24:27], a[36:39], v[16:19], v[24:27]
    s_waitcnt lgkmcnt(2)
    v_mfma_f32_16x16x32_bf16 v[28:31], a[36:39], v[20:23], v[28:31]
    v_mfma_f32_16x16x32_bf16 v[32:35], a[108:111], v[16:19], v[32:35]
    v_mfma_f32_16x16x32_bf16 v[36:39], a[108:111], v[20:23], v[36:39]
    s_waitcnt lgkmcnt(1)
    ds_read_b128 v[16:19], v6 offset:11264
    ds_read_b128 v[20:23], v6 offset:29696
    v_mfma_f32_16x16x32_bf16 v[24:27], a[40:43], v[8:11], v[24:27]
    s_waitcnt lgkmcnt(2)
    v_mfma_f32_16x16x32_bf16 v[28:31], a[40:43], v[12:15], v[28:31]
    v_mfma_f32_16x16x32_bf16 v[32:35], a[112:115], v[8:11], v[32:35]
    v_mfma_f32_16x16x32_bf16 v[36:39], a[112:115], v[12:15], v[36:39]
    s_waitcnt lgkmcnt(1)
    ds_read_b128 v[8:11], v6 offset:12288
    ds_read_b128 v[12:15], v6 offset:30720
    v_mfma_f32_16x16x32_bf16 v[24:27], a[44:47], v[16:19], v[24:27]
    s_waitcnt lgkmcnt(2)
    v_mfma_f32_16x16x32_bf16 v[28:31], a[44:47], v[20:23], v[28:31]
    v_mfma_f32_16x16x32_bf16 v[32:35], a[116:119], v[16:19], v[32:35]
    v_mfma_f32_16x16x32_bf16 v[36:39], a[116:119], v[20:23], v[36:39]
    s_waitcnt lgkmcnt(1)
    ds_read_b128 v[16:19], v6 offset:13312
    ds_read_b128 v[20:23], v6 offset:31744
    v_mfma_f32_16x16x32_bf16 v[24:27], a[48:51], v[8:11], v[24:27]
    s_waitcnt lgkmcnt(2)
    v_mfma_f32_16x16x32_bf16 v[28:31], a[48:51], v[12:15], v[28:31]
    v_mfma_f32_16x16x32_bf16 v[32:35], a[120:123], v[8:11], v[32:35]
    v_mfma_f32_16x16x32_bf16 v[36:39], a[120:123], v[12:15], v[36:39]
    s_waitcnt lgkmcnt(1)
    ds_read_b128 v[8:11], v6 offset:14336
    ds_read_b128 v[12:15], v6 offset:32768
    v_mfma_f32_16x16x32_bf16 v[24:27], a[52:55], v[16:19], v[24:27]
    s_waitcnt lgkmcnt(2)
    v_mfma_f32_16x16x32_bf16 v[28:31], a[52:55], v[20:23], v[28:31]
    v_mfma_f32_16x16x32_bf16 v[32:35], a[124:127], v[16:19], v[32:35]
    v_mfma_f32_16x16x32_bf16 v[36:39], a[124:127], v[20:23], v[36:39]
    s_waitcnt lgkmcnt(1)
    ds_read_b128 v[16:19], v6 offset:15360
    ds_read_b128 v[20:23], v6 offset:33792
    v_mfma_f32_16x16x32_bf16 v[24:27], a[56:59], v[8:11], v[24:27]
    s_waitcnt lgkmcnt(2)
    v_mfma_f32_16x16x32_bf16 v[28:31], a[56:59], v[12:15], v[28:31]
    v_mfma_f32_16x16x32_bf16 v[32:35], a[128:131], v[8:11], v[32:35]
    v_mfma_f32_16x16x32_bf16 v[36:39], a[128:131], v[12:15], v[36:39]
    s_waitcnt lgkmcnt(1)
    ds_read_b128 v[8:11], v6 offset:16384
    ds_read_b128 v[12:15], v6 offset:34816
    v_mfma_f32_16x16x32_bf16 v[24:27], a[60:63], v[16:19], v[24:27]
    s_waitcnt lgkmcnt(2)
    v_mfma_f32_16x16x32_bf16 v[28:31], a[60:63], v[20:23], v[28:31]
    v_mfma_f32_16x16x32_bf16 v[32:35], a[132:135], v[16:19], v[32:35]
    v_mfma_f32_16x16x32_bf16 v[36:39], a[132:135], v[20:23], v[36:39]
    s_waitcnt lgkmcnt(1)
    ds_read_b128 v[16:19], v6 offset:17408
    ds_read_b128 v[20:23], v6 offset:35840
    v_mfma_f32_16x16x32_bf16 v[24:27], a[64:67], v[8:11], v[24:27]
    s_waitcnt lgkmcnt(2)
    v_mfma_f32_16x16x32_bf16 v[28:31], a[64:67], v[12:15], v[28:31]
    v_mfma_f32_16x16x32_bf16 v[32:35], a[136:139], v[8:11], v[32:35]
    v_mfma_f32_16x16x32_bf16 v[36:39], a[136:139], v[12:15], v[36:39]
    s_waitcnt lgkmcnt(1)
    v_mfma_f32_16x16x32_bf16 v[24:27], a[68:71], v[16:19], v[24:27]
    s_waitcnt lgkmcnt(0)
    v_mfma_f32_16x16x32_bf16 v[28:31], a[68:71], v[20:23], v[28:31]
    v_mfma_f32_16x16x32_bf16 v[32:35], a[140:143], v[16:19], v[32:35]
    v_mfma_f32_16x16x32_bf16 v[36:39], a[140:143], v[20:23], v[36:39]
    s_waitcnt vmcnt(9)
    s_mul_i32 s43, s37, 73728
    s_add_u32 s43, s43, s36
    s_add_u32 s32, s43, 36864
    v_cvt_pk_bf16_f32 v58, v24, v25
    v_cvt_pk_bf16_f32 v59, v26, v27
    buffer_store_dwordx2 v[58:59], v56, s[76:79], s43 offen offset:0
    v_cvt_pk_bf16_f32 v60, v28, v29
    v_cvt_pk_bf16_f32 v61, v30, v31
    buffer_store_dwordx2 v[60:61], v56, s[76:79], s32 offen offset:0
    v_cvt_pk_bf16_f32 v62, v32, v33
    v_cvt_pk_bf16_f32 v63, v34, v35
    buffer_store_dwordx2 v[62:63], v56, s[76:79], s43 offen offset:32
    v_cvt_pk_bf16_f32 v64, v36, v37
    v_cvt_pk_bf16_f32 v65, v38, v39
    buffer_store_dwordx2 v[64:65], v56, s[76:79], s32 offen offset:32
    s_add_u32 s37, s37, 25
    s_add_u32 s39, s39, 36864
    s_cmp_eq_u32 s39, 147456
    s_cselect_b32 s39, 0, s39
    s_cmp_lt_u32 s37, 64
    s_cbranch_scc1 A3_loop
    s_waitcnt vmcnt(0)
A3_skip:
    s_barrier
    s_cmp_ge_u32 s3, 120
    s_cbranch_scc1 A4_skip
    s_mul_i32 s37, s3, 5462
    s_lshr_b32 s37, s37, 16
    s_mul_i32 s32, s37, 12
    s_sub_u32 s38, s3, s32
    v_bfe_u32 v10, v0, 2, 2
    v_bfe_u32 v11, v0, 4, 1
    v_lshl_add_u32 v10, v11, 2, v10
    v_lshrrev_b32 v11, 5, v0
    v_lshl_add_u32 v10, v11, 4, v10
    v_mul_u32_u24 v10, 1152, v10
    v_bfe_u32 v11, v0, 4, 1
    v_lshlrev_b32 v11, 1, v11
    v_xor_b32 v11, v11, v0
    v_and_b32 v11, 3, v11
    v_lshl_add_u32 v4, v11, 4, v10
    s_mul_i32 s35, s4, 32768
    v_add_u32 v2, s35, v7
    v_xor_b32 v3, 32, v2
    s_mul_i32 s36, s38, 96
    s_mul_i32 s32, s4, 1179648
    s_add_u32 s34, s36, s32
    s_add_u32 m0, s35, 0
    s_add_u32 s32, s34, 0
    buffer_load_dwordx4 v4, s[20:23], s32 offen lds
    s_add_u32 m0, s35, 1024
    s_add_u32 s32, s34, 9216
    buffer_load_dwordx4 v4, s[20:23], s32 offen lds
    s_add_u32 m0, s35, 2048
    s_add_u32 s32, s34, 64
    buffer_load_dwordx4 v4, s[20:23], s32 offen lds
    s_add_u32 m0, s35, 3072
    s_add_u32 s32, s34, 9280
    buffer_load_dwordx4 v4, s[20:23], s32 offen lds
    s_add_u32 m0, s35, 4096
    s_add_u32 s32, s34, 36864
    buffer_load_dwordx4 v4, s[20:23], s32 offen lds
    s_add_u32 m0, s35, 5120
    s_add_u32 s32, s34, 46080
    buffer_load_dwordx4 v4, s[20:23], s32 offen lds
    s_add_u32 m0, s35, 6144
    s_add_u32 s32, s34, 36928
    buffer_load_dwordx4 v4, s[20:23], s32 offen lds
    s_add_u32 m0, s35, 7168
    s_add_u32 s32, s34, 46144
    buffer_load_dwordx4 v4, s[20:23], s32 offen lds
    s_add_u32 m0, s35, 8192
    s_add_u32 s32, s34, 73728
    buffer_load_dwordx4 v4, s[20:23], s32 offen lds
    s_add_u32 m0, s35, 9216
    s_add_u32 s32, s34, 82944
    buffer_load_dwordx4 v4, s[20:23], s32 offen lds
    s_add_u32 m0, s35, 10240
    s_add_u32 s32, s34, 73792
    buffer_load_dwordx4 v4, s[20:23], s32 offen lds
    s_add_u32 m0, s35, 11264
    s_add_u32 s32, s34, 83008
    buffer_load_dwordx4 v4, s[20:23], s32 offen lds
    s_add_u32 m0, s35, 12288
    s_add_u32 s32, s34, 110592
    buffer_load_dwordx4 v4, s[20:23], s32 offen lds
    s_add_u32 m0, s35, 13312
    s_add_u32 s32, s34, 119808
    buffer_load_dwordx4 v4, s[20:23], s32 offen lds
    s_add_u32 m0, s35, 14336
    s_add_u32 s32, s34, 110656
    buffer_load_dwordx4 v4, s[20:23], s32 offen lds
    s_add_u32 m0, s35, 15360
    s_add_u32 s32, s34, 119872
    buffer_load_dwordx4 v4, s[20:23], s32 offen lds
    s_add_u32 m0, s35, 16384
    s_add_u32 s32, s34, 147456
    buffer_load_dwordx4 v4, s[20:23], s32 offen lds
    s_add_u32 m0, s35, 17408
    s_add_u32 s32, s34, 156672
    buffer_load_dwordx4 v4, s[20:23], s32 offen lds
    s_add_u32 m0, s35, 18432
    s_add_u32 s32, s34, 147520
    buffer_load_dwordx4 v4, s[20:23], s32 offen lds
    s_add_u32 m0, s35, 19456
    s_add_u32 s32, s34, 156736
    buffer_load_dwordx4 v4, s[20:23], s32 offen lds
    s_add_u32 m0, s35, 20480
    s_add_u32 s32, s34, 184320
    buffer_load_dwordx4 v4, s[20:23], s32 offen lds
    s_add_u32 m0, s35, 21504
    s_add_u32 s32, s34, 193536
    buffer_load_dwordx4 v4, s[20:23], s32 offen lds
    s_add_u32 m0, s35, 22528
    s_add_u32 s32, s34, 184384
    buffer_load_dwordx4 v4, s[20:23], s32 offen lds
    s_add_u32 m0, s35, 23552
    s_add_u32 s32, s34, 193600
    buffer_load_dwordx4 v4, s[20:23], s32 offen lds
    s_add_u32 m0, s35, 24576
    s_add_u32 s32, s34, 221184
    buffer_load_dwordx4 v4, s[20:23], s32 offen lds
    s_add_u32 m0, s35, 25600
    s_add_u32 s32, s34, 230400
    buffer_load_dwordx4 v4, s[20:23], s32 offen lds
    s_add_u32 m0, s35, 26624
    s_add_u32 s32, s34, 221248
    buffer_load_dwordx4 v4, s[20:23], s32 offen lds
    s_add_u32 m0, s35, 27648
    s_add_u32 s32, s34, 230464
    buffer_load_dwordx4 v4, s[20:23], s32 offen lds
    s_add_u32 m0, s35, 28672
    s_add_u32 s32, s34, 258048
    buffer_load_dwordx4 v4, s[20:23], s32 offen lds
    s_add_u32 m0, s35, 29696
    s_add_u32 s32, s34, 267264
    buffer_load_dwordx4 v4, s[20:23], s32 offen lds
    s_add_u32 m0, s35, 30720
    s_add_u32 s32, s34, 258112
    buffer_load_dwordx4 v4, s[20:23], s32 offen lds
    s_add_u32 m0, s35, 31744
    s_add_u32 s32, s34, 267328
    buffer_load_dwordx4 v4, s[20:23], s32 offen lds
    s_waitcnt vmcnt(24)
    ds_read_b64_tr_b16 a[0:1], v2 offset:0
    ds_read_b64_tr_b16 a[2:3], v2 offset:512
    ds_read_b64_tr_b16 a[128:129], v3 offset:0
    ds_read_b64_tr_b16 a[130:131], v3 offset:512
    ds_read_b64_tr_b16 v[80:81], v2 offset:2048
    ds_read_b64_tr_b16 v[82:83], v2 offset:2560
    ds_read_b64_tr_b16 v[208:209], v3 offset:2048
    ds_read_b64_tr_b16 v[210:211], v3 offset:2560
    ds_read_b64_tr_b16 a[4:5], v2 offset:4096
    ds_read_b64_tr_b16 a[6:7], v2 offset:4608
    ds_read_b64_tr_b16 a[132:133], v3 offset:4096
    ds_read_b64_tr_b16 a[134:135], v3 offset:4608
    ds_read_b64_tr_b16 v[84:85], v2 offset:6144
    ds_read_b64_tr_b16 v[86:87], v2 offset:6656
    s_waitcnt lgkmcnt(7)
    ds_read_b64_tr_b16 v[208:209], v3 offset:6144
    s_waitcnt lgkmcnt(7)
    ds_read_b64_tr_b16 v[210:211], v3 offset:6656
    s_waitcnt lgkmcnt(0)
    s_add_u32 m0, s35, 0
    s_add_u32 s32, s34, 294912
    buffer_load_dwordx4 v4, s[20:23], s32 offen lds
    s_add_u32 m0, s35, 1024
    s_add_u32 s32, s34, 304128
    buffer_load_dwordx4 v4, s[20:23], s32 offen lds
    s_add_u32 m0, s35, 2048
    s_add_u32 s32, s34, 294976
    buffer_load_dwordx4 v4, s[20:23], s32 offen lds
    s_add_u32 m0, s35, 3072
    s_add_u32 s32, s34, 304192
    buffer_load_dwordx4 v4, s[20:23], s32 offen lds
    s_add_u32 m0, s35, 4096
    s_add_u32 s32, s34, 331776
    buffer_load_dwordx4 v4, s[20:23], s32 offen lds
    s_add_u32 m0, s35, 5120
    s_add_u32 s32, s34, 340992
    buffer_load_dwordx4 v4, s[20:23], s32 offen lds
    s_add_u32 m0, s35, 6144
    s_add_u32 s32, s34, 331840
    buffer_load_dwordx4 v4, s[20:23], s32 offen lds
    s_add_u32 m0, s35, 7168
    s_add_u32 s32, s34, 341056
    buffer_load_dwordx4 v4, s[20:23], s32 offen lds
    s_waitcnt vmcnt(24)
    ds_read_b64_tr_b16 a[8:9], v2 offset:8192
    ds_read_b64_tr_b16 a[10:11], v2 offset:8704
    ds_read_b64_tr_b16 a[136:137], v3 offset:8192
    ds_read_b64_tr_b16 a[138:139], v3 offset:8704
    ds_read_b64_tr_b16 v[88:89], v2 offset:10240
    ds_read_b64_tr_b16 v[90:91], v2 offset:10752
    ds_read_b64_tr_b16 v[208:209], v3 offset:10240
    ds_read_b64_tr_b16 v[210:211], v3 offset:10752
    ds_read_b64_tr_b16 a[12:13], v2 offset:12288
    ds_read_b64_tr_b16 a[14:15], v2 offset:12800
    ds_read_b64_tr_b16 a[140:141], v3 offset:12288
    ds_read_b64_tr_b16 a[142:143], v3 offset:12800
    ds_read_b64_tr_b16 v[92:93], v2 offset:14336
    ds_read_b64_tr_b16 v[94:95], v2 offset:14848
    s_waitcnt lgkmcnt(7)
    ds_read_b64_tr_b16 v[208:209], v3 offset:14336
    s_waitcnt lgkmcnt(7)
    ds_read_b64_tr_b16 v[210:211], v3 offset:14848
    s_waitcnt lgkmcnt(0)
    s_add_u32 m0, s35, 8192
    s_add_u32 s32, s34, 368640
    buffer_load_dwordx4 v4, s[20:23], s32 offen lds
    s_add_u32 m0, s35, 9216
    s_add_u32 s32, s34, 377856
    buffer_load_dwordx4 v4, s[20:23], s32 offen lds
    s_add_u32 m0, s35, 10240
    s_add_u32 s32, s34, 368704
    buffer_load_dwordx4 v4, s[20:23], s32 offen lds
    s_add_u32 m0, s35, 11264
    s_add_u32 s32, s34, 377920
    buffer_load_dwordx4 v4, s[20:23], s32 offen lds
    s_add_u32 m0, s35, 12288
    s_add_u32 s32, s34, 405504
    buffer_load_dwordx4 v4, s[20:23], s32 offen lds
    s_add_u32 m0, s35, 13312
    s_add_u32 s32, s34, 414720
    buffer_load_dwordx4 v4, s[20:23], s32 offen lds
    s_add_u32 m0, s35, 14336
    s_add_u32 s32, s34, 405568
    buffer_load_dwordx4 v4, s[20:23], s32 offen lds
    s_add_u32 m0, s35, 15360
    s_add_u32 s32, s34, 414784
    buffer_load_dwordx4 v4, s[20:23], s32 offen lds
    s_waitcnt vmcnt(24)
    ds_read_b64_tr_b16 a[16:17], v2 offset:16384
    ds_read_b64_tr_b16 a[18:19], v2 offset:16896
    ds_read_b64_tr_b16 a[144:145], v3 offset:16384
    ds_read_b64_tr_b16 a[146:147], v3 offset:16896
    ds_read_b64_tr_b16 v[96:97], v2 offset:18432
    ds_read_b64_tr_b16 v[98:99], v2 offset:18944
    ds_read_b64_tr_b16 v[208:209], v3 offset:18432
    ds_read_b64_tr_b16 v[210:211], v3 offset:18944
    ds_read_b64_tr_b16 a[20:21], v2 offset:20480
    ds_read_b64_tr_b16 a[22:23], v2 offset:20992
    ds_read_b64_tr_b16 a[148:149], v3 offset:20480
    ds_read_b64_tr_b16 a[150:151], v3 offset:20992
    ds_read_b64_tr_b16 v[100:101], v2 offset:22528
    ds_read_b64_tr_b16 v[102:103], v2 offset:23040
    s_waitcnt lgkmcnt(7)
    ds_read_b64_tr_b16 v[208:209], v3 offset:22528
    s_waitcnt lgkmcnt(7)
    ds_read_b64_tr_b16 v[210:211], v3 offset:23040
    s_waitcnt lgkmcnt(0)
    s_add_u32 m0, s35, 16384
    s_add_u32 s32, s34, 442368
    buffer_load_dwordx4 v4, s[20:23], s32 offen lds
    s_add_u32 m0, s35, 17408
    s_add_u32 s32, s34, 451584
    buffer_load_dwordx4 v4, s[20:23], s32 offen lds
    s_add_u32 m0, s35, 18432
    s_add_u32 s32, s34, 442432
    buffer_load_dwordx4 v4, s[20:23], s32 offen lds
    s_add_u32 m0, s35, 19456
    s_add_u32 s32, s34, 451648
    buffer_load_dwordx4 v4, s[20:23], s32 offen lds
    s_add_u32 m0, s35, 20480
    s_add_u32 s32, s34, 479232
    buffer_load_dwordx4 v4, s[20:23], s32 offen lds
    s_add_u32 m0, s35, 21504
    s_add_u32 s32, s34, 488448
    buffer_load_dwordx4 v4, s[20:23], s32 offen lds
    s_add_u32 m0, s35, 22528
    s_add_u32 s32, s34, 479296
    buffer_load_dwordx4 v4, s[20:23], s32 offen lds
    s_add_u32 m0, s35, 23552
    s_add_u32 s32, s34, 488512
    buffer_load_dwordx4 v4, s[20:23], s32 offen lds
    s_waitcnt vmcnt(24)
    ds_read_b64_tr_b16 a[24:25], v2 offset:24576
    ds_read_b64_tr_b16 a[26:27], v2 offset:25088
    ds_read_b64_tr_b16 a[152:153], v3 offset:24576
    ds_read_b64_tr_b16 a[154:155], v3 offset:25088
    ds_read_b64_tr_b16 v[104:105], v2 offset:26624
    ds_read_b64_tr_b16 v[106:107], v2 offset:27136
    ds_read_b64_tr_b16 v[208:209], v3 offset:26624
    ds_read_b64_tr_b16 v[210:211], v3 offset:27136
    ds_read_b64_tr_b16 a[28:29], v2 offset:28672
    ds_read_b64_tr_b16 a[30:31], v2 offset:29184
    ds_read_b64_tr_b16 a[156:157], v3 offset:28672
    ds_read_b64_tr_b16 a[158:159], v3 offset:29184
    ds_read_b64_tr_b16 v[108:109], v2 offset:30720
    ds_read_b64_tr_b16 v[110:111], v2 offset:31232
    s_waitcnt lgkmcnt(7)
    ds_read_b64_tr_b16 v[208:209], v3 offset:30720
    s_waitcnt lgkmcnt(7)
    ds_read_b64_tr_b16 v[210:211], v3 offset:31232
    s_waitcnt lgkmcnt(0)
    s_add_u32 m0, s35, 24576
    s_add_u32 s32, s34, 516096
    buffer_load_dwordx4 v4, s[20:23], s32 offen lds
    s_add_u32 m0, s35, 25600
    s_add_u32 s32, s34, 525312
    buffer_load_dwordx4 v4, s[20:23], s32 offen lds
    s_add_u32 m0, s35, 26624
    s_add_u32 s32, s34, 516160
    buffer_load_dwordx4 v4, s[20:23], s32 offen lds
    s_add_u32 m0, s35, 27648
    s_add_u32 s32, s34, 525376
    buffer_load_dwordx4 v4, s[20:23], s32 offen lds
    s_add_u32 m0, s35, 28672
    s_add_u32 s32, s34, 552960
    buffer_load_dwordx4 v4, s[20:23], s32 offen lds
    s_add_u32 m0, s35, 29696
    s_add_u32 s32, s34, 562176
    buffer_load_dwordx4 v4, s[20:23], s32 offen lds
    s_add_u32 m0, s35, 30720
    s_add_u32 s32, s34, 553024
    buffer_load_dwordx4 v4, s[20:23], s32 offen lds
    s_add_u32 m0, s35, 31744
    s_add_u32 s32, s34, 562240
    buffer_load_dwordx4 v4, s[20:23], s32 offen lds
    s_waitcnt vmcnt(24)
    ds_read_b64_tr_b16 a[32:33], v2 offset:0
    ds_read_b64_tr_b16 a[34:35], v2 offset:512
    ds_read_b64_tr_b16 a[160:161], v3 offset:0
    ds_read_b64_tr_b16 a[162:163], v3 offset:512
    ds_read_b64_tr_b16 v[112:113], v2 offset:2048
    ds_read_b64_tr_b16 v[114:115], v2 offset:2560
    ds_read_b64_tr_b16 v[208:209], v3 offset:2048
    ds_read_b64_tr_b16 v[210:211], v3 offset:2560
    ds_read_b64_tr_b16 a[36:37], v2 offset:4096
    ds_read_b64_tr_b16 a[38:39], v2 offset:4608
    ds_read_b64_tr_b16 a[164:165], v3 offset:4096
    ds_read_b64_tr_b16 a[166:167], v3 offset:4608
    ds_read_b64_tr_b16 v[116:117], v2 offset:6144
    ds_read_b64_tr_b16 v[118:119], v2 offset:6656
    s_waitcnt lgkmcnt(7)
    ds_read_b64_tr_b16 v[208:209], v3 offset:6144
    s_waitcnt lgkmcnt(7)
    ds_read_b64_tr_b16 v[210:211], v3 offset:6656
    s_waitcnt lgkmcnt(0)
    s_add_u32 m0, s35, 0
    s_add_u32 s32, s34, 589824
    buffer_load_dwordx4 v4, s[20:23], s32 offen lds
    s_add_u32 m0, s35, 1024
    s_add_u32 s32, s34, 599040
    buffer_load_dwordx4 v4, s[20:23], s32 offen lds
    s_add_u32 m0, s35, 2048
    s_add_u32 s32, s34, 589888
    buffer_load_dwordx4 v4, s[20:23], s32 offen lds
    s_add_u32 m0, s35, 3072
    s_add_u32 s32, s34, 599104
    buffer_load_dwordx4 v4, s[20:23], s32 offen lds
    s_add_u32 m0, s35, 4096
    s_add_u32 s32, s34, 626688
    buffer_load_dwordx4 v4, s[20:23], s32 offen lds
    s_add_u32 m0, s35, 5120
    s_add_u32 s32, s34, 635904
    buffer_load_dwordx4 v4, s[20:23], s32 offen lds
    s_add_u32 m0, s35, 6144
    s_add_u32 s32, s34, 626752
    buffer_load_dwordx4 v4, s[20:23], s32 offen lds
    s_add_u32 m0, s35, 7168
    s_add_u32 s32, s34, 635968
    buffer_load_dwordx4 v4, s[20:23], s32 offen lds
    s_waitcnt vmcnt(24)
    ds_read_b64_tr_b16 a[40:41], v2 offset:8192
    ds_read_b64_tr_b16 a[42:43], v2 offset:8704
    ds_read_b64_tr_b16 a[168:169], v3 offset:8192
    ds_read_b64_tr_b16 a[170:171], v3 offset:8704
    ds_read_b64_tr_b16 v[120:121], v2 offset:10240
    ds_read_b64_tr_b16 v[122:123], v2 offset:10752
    ds_read_b64_tr_b16 v[208:209], v3 offset:10240
    ds_read_b64_tr_b16 v[210:211], v3 offset:10752
    ds_read_b64_tr_b16 a[44:45], v2 offset:12288
    ds_read_b64_tr_b16 a[46:47], v2 offset:12800
    ds_read_b64_tr_b16 a[172:173], v3 offset:12288
    ds_read_b64_tr_b16 a[174:175], v3 offset:12800
    ds_read_b64_tr_b16 v[124:125], v2 offset:14336
    ds_read_b64_tr_b16 v[126:127], v2 offset:14848
    s_waitcnt lgkmcnt(7)
    ds_read_b64_tr_b16 v[208:209], v3 offset:14336
    s_waitcnt lgkmcnt(7)
    ds_read_b64_tr_b16 v[210:211], v3 offset:14848
    s_waitcnt lgkmcnt(0)
    s_add_u32 m0, s35, 8192
    s_add_u32 s32, s34, 663552
    buffer_load_dwordx4 v4, s[20:23], s32 offen lds
    s_add_u32 m0, s35, 9216
    s_add_u32 s32, s34, 672768
    buffer_load_dwordx4 v4, s[20:23], s32 offen lds
    s_add_u32 m0, s35, 10240
    s_add_u32 s32, s34, 663616
    buffer_load_dwordx4 v4, s[20:23], s32 offen lds
    s_add_u32 m0, s35, 11264
    s_add_u32 s32, s34, 672832
    buffer_load_dwordx4 v4, s[20:23], s32 offen lds
    s_add_u32 m0, s35, 12288
    s_add_u32 s32, s34, 700416
    buffer_load_dwordx4 v4, s[20:23], s32 offen lds
    s_add_u32 m0, s35, 13312
    s_add_u32 s32, s34, 709632
    buffer_load_dwordx4 v4, s[20:23], s32 offen lds
    s_add_u32 m0, s35, 14336
    s_add_u32 s32, s34, 700480
    buffer_load_dwordx4 v4, s[20:23], s32 offen lds
    s_add_u32 m0, s35, 15360
    s_add_u32 s32, s34, 709696
    buffer_load_dwordx4 v4, s[20:23], s32 offen lds
    s_waitcnt vmcnt(24)
    ds_read_b64_tr_b16 a[48:49], v2 offset:16384
    ds_read_b64_tr_b16 a[50:51], v2 offset:16896
    ds_read_b64_tr_b16 a[176:177], v3 offset:16384
    ds_read_b64_tr_b16 a[178:179], v3 offset:16896
    ds_read_b64_tr_b16 v[128:129], v2 offset:18432
    ds_read_b64_tr_b16 v[130:131], v2 offset:18944
    ds_read_b64_tr_b16 v[208:209], v3 offset:18432
    ds_read_b64_tr_b16 v[210:211], v3 offset:18944
    ds_read_b64_tr_b16 a[52:53], v2 offset:20480
    ds_read_b64_tr_b16 a[54:55], v2 offset:20992
    ds_read_b64_tr_b16 a[180:181], v3 offset:20480
    ds_read_b64_tr_b16 a[182:183], v3 offset:20992
    ds_read_b64_tr_b16 v[132:133], v2 offset:22528
    ds_read_b64_tr_b16 v[134:135], v2 offset:23040
    s_waitcnt lgkmcnt(7)
    ds_read_b64_tr_b16 v[208:209], v3 offset:22528
    s_waitcnt lgkmcnt(7)
    ds_read_b64_tr_b16 v[210:211], v3 offset:23040
    s_waitcnt lgkmcnt(0)
    s_add_u32 m0, s35, 16384
    s_add_u32 s32, s34, 737280
    buffer_load_dwordx4 v4, s[20:23], s32 offen lds
    s_add_u32 m0, s35, 17408
    s_add_u32 s32, s34, 746496
    buffer_load_dwordx4 v4, s[20:23], s32 offen lds
    s_add_u32 m0, s35, 18432
    s_add_u32 s32, s34, 737344
    buffer_load_dwordx4 v4, s[20:23], s32 offen lds
    s_add_u32 m0, s35, 19456
    s_add_u32 s32, s34, 746560
    buffer_load_dwordx4 v4, s[20:23], s32 offen lds
    s_add_u32 m0, s35, 20480
    s_add_u32 s32, s34, 774144
    buffer_load_dwordx4 v4, s[20:23], s32 offen lds
    s_add_u32 m0, s35, 21504
    s_add_u32 s32, s34, 783360
    buffer_load_dwordx4 v4, s[20:23], s32 offen lds
    s_add_u32 m0, s35, 22528
    s_add_u32 s32, s34, 774208
    buffer_load_dwordx4 v4, s[20:23], s32 offen lds
    s_add_u32 m0, s35, 23552
    s_add_u32 s32, s34, 783424
    buffer_load_dwordx4 v4, s[20:23], s32 offen lds
    s_waitcnt vmcnt(24)
    ds_read_b64_tr_b16 a[56:57], v2 offset:24576
    ds_read_b64_tr_b16 a[58:59], v2 offset:25088
    ds_read_b64_tr_b16 a[184:185], v3 offset:24576
    ds_read_b64_tr_b16 a[186:187], v3 offset:25088
    ds_read_b64_tr_b16 v[136:137], v2 offset:26624
    ds_read_b64_tr_b16 v[138:139], v2 offset:27136
    ds_read_b64_tr_b16 v[208:209], v3 offset:26624
    ds_read_b64_tr_b16 v[210:211], v3 offset:27136
    ds_read_b64_tr_b16 a[60:61], v2 offset:28672
    ds_read_b64_tr_b16 a[62:63], v2 offset:29184
    ds_read_b64_tr_b16 a[188:189], v3 offset:28672
    ds_read_b64_tr_b16 a[190:191], v3 offset:29184
    ds_read_b64_tr_b16 v[140:141], v2 offset:30720
    ds_read_b64_tr_b16 v[142:143], v2 offset:31232
    s_waitcnt lgkmcnt(7)
    ds_read_b64_tr_b16 v[208:209], v3 offset:30720
    s_waitcnt lgkmcnt(7)
    ds_read_b64_tr_b16 v[210:211], v3 offset:31232
    s_waitcnt lgkmcnt(0)
    s_add_u32 m0, s35, 24576
    s_add_u32 s32, s34, 811008
    buffer_load_dwordx4 v4, s[20:23], s32 offen lds
    s_add_u32 m0, s35, 25600
    s_add_u32 s32, s34, 820224
    buffer_load_dwordx4 v4, s[20:23], s32 offen lds
    s_add_u32 m0, s35, 26624
    s_add_u32 s32, s34, 811072
    buffer_load_dwordx4 v4, s[20:23], s32 offen lds
    s_add_u32 m0, s35, 27648
    s_add_u32 s32, s34, 820288
    buffer_load_dwordx4 v4, s[20:23], s32 offen lds
    s_add_u32 m0, s35, 28672
    s_add_u32 s32, s34, 847872
    buffer_load_dwordx4 v4, s[20:23], s32 offen lds
    s_add_u32 m0, s35, 29696
    s_add_u32 s32, s34, 857088
    buffer_load_dwordx4 v4, s[20:23], s32 offen lds
    s_add_u32 m0, s35, 30720
    s_add_u32 s32, s34, 847936
    buffer_load_dwordx4 v4, s[20:23], s32 offen lds
    s_add_u32 m0, s35, 31744
    s_add_u32 s32, s34, 857152
    buffer_load_dwordx4 v4, s[20:23], s32 offen lds
    s_waitcnt vmcnt(24)
    ds_read_b64_tr_b16 a[64:65], v2 offset:0
    ds_read_b64_tr_b16 a[66:67], v2 offset:512
    ds_read_b64_tr_b16 a[192:193], v3 offset:0
    ds_read_b64_tr_b16 a[194:195], v3 offset:512
    ds_read_b64_tr_b16 v[144:145], v2 offset:2048
    ds_read_b64_tr_b16 v[146:147], v2 offset:2560
    ds_read_b64_tr_b16 v[208:209], v3 offset:2048
    ds_read_b64_tr_b16 v[210:211], v3 offset:2560
    ds_read_b64_tr_b16 a[68:69], v2 offset:4096
    ds_read_b64_tr_b16 a[70:71], v2 offset:4608
    ds_read_b64_tr_b16 a[196:197], v3 offset:4096
    ds_read_b64_tr_b16 a[198:199], v3 offset:4608
    ds_read_b64_tr_b16 v[148:149], v2 offset:6144
    ds_read_b64_tr_b16 v[150:151], v2 offset:6656
    s_waitcnt lgkmcnt(7)
    ds_read_b64_tr_b16 v[208:209], v3 offset:6144
    s_waitcnt lgkmcnt(7)
    ds_read_b64_tr_b16 v[210:211], v3 offset:6656
    s_waitcnt lgkmcnt(0)
    s_add_u32 m0, s35, 0
    s_add_u32 s32, s34, 884736
    buffer_load_dwordx4 v4, s[20:23], s32 offen lds
    s_add_u32 m0, s35, 1024
    s_add_u32 s32, s34, 893952
    buffer_load_dwordx4 v4, s[20:23], s32 offen lds
    s_add_u32 m0, s35, 2048
    s_add_u32 s32, s34, 884800
    buffer_load_dwordx4 v4, s[20:23], s32 offen lds
    s_add_u32 m0, s35, 3072
    s_add_u32 s32, s34, 894016
    buffer_load_dwordx4 v4, s[20:23], s32 offen lds
    s_add_u32 m0, s35, 4096
    s_add_u32 s32, s34, 921600
    buffer_load_dwordx4 v4, s[20:23], s32 offen lds
    s_add_u32 m0, s35, 5120
    s_add_u32 s32, s34, 930816
    buffer_load_dwordx4 v4, s[20:23], s32 offen lds
    s_add_u32 m0, s35, 6144
    s_add_u32 s32, s34, 921664
    buffer_load_dwordx4 v4, s[20:23], s32 offen lds
    s_add_u32 m0, s35, 7168
    s_add_u32 s32, s34, 930880
    buffer_load_dwordx4 v4, s[20:23], s32 offen lds
    s_waitcnt vmcnt(24)
    ds_read_b64_tr_b16 a[72:73], v2 offset:8192
    ds_read_b64_tr_b16 a[74:75], v2 offset:8704
    ds_read_b64_tr_b16 a[200:201], v3 offset:8192
    ds_read_b64_tr_b16 a[202:203], v3 offset:8704
    ds_read_b64_tr_b16 v[152:153], v2 offset:10240
    ds_read_b64_tr_b16 v[154:155], v2 offset:10752
    ds_read_b64_tr_b16 v[208:209], v3 offset:10240
    ds_read_b64_tr_b16 v[210:211], v3 offset:10752
    ds_read_b64_tr_b16 a[76:77], v2 offset:12288
    ds_read_b64_tr_b16 a[78:79], v2 offset:12800
    ds_read_b64_tr_b16 a[204:205], v3 offset:12288
    ds_read_b64_tr_b16 a[206:207], v3 offset:12800
    ds_read_b64_tr_b16 v[156:157], v2 offset:14336
    ds_read_b64_tr_b16 v[158:159], v2 offset:14848
    s_waitcnt lgkmcnt(7)
    ds_read_b64_tr_b16 v[208:209], v3 offset:14336
    s_waitcnt lgkmcnt(7)
    ds_read_b64_tr_b16 v[210:211], v3 offset:14848
    s_waitcnt lgkmcnt(0)
    s_add_u32 m0, s35, 8192
    s_add_u32 s32, s34, 958464
    buffer_load_dwordx4 v4, s[20:23], s32 offen lds
    s_add_u32 m0, s35, 9216
    s_add_u32 s32, s34, 967680
    buffer_load_dwordx4 v4, s[20:23], s32 offen lds
    s_add_u32 m0, s35, 10240
    s_add_u32 s32, s34, 958528
    buffer_load_dwordx4 v4, s[20:23], s32 offen lds
    s_add_u32 m0, s35, 11264
    s_add_u32 s32, s34, 967744
    buffer_load_dwordx4 v4, s[20:23], s32 offen lds
    s_add_u32 m0, s35, 12288
    s_add_u32 s32, s34, 995328
    buffer_load_dwordx4 v4, s[20:23], s32 offen lds
    s_add_u32 m0, s35, 13312
    s_add_u32 s32, s34, 1004544
    buffer_load_dwordx4 v4, s[20:23], s32 offen lds
    s_add_u32 m0, s35, 14336
    s_add_u32 s32, s34, 995392
    buffer_load_dwordx4 v4, s[20:23], s32 offen lds
    s_add_u32 m0, s35, 15360
    s_add_u32 s32, s34, 1004608
    buffer_load_dwordx4 v4, s[20:23], s32 offen lds
    s_waitcnt vmcnt(24)
    ds_read_b64_tr_b16 a[80:81], v2 offset:16384
    ds_read_b64_tr_b16 a[82:83], v2 offset:16896
    ds_read_b64_tr_b16 a[208:209], v3 offset:16384
    ds_read_b64_tr_b16 a[210:211], v3 offset:16896
    ds_read_b64_tr_b16 v[160:161], v2 offset:18432
    ds_read_b64_tr_b16 v[162:163], v2 offset:18944
    ds_read_b64_tr_b16 v[208:209], v3 offset:18432
    ds_read_b64_tr_b16 v[210:211], v3 offset:18944
    ds_read_b64_tr_b16 a[84:85], v2 offset:20480
    ds_read_b64_tr_b16 a[86:87], v2 offset:20992
    ds_read_b64_tr_b16 a[212:213], v3 offset:20480
    ds_read_b64_tr_b16 a[214:215], v3 offset:20992
    ds_read_b64_tr_b16 v[164:165], v2 offset:22528
    ds_read_b64_tr_b16 v[166:167], v2 offset:23040
    s_waitcnt lgkmcnt(7)
    ds_read_b64_tr_b16 v[208:209], v3 offset:22528
    s_waitcnt lgkmcnt(7)
    ds_read_b64_tr_b16 v[210:211], v3 offset:23040
    s_waitcnt lgkmcnt(0)
    s_add_u32 m0, s35, 16384
    s_add_u32 s32, s34, 1032192
    buffer_load_dwordx4 v4, s[20:23], s32 offen lds
    s_add_u32 m0, s35, 17408
    s_add_u32 s32, s34, 1041408
    buffer_load_dwordx4 v4, s[20:23], s32 offen lds
    s_add_u32 m0, s35, 18432
    s_add_u32 s32, s34, 1032256
    buffer_load_dwordx4 v4, s[20:23], s32 offen lds
    s_add_u32 m0, s35, 19456
    s_add_u32 s32, s34, 1041472
    buffer_load_dwordx4 v4, s[20:23], s32 offen lds
    s_add_u32 m0, s35, 20480
    s_add_u32 s32, s34, 1069056
    buffer_load_dwordx4 v4, s[20:23], s32 offen lds
    s_add_u32 m0, s35, 21504
    s_add_u32 s32, s34, 1078272
    buffer_load_dwordx4 v4, s[20:23], s32 offen lds
    s_add_u32 m0, s35, 22528
    s_add_u32 s32, s34, 1069120
    buffer_load_dwordx4 v4, s[20:23], s32 offen lds
    s_add_u32 m0, s35, 23552
    s_add_u32 s32, s34, 1078336
    buffer_load_dwordx4 v4, s[20:23], s32 offen lds
    s_waitcnt vmcnt(24)
    ds_read_b64_tr_b16 a[88:89], v2 offset:24576
    ds_read_b64_tr_b16 a[90:91], v2 offset:25088
    ds_read_b64_tr_b16 a[216:217], v3 offset:24576
    ds_read_b64_tr_b16 a[218:219], v3 offset:25088
    ds_read_b64_tr_b16 v[168:169], v2 offset:26624
    ds_read_b64_tr_b16 v[170:171], v2 offset:27136
    ds_read_b64_tr_b16 v[208:209], v3 offset:26624
    ds_read_b64_tr_b16 v[210:211], v3 offset:27136
    ds_read_b64_tr_b16 a[92:93], v2 offset:28672
    ds_read_b64_tr_b16 a[94:95], v2 offset:29184
    ds_read_b64_tr_b16 a[220:221], v3 offset:28672
    ds_read_b64_tr_b16 a[222:223], v3 offset:29184
    ds_read_b64_tr_b16 v[172:173], v2 offset:30720
    ds_read_b64_tr_b16 v[174:175], v2 offset:31232
    s_waitcnt lgkmcnt(7)
    ds_read_b64_tr_b16 v[208:209], v3 offset:30720
    s_waitcnt lgkmcnt(7)
    ds_read_b64_tr_b16 v[210:211], v3 offset:31232
    s_waitcnt lgkmcnt(0)
    s_add_u32 m0, s35, 24576
    s_add_u32 s32, s34, 1105920
    buffer_load_dwordx4 v4, s[20:23], s32 offen lds
    s_add_u32 m0, s35, 25600
    s_add_u32 s32, s34, 1115136
    buffer_load_dwordx4 v4, s[20:23], s32 offen lds
    s_add_u32 m0, s35, 26624
    s_add_u32 s32, s34, 1105984
    buffer_load_dwordx4 v4, s[20:23], s32 offen lds
    s_add_u32 m0, s35, 27648
    s_add_u32 s32, s34, 1115200
    buffer_load_dwordx4 v4, s[20:23], s32 offen lds
    s_add_u32 m0, s35, 28672
    s_add_u32 s32, s34, 1142784
    buffer_load_dwordx4 v4, s[20:23], s32 offen lds
    s_add_u32 m0, s35, 29696
    s_add_u32 s32, s34, 1152000
    buffer_load_dwordx4 v4, s[20:23], s32 offen lds
    s_add_u32 m0, s35, 30720
    s_add_u32 s32, s34, 1142848
    buffer_load_dwordx4 v4, s[20:23], s32 offen lds
    s_add_u32 m0, s35, 31744
    s_add_u32 s32, s34, 1152064
    buffer_load_dwordx4 v4, s[20:23], s32 offen lds
    s_waitcnt vmcnt(24)
    ds_read_b64_tr_b16 a[96:97], v2 offset:0
    ds_read_b64_tr_b16 a[98:99], v2 offset:512
    ds_read_b64_tr_b16 a[224:225], v3 offset:0
    ds_read_b64_tr_b16 a[226:227], v3 offset:512
    ds_read_b64_tr_b16 v[176:177], v2 offset:2048
    ds_read_b64_tr_b16 v[178:179], v2 offset:2560
    ds_read_b64_tr_b16 v[208:209], v3 offset:2048
    ds_read_b64_tr_b16 v[210:211], v3 offset:2560
    ds_read_b64_tr_b16 a[100:101], v2 offset:4096
    ds_read_b64_tr_b16 a[102:103], v2 offset:4608
    ds_read_b64_tr_b16 a[228:229], v3 offset:4096
    ds_read_b64_tr_b16 a[230:231], v3 offset:4608
    ds_read_b64_tr_b16 v[180:181], v2 offset:6144
    ds_read_b64_tr_b16 v[182:183], v2 offset:6656
    s_waitcnt lgkmcnt(7)
    ds_read_b64_tr_b16 v[208:209], v3 offset:6144
    s_waitcnt lgkmcnt(7)
    ds_read_b64_tr_b16 v[210:211], v3 offset:6656
    s_waitcnt lgkmcnt(0)
    s_waitcnt vmcnt(16)
    ds_read_b64_tr_b16 a[104:105], v2 offset:8192
    ds_read_b64_tr_b16 a[106:107], v2 offset:8704
    ds_read_b64_tr_b16 a[232:233], v3 offset:8192
    ds_read_b64_tr_b16 a[234:235], v3 offset:8704
    ds_read_b64_tr_b16 v[184:185], v2 offset:10240
    ds_read_b64_tr_b16 v[186:187], v2 offset:10752
    ds_read_b64_tr_b16 v[208:209], v3 offset:10240
    ds_read_b64_tr_b16 v[210:211], v3 offset:10752
    ds_read_b64_tr_b16 a[108:109], v2 offset:12288
    ds_read_b64_tr_b16 a[110:111], v2 offset:12800
    ds_read_b64_tr_b16 a[236:237], v3 offset:12288
    ds_read_b64_tr_b16 a[238:239], v3 offset:12800
    ds_read_b64_tr_b16 v[188:189], v2 offset:14336
    ds_read_b64_tr_b16 v[190:191], v2 offset:14848
    s_waitcnt lgkmcnt(7)
    ds_read_b64_tr_b16 v[208:209], v3 offset:14336
    s_waitcnt lgkmcnt(7)
    ds_read_b64_tr_b16 v[210:211], v3 offset:14848
    s_waitcnt lgkmcnt(0)
    s_waitcnt vmcnt(8)
    ds_read_b64_tr_b16 a[112:113], v2 offset:16384
    ds_read_b64_tr_b16 a[114:115], v2 offset:16896
    ds_read_b64_tr_b16 a[240:241], v3 offset:16384
    ds_read_b64_tr_b16 a[242:243], v3 offset:16896
    ds_read_b64_tr_b16 v[192:193], v2 offset:18432
    ds_read_b64_tr_b16 v[194:195], v2 offset:18944
    ds_read_b64_tr_b16 v[208:209], v3 offset:18432
    ds_read_b64_tr_b16 v[210:211], v3 offset:18944
    ds_read_b64_tr_b16 a[116:117], v2 offset:20480
    ds_read_b64_tr_b16 a[118:119], v2 offset:20992
    ds_read_b64_tr_b16 a[244:245], v3 offset:20480
    ds_read_b64_tr_b16 a[246:247], v3 offset:20992
    ds_read_b64_tr_b16 v[196:197], v2 offset:22528
    ds_read_b64_tr_b16 v[198:199], v2 offset:23040
    s_waitcnt lgkmcnt(7)
    ds_read_b64_tr_b16 v[208:209], v3 offset:22528
    s_waitcnt lgkmcnt(7)
    ds_read_b64_tr_b16 v[210:211], v3 offset:23040
    s_waitcnt lgkmcnt(0)
    s_waitcnt vmcnt(0)
    ds_read_b64_tr_b16 a[120:121], v2 offset:24576
    ds_read_b64_tr_b16 a[122:123], v2 offset:25088
    ds_read_b64_tr_b16 a[248:249], v3 offset:24576
    ds_read_b64_tr_b16 a[250:251], v3 offset:25088
    ds_read_b64_tr_b16 v[200:201], v2 offset:26624
    ds_read_b64_tr_b16 v[202:203], v2 offset:27136
    ds_read_b64_tr_b16 v[208:209], v3 offset:26624
    ds_read_b64_tr_b16 v[210:211], v3 offset:27136
    ds_read_b64_tr_b16 a[124:125], v2 offset:28672
    ds_read_b64_tr_b16 a[126:127], v2 offset:29184
    ds_read_b64_tr_b16 a[252:253], v3 offset:28672
    ds_read_b64_tr_b16 a[254:255], v3 offset:29184
    ds_read_b64_tr_b16 v[204:205], v2 offset:30720
    ds_read_b64_tr_b16 v[206:207], v2 offset:31232
    s_waitcnt lgkmcnt(7)
    ds_read_b64_tr_b16 v[208:209], v3 offset:30720
    s_waitcnt lgkmcnt(7)
    ds_read_b64_tr_b16 v[210:211], v3 offset:31232
    s_waitcnt lgkmcnt(0)
    s_barrier
    s_mul_i32 s32, s4, 3072
    v_add_u32 v72, s32, v1
    s_lshl_b32 s32, s4, 10
    v_add_u32 v73, s32, v1
    v_and_b32 v10, 15, v0
    v_mul_u32_u24 v10, 2304, v10
    v_lshrrev_b32 v11, 4, v0
    v_lshl_add_u32 v74, v11, 3, v10
A4_loop:
    s_lshr_b32 s33, s37, 2
    s_lshl_b32 s33, s33, 12
    s_and_b32 s34, s37, 3
    s_lshl_b32 s34, s34, 8
    s_add_u32 s33, s33, s34
    s_add_u32 s33, s33, 51905536
    s_cmp_lg_u32 s4, 0
    s_cbranch_scc1 A4_w_d
    v_lshrrev_b32 v10, 1, v1
    v_min_u32 v10, 248, v10
    s_mov_b32 s44, 0
A4_w:
    buffer_load_dwordx2 v[20:21], v10, s[24:27], s33 offen sc1
    s_add_u32 s44, s44, 1
    s_waitcnt vmcnt(0)
    v_and_b32 v20, v20, v21
    v_cmp_ne_u32 vcc, 1, v20
    s_cmp_gt_u32 s44, 400000
    s_nop 3
    s_cbranch_scc1 A4_w_d
    s_cbranch_vccz A4_w_d
    s_sleep 2
    s_branch A4_w
A4_w_d:
    s_barrier
    s_lshl_b32 s32, s37, 17
    s_lshl_b32 s33, s4, 15
    s_add_u32 s32, s32, s33
    s_add_u32 s32, s32, 58720256
    buffer_load_dwordx4 v[8:11], v1, s[24:27], s32 offen offset:0 sc1
    buffer_load_dwordx4 v[12:15], v1, s[24:27], s32 offen offset:1024 sc1
    buffer_load_dwordx4 v[16:19], v1, s[24:27], s32 offen offset:2048 sc1
    buffer_load_dwordx4 v[20:23], v1, s[24:27], s32 offen offset:3072 sc1
    s_add_u32 s32, s32, 4096
    buffer_load_dwordx4 v[24:27], v1, s[24:27], s32 offen offset:0 sc1
    buffer_load_dwordx4 v[28:31], v1, s[24:27], s32 offen offset:1024 sc1
    buffer_load_dwordx4 v[32:35], v1, s[24:27], s32 offen offset:2048 sc1
    buffer_load_dwordx4 v[36:39], v1, s[24:27], s32 offen offset:3072 sc1
    s_add_u32 s32, s32, 4096
    buffer_load_dwordx4 v[40:43], v1, s[24:27], s32 offen offset:0 sc1
    buffer_load_dwordx4 v[44:47], v1, s[24:27], s32 offen offset:1024 sc1
    buffer_load_dwordx4 v[48:51], v1, s[24:27], s32 offen offset:2048 sc1
    buffer_load_dwordx4 v[52:55], v1, s[24:27], s32 offen offset:3072 sc1
    s_add_u32 s32, s32, 4096
    buffer_load_dwordx4 v[56:59], v1, s[24:27], s32 offen offset:0 sc1
    buffer_load_dwordx4 v[208:211], v1, s[24:27], s32 offen offset:1024 sc1
    buffer_load_dwordx4 v[212:215], v1, s[24:27], s32 offen offset:2048 sc1
    buffer_load_dwordx4 v[216:219], v1, s[24:27], s32 offen offset:3072 sc1
    s_add_u32 s32, s32, 4096
    buffer_load_dwordx4 v[220:223], v1, s[24:27], s32 offen offset:0 sc1
    buffer_load_dwordx4 v[224:227], v1, s[24:27], s32 offen offset:1024 sc1
    buffer_load_dwordx4 v[228:231], v1, s[24:27], s32 offen offset:2048 sc1
    buffer_load_dwordx4 v[232:235], v1, s[24:27], s32 offen offset:3072 sc1
    s_add_u32 s32, s32, 4096
    buffer_load_dwordx4 v[236:239], v1, s[24:27], s32 offen offset:0 sc1
    buffer_load_dwordx4 v[240:243], v1, s[24:27], s32 offen offset:1024 sc1
    buffer_load_dwordx4 v[244:247], v1, s[24:27], s32 offen offset:2048 sc1
    buffer_load_dwordx4 v[248:251], v1, s[24:27], s32 offen offset:3072 sc1
    s_waitcnt vmcnt(23)
    v_mfma_f32_16x16x32_bf16 v[60:63], a[0:3], v[8:11], 0
    v_mfma_f32_16x16x32_bf16 v[64:67], a[128:131], v[8:11], 0
    v_mfma_f32_16x16x32_bf16 v[68:71], v[80:83], v[8:11], 0
    s_add_u32 s32, s32, 4096
    buffer_load_dwordx4 v[8:11], v1, s[24:27], s32 offen offset:0 sc1
    s_waitcnt vmcnt(23)
    v_mfma_f32_16x16x32_bf16 v[60:63], a[4:7], v[12:15], v[60:63]
    v_mfma_f32_16x16x32_bf16 v[64:67], a[132:135], v[12:15], v[64:67]
    v_mfma_f32_16x16x32_bf16 v[68:71], v[84:87], v[12:15], v[68:71]
    buffer_load_dwordx4 v[12:15], v1, s[24:27], s32 offen offset:1024 sc1
    s_waitcnt vmcnt(23)
    v_mfma_f32_16x16x32_bf16 v[60:63], a[8:11], v[16:19], v[60:63]
    v_mfma_f32_16x16x32_bf16 v[64:67], a[136:139], v[16:19], v[64:67]
    v_mfma_f32_16x16x32_bf16 v[68:71], v[88:91], v[16:19], v[68:71]
    buffer_load_dwordx4 v[16:19], v1, s[24:27], s32 offen offset:2048 sc1
    s_waitcnt vmcnt(23)
    v_mfma_f32_16x16x32_bf16 v[60:63], a[12:15], v[20:23], v[60:63]
    v_mfma_f32_16x16x32_bf16 v[64:67], a[140:143], v[20:23], v[64:67]
    v_mfma_f32_16x16x32_bf16 v[68:71], v[92:95], v[20:23], v[68:71]
    buffer_load_dwordx4 v[20:23], v1, s[24:27], s32 offen offset:3072 sc1
    s_waitcnt vmcnt(23)
    v_mfma_f32_16x16x32_bf16 v[60:63], a[16:19], v[24:27], v[60:63]
    v_mfma_f32_16x16x32_bf16 v[64:67], a[144:147], v[24:27], v[64:67]
    v_mfma_f32_16x16x32_bf16 v[68:71], v[96:99], v[24:27], v[68:71]
    s_add_u32 s32, s32, 4096
    buffer_load_dwordx4 v[24:27], v1, s[24:27], s32 offen offset:0 sc1
    s_waitcnt vmcnt(23)
    v_mfma_f32_16x16x32_bf16 v[60:63], a[20:23], v[28:31], v[60:63]
    v_mfma_f32_16x16x32_bf16 v[64:67], a[148:151], v[28:31], v[64:67]
    v_mfma_f32_16x16x32_bf16 v[68:71], v[100:103], v[28:31], v[68:71]
    buffer_load_dwordx4 v[28:31], v1, s[24:27], s32 offen offset:1024 sc1
    s_waitcnt vmcnt(23)
    v_mfma_f32_16x16x32_bf16 v[60:63], a[24:27], v[32:35], v[60:63]
    v_mfma_f32_16x16x32_bf16 v[64:67], a[152:155], v[32:35], v[64:67]
    v_mfma_f32_16x16x32_bf16 v[68:71], v[104:107], v[32:35], v[68:71]
    buffer_load_dwordx4 v[32:35], v1, s[24:27], s32 offen offset:2048 sc1
    s_waitcnt vmcnt(23)
    v_mfma_f32_16x16x32_bf16 v[60:63], a[28:31], v[36:39], v[60:63]
    v_mfma_f32_16x16x32_bf16 v[64:67], a[156:159], v[36:39], v[64:67]
    v_mfma_f32_16x16x32_bf16 v[68:71], v[108:111], v[36:39], v[68:71]
    buffer_load_dwordx4 v[36:39], v1, s[24:27], s32 offen offset:3072 sc1
    s_waitcnt vmcnt(23)
    v_mfma_f32_16x16x32_bf16 v[60:63], a[32:35], v[40:43], v[60:63]
    v_mfma_f32_16x16x32_bf16 v[64:67], a[160:163], v[40:43], v[64:67]
    v_mfma_f32_16x16x32_bf16 v[68:71], v[112:115], v[40:43], v[68:71]
    s_waitcnt vmcnt(22)
    v_mfma_f32_16x16x32_bf16 v[60:63], a[36:39], v[44:47], v[60:63]
    v_mfma_f32_16x16x32_bf16 v[64:67], a[164:167], v[44:47], v[64:67]
    v_mfma_f32_16x16x32_bf16 v[68:71], v[116:119], v[44:47], v[68:71]
    s_waitcnt vmcnt(21)
    v_mfma_f32_16x16x32_bf16 v[60:63], a[40:43], v[48:51], v[60:63]
    v_mfma_f32_16x16x32_bf16 v[64:67], a[168:171], v[48:51], v[64:67]
    v_mfma_f32_16x16x32_bf16 v[68:71], v[120:123], v[48:51], v[68:71]
    s_waitcnt vmcnt(20)
    v_mfma_f32_16x16x32_bf16 v[60:63], a[44:47], v[52:55], v[60:63]
    v_mfma_f32_16x16x32_bf16 v[64:67], a[172:175], v[52:55], v[64:67]
    v_mfma_f32_16x16x32_bf16 v[68:71], v[124:127], v[52:55], v[68:71]
    s_waitcnt vmcnt(19)
    v_mfma_f32_16x16x32_bf16 v[60:63], a[48:51], v[56:59], v[60:63]
    v_mfma_f32_16x16x32_bf16 v[64:67], a[176:179], v[56:59], v[64:67]
    v_mfma_f32_16x16x32_bf16 v[68:71], v[128:131], v[56:59], v[68:71]
    s_waitcnt vmcnt(18)
    v_mfma_f32_16x16x32_bf16 v[60:63], a[52:55], v[208:211], v[60:63]
    v_mfma_f32_16x16x32_bf16 v[64:67], a[180:183], v[208:211], v[64:67]
    v_mfma_f32_16x16x32_bf16 v[68:71], v[132:135], v[208:211], v[68:71]
    s_waitcnt vmcnt(17)
    v_mfma_f32_16x16x32_bf16 v[60:63], a[56:59], v[212:215], v[60:63]
    v_mfma_f32_16x16x32_bf16 v[64:67], a[184:187], v[212:215], v[64:67]
    v_mfma_f32_16x16x32_bf16 v[68:71], v[136:139], v[212:215], v[68:71]
    s_waitcnt vmcnt(16)
    v_mfma_f32_16x16x32_bf16 v[60:63], a[60:63], v[216:219], v[60:63]
    v_mfma_f32_16x16x32_bf16 v[64:67], a[188:191], v[216:219], v[64:67]
    v_mfma_f32_16x16x32_bf16 v[68:71], v[140:143], v[216:219], v[68:71]
    s_waitcnt vmcnt(15)
    v_mfma_f32_16x16x32_bf16 v[60:63], a[64:67], v[220:223], v[60:63]
    v_mfma_f32_16x16x32_bf16 v[64:67], a[192:195], v[220:223], v[64:67]
    v_mfma_f32_16x16x32_bf16 v[68:71], v[144:147], v[220:223], v[68:71]
    s_waitcnt vmcnt(14)
    v_mfma_f32_16x16x32_bf16 v[60:63], a[68:71], v[224:227], v[60:63]
    v_mfma_f32_16x16x32_bf16 v[64:67], a[196:199], v[224:227], v[64:67]
    v_mfma_f32_16x16x32_bf16 v[68:71], v[148:151], v[224:227], v[68:71]
    s_waitcnt vmcnt(13)
    v_mfma_f32_16x16x32_bf16 v[60:63], a[72:75], v[228:231], v[60:63]
    v_mfma_f32_16x16x32_bf16 v[64:67], a[200:203], v[228:231], v[64:67]
    v_mfma_f32_16x16x32_bf16 v[68:71], v[152:155], v[228:231], v[68:71]
    s_waitcnt vmcnt(12)
    v_mfma_f32_16x16x32_bf16 v[60:63], a[76:79], v[232:235], v[60:63]
    v_mfma_f32_16x16x32_bf16 v[64:67], a[204:207], v[232:235], v[64:67]
    v_mfma_f32_16x16x32_bf16 v[68:71], v[156:159], v[232:235], v[68:71]
    s_waitcnt vmcnt(11)
    v_mfma_f32_16x16x32_bf16 v[60:63], a[80:83], v[236:239], v[60:63]
    v_mfma_f32_16x16x32_bf16 v[64:67], a[208:211], v[236:239], v[64:67]
    v_mfma_f32_16x16x32_bf16 v[68:71], v[160:163], v[236:239], v[68:71]
    s_waitcnt vmcnt(10)
    v_mfma_f32_16x16x32_bf16 v[60:63], a[84:87], v[240:243], v[60:63]
    v_mfma_f32_16x16x32_bf16 v[64:67], a[212:215], v[240:243], v[64:67]
    v_mfma_f32_16x16x32_bf16 v[68:71], v[164:167], v[240:243], v[68:71]
    s_waitcnt vmcnt(9)
    v_mfma_f32_16x16x32_bf16 v[60:63], a[88:91], v[244:247], v[60:63]
    v_mfma_f32_16x16x32_bf16 v[64:67], a[216:219], v[244:247], v[64:67]
    v_mfma_f32_16x16x32_bf16 v[68:71], v[168:171], v[244:247], v[68:71]
    s_waitcnt vmcnt(8)
    v_mfma_f32_16x16x32_bf16 v[60:63], a[92:95], v[248:251], v[60:63]
    v_mfma_f32_16x16x32_bf16 v[64:67], a[220:223], v[248:251], v[64:67]
    v_mfma_f32_16x16x32_bf16 v[68:71], v[172:175], v[248:251], v[68:71]
    s_waitcnt vmcnt(7)
    v_mfma_f32_16x16x32_bf16 v[60:63], a[96:99], v[8:11], v[60:63]
    v_mfma_f32_16x16x32_bf16 v[64:67], a[224:227], v[8:11], v[64:67]
    v_mfma_f32_16x16x32_bf16 v[68:71], v[176:179], v[8:11], v[68:71]
    s_waitcnt vmcnt(6)
    v_mfma_f32_16x16x32_bf16 v[60:63], a[100:103], v[12:15], v[60:63]
    v_mfma_f32_16x16x32_bf16 v[64:67], a[228:231], v[12:15], v[64:67]
    v_mfma_f32_16x16x32_bf16 v[68:71], v[180:183], v[12:15], v[68:71]
    s_waitcnt vmcnt(5)
    v_mfma_f32_16x16x32_bf16 v[60:63], a[104:107], v[16:19], v[60:63]
    v_mfma_f32_16x16x32_bf16 v[64:67], a[232:235], v[16:19], v[64:67]
    v_mfma_f32_16x16x32_bf16 v[68:71], v[184:187], v[16:19], v[68:71]
    s_waitcnt vmcnt(4)
    v_mfma_f32_16x16x32_bf16 v[60:63], a[108:111], v[20:23], v[60:63]
    v_mfma_f32_16x16x32_bf16 v[64:67], a[236:239], v[20:23], v[64:67]
    v_mfma_f32_16x16x32_bf16 v[68:71], v[188:191], v[20:23], v[68:71]
    s_waitcnt vmcnt(3)
    v_mfma_f32_16x16x32_bf16 v[60:63], a[112:115], v[24:27], v[60:63]
    v_mfma_f32_16x16x32_bf16 v[64:67], a[240:243], v[24:27], v[64:67]
    v_mfma_f32_16x16x32_bf16 v[68:71], v[192:195], v[24:27], v[68:71]
    s_waitcnt vmcnt(2)
    v_mfma_f32_16x16x32_bf16 v[60:63], a[116:119], v[28:31], v[60:63]
    v_mfma_f32_16x16x32_bf16 v[64:67], a[244:247], v[28:31], v[64:67]
    v_mfma_f32_16x16x32_bf16 v[68:71], v[196:199], v[28:31], v[68:71]
    s_waitcnt vmcnt(1)
    v_mfma_f32_16x16x32_bf16 v[60:63], a[120:123], v[32:35], v[60:63]
    v_mfma_f32_16x16x32_bf16 v[64:67], a[248:251], v[32:35], v[64:67]
    v_mfma_f32_16x16x32_bf16 v[68:71], v[200:203], v[32:35], v[68:71]
    s_waitcnt vmcnt(0)
    v_mfma_f32_16x16x32_bf16 v[60:63], a[124:127], v[36:39], v[60:63]
    v_mfma_f32_16x16x32_bf16 v[64:67], a[252:255], v[36:39], v[64:67]
    v_mfma_f32_16x16x32_bf16 v[68:71], v[204:207], v[36:39], v[68:71]
    ds_write_b128 v72, v[60:63] offset:0
    s_nop 2
    ds_write_b128 v72, v[64:67] offset:1024
    s_nop 2
    ds_write_b128 v72, v[68:71] offset:2048
    s_waitcnt lgkmcnt(0)
    s_barrier
    s_cmp_eq_u32 s4, 3
    s_cbranch_scc1 A4_nored
    ds_read_b128 v[8:11], v73 offset:0
    ds_read_b128 v[12:15], v73 offset:3072
    ds_read_b128 v[16:19], v73 offset:6144
    ds_read_b128 v[20:23], v73 offset:9216
    s_mul_i32 s43, s37, 36864
    s_add_u32 s43, s43, s36
    s_lshl_b32 s32, s4, 5
    s_add_u32 s43, s43, s32
    s_add_u32 s43, s43, 1152
    s_waitcnt lgkmcnt(2)
    v_pk_add_f32 v[8:9], v[8:9], v[12:13]
    s_waitcnt lgkmcnt(0)
    v_pk_add_f32 v[16:17], v[16:17], v[20:21]
    v_pk_add_f32 v[8:9], v[8:9], v[16:17]
    v_cvt_pk_bf16_f32 v12, v8, v9
    v_pk_add_f32 v[10:11], v[10:11], v[14:15]
    v_pk_add_f32 v[18:19], v[18:19], v[22:23]
    v_pk_add_f32 v[10:11], v[10:11], v[18:19]
    v_cvt_pk_bf16_f32 v13, v10, v11
    buffer_store_dwordx2 v[12:13], v74, s[76:79], s43 offen
A4_nored:
    s_barrier
    s_add_u32 s37, s37, 10
    s_cmp_lt_u32 s37, 128
    s_cbranch_scc1 A4_loop
A4_skip:
    s_endpgm
K_rc:
    s_lshr_b32 s3, s2, 3
    s_load_dwordx4 s[60:63], s[0:1], 32
    s_load_dwordx4 s[64:67], s[0:1], 48
    s_load_dwordx2 s[68:69], s[0:1], 64
    s_load_dwordx4 s[72:75], s[0:1], 88
    v_lshrrev_b32 v10, 6, v0
    v_and_b32 v0, 63, v0
    v_readfirstlane_b32 s4, v10
    s_getreg_b32 s76, hwreg(HW_REG_XCC_ID)
    v_lshlrev_b32 v1, 4, v0
    v_lshlrev_b32 v2, 3, v0
    s_waitcnt lgkmcnt(0)
    s_mov_b32 s8, s62
    s_and_b32 s9, s63, 0xffff
    s_mov_b32 s10, 4718592
    s_mov_b32 s11, 0x20000
    s_mov_b32 s12, s64
    s_and_b32 s13, s65, 0xffff
    s_mov_b32 s14, 4718592
    s_mov_b32 s15, 0x20000
    s_mov_b32 s16, s66
    s_and_b32 s17, s67, 0xffff
    s_mov_b32 s18, 4718592
    s_mov_b32 s19, 0x20000
    s_mov_b32 s20, s68
    s_and_b32 s21, s69, 0xffff
    s_mov_b32 s22, 4718592
    s_mov_b32 s23, 0x20000
    s_mov_b32 s24, s74
    s_and_b32 s25, s75, 0xffff
    s_mov_b32 s26, 268435456
    s_mov_b32 s27, 0x20000
    s_mov_b32 s28, s72
    s_mov_b32 s29, s73
    s_mov_b32 s30, s60
    s_mov_b32 s31, s61
    s_mov_b32 s40, 0x3e0293ee
    s_lshl_b32 s77, s4, 11
    s_and_b32 s76, s76, 15
    s_mov_b32 s50, 0xffbfffbf
    s_mov_b32 s51, 0xffbfffbf
    s_add_u32 s41, s3, 32
    s_cmp_eq_u32 s4, 1
    s_cselect_b32 s41, s3, s41
    s_cselect_b32 s38, 1, 0
    s_add_u32 s42, s3, 64
    s_min_u32 s42, s42, 71
    s_cmp_ge_u32 s4, 2
    s_cselect_b32 s41, s42, s41
    s_lshl_b32 s36, s41, 12
    s_add_u32 s36, s36, 50331648
    s_cmp_lt_u32 s3, 8
    s_cselect_b32 s42, 0, 2
    s_cmp_eq_u32 s4, 2
    s_cselect_b32 s38, s42, s38
    s_cmp_eq_u32 s4, 3
    s_cselect_b32 s38, 2, s38
    s_bfe_u32 s42, s41, 0x20003
    s_lshl_b32 s42, s42, 11
    s_cmp_lt_u32 s41, 32
    s_cselect_b32 s44, 1024, 0
    s_add_u32 s42, s42, s44
    s_and_b32 s44, s41, 1
    s_lshl_b32 s44, s44, 9
    s_add_u32 s42, s42, s44
    s_bfe_u32 s44, s41, 0x20001
    s_lshl_b32 s44, s44, 6
    s_add_u32 s42, s42, s44
    s_lshl_b32 s43, s41, 7
    s_cmp_ge_u32 s41, 64
    s_cselect_b32 s42, s43, s42
    s_cselect_b32 s43, 6, 8
    v_bfe_u32 v10, v0, 2, 1
    v_lshlrev_b32 v10, s43, v10
    v_bfe_u32 v11, v0, 1, 1
    v_lshl_add_u32 v10, v11, 5, v10
    v_bfe_u32 v11, v0, 4, 1
    v_lshl_add_u32 v10, v11, 4, v10
    v_bfe_u32 v11, v0, 0, 1
    v_lshl_add_u32 v10, v11, 3, v10
    v_lshrrev_b32 v11, 5, v0
    v_bfe_u32 v12, v0, 3, 1
    v_lshl_add_u32 v11, v11, 1, v12
    v_and_b32 v11, 3, v11
    v_mul_u32_u24 v11, 9472, v11
    v_add3_u32 v7, v10, v11, s42
    v_mov_b64 v[12:13], 0
    v_mov_b64 v[14:15], 0
    v_mov_b64 v[16:17], 1
    v_mov_b64 v[18:19], 1
    v_mov_b64 v[20:21], s[50:51]
    s_lshl_b32 s41, s3, 12
    s_lshl_b32 s42, s4, 10
    s_add_u32 s41, s41, s42
    s_add_u32 s41, s41, 51904512
    buffer_store_dwordx4 v[12:15], v1, s[24:27], s41 offen sc1
    s_cmp_eq_u32 s38, 2
    s_nop 0
    s_cbranch_scc1 C_noinit
    buffer_store_dwordx4 v[16:19], v1, s[24:27], s36 offen offset:0 sc1
    buffer_store_dwordx4 v[16:19], v1, s[24:27], s36 offen offset:1024 sc1
    buffer_store_dwordx4 v[16:19], v1, s[24:27], s36 offen offset:2048 sc1
    buffer_store_dwordx4 v[16:19], v1, s[24:27], s36 offen offset:3072 sc1
    s_mov_b32 s41, 51380224
    buffer_store_dwordx2 v[20:21], v7, s[24:27], s41 offen sc1
    s_mov_b32 s41, 51445760
    buffer_store_dwordx2 v[20:21], v7, s[24:27], s41 offen sc1
    s_mov_b32 s41, 51511296
    buffer_store_dwordx2 v[20:21], v7, s[24:27], s41 offen sc1
C_noinit:
    v_bfe_u32 v11, v0, 2, 2
    v_lshlrev_b32 v10, 1, v11
    v_bfe_u32 v11, v0, 0, 1
    v_lshl_add_u32 v10, v11, 0, v10
    v_mul_u32_u24 v10, 1152, v10
    v_mov_b32 v22, v10
    v_bfe_u32 v11, v0, 4, 2
    v_lshl_add_u32 v10, v11, 3, v10
    v_bfe_u32 v11, v0, 1, 1
    v_lshl_add_u32 v10, v11, 2, v10
    v_bfe_u32 v11, v0, 4, 2
    v_lshl_add_u32 v22, v11, 5, v22
    v_bfe_u32 v11, v0, 1, 1
    v_lshl_add_u32 v22, v11, 4, v22
    s_lshl_b32 s41, s4, 7
    v_add_u32 v10, s41, v10
    global_load_dword v24, v10, s[30:31] offset:512
    global_load_dword v25, v10, s[30:31] offset:544
    global_load_dword v26, v10, s[30:31] offset:576
    global_load_dword v27, v10, s[30:31] offset:608
    global_load_dword v28, v10, s[30:31] offset:0
    global_load_dword v29, v10, s[30:31] offset:32
    global_load_dword v30, v10, s[30:31] offset:64
    global_load_dword v31, v10, s[30:31] offset:96
    global_load_dwordx4 v[58:61], v22, s[30:31] offset:1024
    v_bfe_u32 v11, v0, 4, 1
    v_lshlrev_b32 v11, 1, v11
    v_xor_b32 v11, v11, v0
    v_and_b32 v12, 3, v11
    v_lshlrev_b32 v13, 4, v12
    v_bfe_u32 v11, v0, 5, 1
    v_lshlrev_b32 v66, 18, v11
    v_bfe_u32 v11, v0, 2, 1
    v_lshl_add_u32 v66, v11, 17, v66
    v_bfe_u32 v11, v0, 3, 1
    v_lshl_add_u32 v66, v11, 14, v66
    v_bfe_u32 v11, v0, 4, 1
    v_lshl_add_u32 v66, v11, 13, v66
    v_add_u32 v66, v66, v13
    v_bfe_u32 v11, v0, 3, 1
    v_lshlrev_b32 v67, 16, v11
    v_bfe_u32 v11, v0, 4, 1
    v_lshl_add_u32 v67, v11, 15, v67
    v_bfe_u32 v11, v0, 5, 1
    v_lshl_add_u32 v67, v11, 14, v67
    v_bfe_u32 v11, v0, 2, 1
    v_lshl_add_u32 v67, v11, 13, v67
    v_add_u32 v67, v67, v13
    v_bfe_u32 v11, v0, 4, 1
    v_lshlrev_b32 v14, 4, v11
    v_bfe_u32 v11, v0, 3, 1
    v_lshl_add_u32 v14, v11, 2, v14
    v_bfe_u32 v11, v0, 5, 1
    v_lshl_add_u32 v14, v11, 1, v14
    v_bfe_u32 v11, v0, 2, 1
    v_lshl_add_u32 v14, v11, 0, v14
    v_mul_u32_u24 v15, 1152, v14
    v_lshrrev_b32 v11, 1, v12
    v_mul_u32_u24 v11, 73728, v11
    v_and_b32 v12, 1, v12
    v_lshl_add_u32 v12, v12, 4, v15
    v_add_u32 v69, v12, v11
    v_lshrrev_b32 v11, 4, v0
    v_lshlrev_b32 v11, 1, v11
    v_xor_b32 v11, v11, v0
    v_and_b32 v11, 7, v11
    v_lshlrev_b32 v13, 4, v11
    v_bfe_u32 v11, v0, 3, 1
    v_lshlrev_b32 v68, 17, v11
    v_bfe_u32 v11, v0, 4, 1
    v_lshl_add_u32 v68, v11, 14, v68
    v_bfe_u32 v11, v0, 5, 1
    v_lshl_add_u32 v68, v11, 13, v68
    v_add_u32 v68, v68, v13
    v_bfe_u32 v11, v0, 3, 1
    v_lshlrev_b32 v70, 13, v11
    v_bfe_u32 v11, v0, 4, 1
    v_lshl_add_u32 v70, v11, 16, v70
    v_bfe_u32 v11, v0, 5, 1
    v_lshl_add_u32 v70, v11, 15, v70
    v_add_u32 v70, v70, v13
    v_bfe_u32 v11, v0, 3, 1
    v_lshlrev_b32 v14, 0, v11
    v_bfe_u32 v11, v0, 4, 1
    v_lshl_add_u32 v14, v11, 2, v14
    v_bfe_u32 v11, v0, 5, 1
    v_lshl_add_u32 v14, v11, 4, v14
    v_mul_u32_u24 v14, 1152, v14
    v_add_u32 v71, v14, v13
    s_lshl_b32 s42, s3, 8
    s_and_b32 s41, s4, 1
    s_lshl_b32 s41, s41, 7
    s_add_u32 s46, s42, s41
    s_lshl_b32 s41, s4, 6
    s_add_u32 s42, s42, s41
    s_mul_i32 s43, s3, 147456
    s_lshl_b32 s41, s4, 5
    s_add_u32 s44, s43, s41
    s_add_u32 s44, s44, 1024
    s_lshl_b32 s41, s4, 7
    s_add_u32 s43, s43, s41
    s_mul_i32 s101, s4, 34816
    s_add_u32 s101, s101, 24576
    s_lshl_b32 s64, s4, 12
    s_cmp_lt_u32 s4, 2
    s_cselect_b32 s8, s8, s12
    s_cselect_b32 s9, s9, s13
    s_xor_b32 s41, s4, 0
    s_lshl_b32 s96, s41, 19
    s_xor_b32 s41, s4, 1
    s_lshl_b32 s97, s41, 19
    s_xor_b32 s41, s4, 2
    s_lshl_b32 s98, s41, 19
    s_xor_b32 s41, s4, 3
    s_lshl_b32 s99, s41, 19
    s_add_u32 m0, s101, 0
    s_add_u32 s41, s46, 0
    s_add_u32 s41, s41, s96
    buffer_load_dwordx4 v68, s[8:11], s41 offen lds
    s_add_u32 m0, s101, 1024
    s_add_u32 s41, s46, 262144
    s_add_u32 s41, s41, s96
    buffer_load_dwordx4 v68, s[8:11], s41 offen lds
    s_add_u32 m0, s101, 2048
    s_add_u32 s41, s46, 32768
    s_add_u32 s41, s41, s96
    buffer_load_dwordx4 v68, s[8:11], s41 offen lds
    s_add_u32 m0, s101, 3072
    s_add_u32 s41, s46, 294912
    s_add_u32 s41, s41, s96
    buffer_load_dwordx4 v68, s[8:11], s41 offen lds
    s_add_u32 m0, s101, 4096
    s_add_u32 s41, s46, 65536
    s_add_u32 s41, s41, s96
    buffer_load_dwordx4 v68, s[8:11], s41 offen lds
    s_add_u32 m0, s101, 5120
    s_add_u32 s41, s46, 327680
    s_add_u32 s41, s41, s96
    buffer_load_dwordx4 v68, s[8:11], s41 offen lds
    s_add_u32 m0, s101, 6144
    s_add_u32 s41, s46, 98304
    s_add_u32 s41, s41, s96
    buffer_load_dwordx4 v68, s[8:11], s41 offen lds
    s_add_u32 m0, s101, 7168
    s_add_u32 s41, s46, 360448
    s_add_u32 s41, s41, s96
    buffer_load_dwordx4 v68, s[8:11], s41 offen lds
    s_add_u32 m0, s101, 8192
    s_add_u32 s41, s46, 0
    s_add_u32 s41, s41, s97
    buffer_load_dwordx4 v68, s[8:11], s41 offen lds
    s_add_u32 m0, s101, 9216
    s_add_u32 s41, s46, 262144
    s_add_u32 s41, s41, s97
    buffer_load_dwordx4 v68, s[8:11], s41 offen lds
    s_add_u32 m0, s101, 10240
    s_add_u32 s41, s46, 32768
    s_add_u32 s41, s41, s97
    buffer_load_dwordx4 v68, s[8:11], s41 offen lds
    s_add_u32 m0, s101, 11264
    s_add_u32 s41, s46, 294912
    s_add_u32 s41, s41, s97
    buffer_load_dwordx4 v68, s[8:11], s41 offen lds
    s_add_u32 m0, s101, 12288
    s_add_u32 s41, s46, 65536
    s_add_u32 s41, s41, s97
    buffer_load_dwordx4 v68, s[8:11], s41 offen lds
    s_add_u32 m0, s101, 13312
    s_add_u32 s41, s46, 327680
    s_add_u32 s41, s41, s97
    buffer_load_dwordx4 v68, s[8:11], s41 offen lds
    s_add_u32 m0, s101, 14336
    s_add_u32 s41, s46, 98304
    s_add_u32 s41, s41, s97
    buffer_load_dwordx4 v68, s[8:11], s41 offen lds
    s_add_u32 m0, s101, 15360
    s_add_u32 s41, s46, 360448
    s_add_u32 s41, s41, s97
    buffer_load_dwordx4 v68, s[8:11], s41 offen lds
    s_add_u32 m0, s101, 16384
    s_add_u32 s41, s46, 2097152
    s_add_u32 s41, s41, s98
    buffer_load_dwordx4 v68, s[8:11], s41 offen lds
    s_add_u32 m0, s101, 17408
    s_add_u32 s41, s46, 2359296
    s_add_u32 s41, s41, s98
    buffer_load_dwordx4 v68, s[8:11], s41 offen lds
    s_add_u32 m0, s101, 18432
    s_add_u32 s41, s46, 2129920
    s_add_u32 s41, s41, s98
    buffer_load_dwordx4 v68, s[8:11], s41 offen lds
    s_add_u32 m0, s101, 19456
    s_add_u32 s41, s46, 2392064
    s_add_u32 s41, s41, s98
    buffer_load_dwordx4 v68, s[8:11], s41 offen lds
    s_mul_i32 s41, s76, s76
    s_lshl_b32 s41, s41, 10
    s_add_u32 s41, s41, s76
    s_lshl_b32 s41, s41, 8
    s_add_u32 s76, s41, 1
    v_mov_b32 v12, 128
    v_mov_b32 v13, s76
    s_waitcnt vmcnt(20)
    s_barrier
    s_cmp_lg_u32 s4, 0
    s_cbranch_scc1 C_arr
    s_mov_b64 exec, 1
    global_atomic_add v12, v13, s[28:29]
    s_mov_b64 exec, -1
C_arr:
    s_mov_b32 s60, 0x05040100
    s_mov_b32 s61, 0x07060302
    v_perm_b32 v34, v25, v24, s60
    v_perm_b32 v35, v27, v26, s60
    v_perm_b32 v36, v25, v24, s61
    v_perm_b32 v37, v27, v26, s61
    v_perm_b32 v38, v29, v28, s60
    v_perm_b32 v39, v31, v30, s60
    v_perm_b32 v40, v29, v28, s61
    v_perm_b32 v41, v31, v30, s61
    v_and_b32 v10, 2, v0
    v_cmp_eq_u32 vcc, 0, v10
    v_mov_b32 v11, 0xeeee
    v_mov_b32 v12, 0x4444
    v_cndmask_b32 v3, v11, v12, vcc
    v_bfe_u32 v11, v0, 0, 4
    v_lshlrev_b32 v10, 5, v11
    v_bfe_u32 v11, v0, 4, 2
    v_lshl_add_u32 v10, v11, 3, v10
    s_and_b32 s41, s4, 1
    s_lshl_b32 s41, s41, 11
    s_add_u32 s41, s41, 8192
    v_add_u32 v10, s41, v10
    s_cmp_lt_u32 s4, 2
    s_cselect_b32 s41, 4, 0
    v_add_u32 v4, s41, v10
    v_bfe_u32 v11, v0, 0, 1
    v_lshlrev_b32 v10, 4, v11
    v_bfe_u32 v11, v0, 2, 2
    v_lshl_add_u32 v10, v11, 6, v10
    v_bfe_u32 v11, v0, 4, 1
    v_lshl_add_u32 v10, v11, 5, v10
    v_bfe_u32 v11, v0, 5, 1
    v_lshl_add_u32 v10, v11, 8, v10
    s_lshl_b32 s41, s4, 9
    s_add_u32 s41, s41, 12288
    v_add_u32 v5, s41, v10
    v_bfe_u32 v11, v0, 3, 3
    v_lshlrev_b32 v10, 12, v11
    v_bfe_u32 v11, v0, 0, 3
    v_lshl_add_u32 v10, v11, 4, v10
    v_bfe_u32 v11, v0, 5, 1
    v_lshlrev_b32 v12, 12, v11
    v_bfe_u32 v11, v0, 0, 5
    v_lshl_add_u32 v12, v11, 2, v12
    s_lshl_b32 s41, s3, 7
    v_add_u32 v6, s41, v10
    v_add_u32 v9, s41, v12
    s_lshl_b32 s41, s4, 15
    s_add_u32 s65, s41, 50331648
    s_add_u32 s66, s65, 131072
    s_lshl_b32 s41, s4, 13
    s_add_u32 s67, s41, 50593792
    v_add_u32 v8, s101, v1
    s_mov_b32 s48, 0xcccccccc
    s_mov_b32 s49, 0xcccccccc
    s_add_u32 s41, s3, s4
    s_and_b32 s41, s41, 3
    s_mul_i32 s75, s41, 9472
    s_lshl_b32 s78, s4, 12
    s_mov_b32 s72, 0x3f803f80
    s_mov_b32 s73, 0x3f803f80
    s_mov_b32 s74, 0x5d800000
    v_and_b32 v10, 4, v0
    v_cmp_eq_u32 vcc, 0, v10
    v_mov_b32 v11, 0x3f800000
    v_mov_b32 v12, 0x3f80
    v_cndmask_b32 v11, v11, v12, vcc
    v_and_b32 v10, 3, v0
    v_cmp_eq_u32 vcc, 0, v10
    s_nop 1
    v_cndmask_b32 v20, 0, v11, vcc
    v_cmp_eq_u32 vcc, 1, v10
    s_nop 1
    v_cndmask_b32 v21, 0, v11, vcc
    v_cmp_eq_u32 vcc, 2, v10
    s_nop 1
    v_cndmask_b32 v22, 0, v11, vcc
    v_cmp_eq_u32 vcc, 3, v10
    s_nop 1
    v_cndmask_b32 v23, 0, v11, vcc
    v_mov_b64 v[42:43], v[20:21]
    v_mov_b64 v[44:45], v[22:23]
    v_bfe_u32 v11, v0, 5, 1
    v_lshlrev_b32 v64, 10, v11
    v_bfe_u32 v11, v0, 4, 1
    v_lshl_add_u32 v64, v11, 8, v64
    v_bfe_u32 v11, v0, 4, 1
    v_lshl_add_u32 v64, v11, 5, v64
    v_bfe_u32 v11, v0, 2, 2
    v_lshl_add_u32 v64, v11, 6, v64
    v_bfe_u32 v11, v0, 0, 2
    v_lshl_add_u32 v64, v11, 3, v64
    v_bfe_u32 v11, v0, 5, 1
    v_lshlrev_b32 v65, 11, v11
    v_bfe_u32 v11, v0, 4, 1
    v_lshl_add_u32 v65, v11, 9, v65
    v_bfe_u32 v11, v0, 2, 2
    v_lshl_add_u32 v65, v11, 7, v65
    v_bfe_u32 v11, v0, 3, 2
    v_lshl_add_u32 v65, v11, 5, v65
    v_bfe_u32 v11, v0, 0, 2
    v_lshl_add_u32 v65, v11, 3, v65
    s_waitcnt vmcnt(16)
    v_xor_b32 v46, 0, v65
    v_add_u32 v46, s101, v46
    ds_read_b64_tr_b16 a[0:1], v46 offset:0
    ds_read_b64_tr_b16 a[2:3], v46 offset:1024
    v_xor_b32 v46, 32, v65
    v_add_u32 v46, s101, v46
    ds_read_b64_tr_b16 a[8:9], v46 offset:0
    ds_read_b64_tr_b16 a[10:11], v46 offset:1024
    v_xor_b32 v46, 64, v65
    v_add_u32 v46, s101, v46
    ds_read_b64_tr_b16 a[16:17], v46 offset:0
    ds_read_b64_tr_b16 a[18:19], v46 offset:1024
    v_xor_b32 v46, 96, v65
    v_add_u32 v46, s101, v46
    ds_read_b64_tr_b16 a[24:25], v46 offset:0
    ds_read_b64_tr_b16 a[26:27], v46 offset:1024
    s_waitcnt lgkmcnt(0)
    s_add_u32 m0, s101, 20480
    s_add_u32 s41, s46, 2162688
    s_add_u32 s41, s41, s98
    buffer_load_dwordx4 v68, s[8:11], s41 offen lds
    s_add_u32 m0, s101, 21504
    s_add_u32 s41, s46, 2424832
    s_add_u32 s41, s41, s98
    buffer_load_dwordx4 v68, s[8:11], s41 offen lds
    s_add_u32 m0, s101, 22528
    s_add_u32 s41, s46, 2195456
    s_add_u32 s41, s41, s98
    buffer_load_dwordx4 v68, s[8:11], s41 offen lds
    s_add_u32 m0, s101, 23552
    s_add_u32 s41, s46, 2457600
    s_add_u32 s41, s41, s98
    buffer_load_dwordx4 v68, s[8:11], s41 offen lds
    s_waitcnt vmcnt(16)
    v_xor_b32 v46, 0, v65
    v_add_u32 v46, s101, v46
    ds_read_b64_tr_b16 a[4:5], v46 offset:4096
    ds_read_b64_tr_b16 a[6:7], v46 offset:5120
    v_xor_b32 v46, 32, v65
    v_add_u32 v46, s101, v46
    ds_read_b64_tr_b16 a[12:13], v46 offset:4096
    ds_read_b64_tr_b16 a[14:15], v46 offset:5120
    v_xor_b32 v46, 64, v65
    v_add_u32 v46, s101, v46
    ds_read_b64_tr_b16 a[20:21], v46 offset:4096
    ds_read_b64_tr_b16 a[22:23], v46 offset:5120
    v_xor_b32 v46, 96, v65
    v_add_u32 v46, s101, v46
    ds_read_b64_tr_b16 a[28:29], v46 offset:4096
    ds_read_b64_tr_b16 a[30:31], v46 offset:5120
    s_waitcnt lgkmcnt(0)
    s_add_u32 m0, s101, 24576
    s_add_u32 s41, s46, 0
    s_add_u32 s41, s41, s98
    buffer_load_dwordx4 v68, s[8:11], s41 offen lds
    s_add_u32 m0, s101, 25600
    s_add_u32 s41, s46, 262144
    s_add_u32 s41, s41, s98
    buffer_load_dwordx4 v68, s[8:11], s41 offen lds
    s_add_u32 m0, s101, 26624
    s_add_u32 s41, s46, 32768
    s_add_u32 s41, s41, s98
    buffer_load_dwordx4 v68, s[8:11], s41 offen lds
    s_add_u32 m0, s101, 27648
    s_add_u32 s41, s46, 294912
    s_add_u32 s41, s41, s98
    buffer_load_dwordx4 v68, s[8:11], s41 offen lds
    s_waitcnt vmcnt(16)
    v_xor_b32 v46, 0, v65
    v_add_u32 v46, s101, v46
    ds_read_b64_tr_b16 a[32:33], v46 offset:8192
    ds_read_b64_tr_b16 a[34:35], v46 offset:9216
    v_xor_b32 v46, 32, v65
    v_add_u32 v46, s101, v46
    ds_read_b64_tr_b16 a[40:41], v46 offset:8192
    ds_read_b64_tr_b16 a[42:43], v46 offset:9216
    v_xor_b32 v46, 64, v65
    v_add_u32 v46, s101, v46
    ds_read_b64_tr_b16 a[48:49], v46 offset:8192
    ds_read_b64_tr_b16 a[50:51], v46 offset:9216
    v_xor_b32 v46, 96, v65
    v_add_u32 v46, s101, v46
    ds_read_b64_tr_b16 a[56:57], v46 offset:8192
    ds_read_b64_tr_b16 a[58:59], v46 offset:9216
    s_waitcnt lgkmcnt(0)
    s_add_u32 m0, s101, 28672
    s_add_u32 s41, s46, 65536
    s_add_u32 s41, s41, s98
    buffer_load_dwordx4 v68, s[8:11], s41 offen lds
    s_add_u32 m0, s101, 29696
    s_add_u32 s41, s46, 327680
    s_add_u32 s41, s41, s98
    buffer_load_dwordx4 v68, s[8:11], s41 offen lds
    s_add_u32 m0, s101, 30720
    s_add_u32 s41, s46, 98304
    s_add_u32 s41, s41, s98
    buffer_load_dwordx4 v68, s[8:11], s41 offen lds
    s_add_u32 m0, s101, 31744
    s_add_u32 s41, s46, 360448
    s_add_u32 s41, s41, s98
    buffer_load_dwordx4 v68, s[8:11], s41 offen lds
    s_waitcnt vmcnt(16)
    v_xor_b32 v46, 0, v65
    v_add_u32 v46, s101, v46
    ds_read_b64_tr_b16 a[36:37], v46 offset:12288
    ds_read_b64_tr_b16 a[38:39], v46 offset:13312
    v_xor_b32 v46, 32, v65
    v_add_u32 v46, s101, v46
    ds_read_b64_tr_b16 a[44:45], v46 offset:12288
    ds_read_b64_tr_b16 a[46:47], v46 offset:13312
    v_xor_b32 v46, 64, v65
    v_add_u32 v46, s101, v46
    ds_read_b64_tr_b16 a[52:53], v46 offset:12288
    ds_read_b64_tr_b16 a[54:55], v46 offset:13312
    v_xor_b32 v46, 96, v65
    v_add_u32 v46, s101, v46
    ds_read_b64_tr_b16 a[60:61], v46 offset:12288
    ds_read_b64_tr_b16 a[62:63], v46 offset:13312
    s_waitcnt lgkmcnt(0)
    s_add_u32 m0, s64, 0
    s_add_u32 s41, s46, 2097152
    s_add_u32 s41, s41, s99
    buffer_load_dwordx4 v68, s[8:11], s41 offen lds
    s_add_u32 m0, s64, 1024
    s_add_u32 s41, s46, 2359296
    s_add_u32 s41, s41, s99
    buffer_load_dwordx4 v68, s[8:11], s41 offen lds
    s_add_u32 m0, s64, 2048
    s_add_u32 s41, s46, 2129920
    s_add_u32 s41, s41, s99
    buffer_load_dwordx4 v68, s[8:11], s41 offen lds
    s_add_u32 m0, s64, 3072
    s_add_u32 s41, s46, 2392064
    s_add_u32 s41, s41, s99
    buffer_load_dwordx4 v68, s[8:11], s41 offen lds
    s_waitcnt vmcnt(16)
    v_xor_b32 v46, 0, v65
    v_add_u32 v46, s101, v46
    ds_read_b64_tr_b16 a[64:65], v46 offset:16384
    ds_read_b64_tr_b16 a[66:67], v46 offset:17408
    v_xor_b32 v46, 32, v65
    v_add_u32 v46, s101, v46
    ds_read_b64_tr_b16 a[72:73], v46 offset:16384
    ds_read_b64_tr_b16 a[74:75], v46 offset:17408
    v_xor_b32 v46, 64, v65
    v_add_u32 v46, s101, v46
    ds_read_b64_tr_b16 a[80:81], v46 offset:16384
    ds_read_b64_tr_b16 a[82:83], v46 offset:17408
    v_xor_b32 v46, 96, v65
    v_add_u32 v46, s101, v46
    ds_read_b64_tr_b16 a[88:89], v46 offset:16384
    ds_read_b64_tr_b16 a[90:91], v46 offset:17408
    s_waitcnt lgkmcnt(0)
    s_add_u32 m0, s101, 0
    s_add_u32 s41, s46, 2162688
    s_add_u32 s41, s41, s99
    buffer_load_dwordx4 v68, s[8:11], s41 offen lds
    s_add_u32 m0, s101, 1024
    s_add_u32 s41, s46, 2424832
    s_add_u32 s41, s41, s99
    buffer_load_dwordx4 v68, s[8:11], s41 offen lds
    s_add_u32 m0, s101, 2048
    s_add_u32 s41, s46, 2195456
    s_add_u32 s41, s41, s99
    buffer_load_dwordx4 v68, s[8:11], s41 offen lds
    s_add_u32 m0, s101, 3072
    s_add_u32 s41, s46, 2457600
    s_add_u32 s41, s41, s99
    buffer_load_dwordx4 v68, s[8:11], s41 offen lds
    s_waitcnt vmcnt(16)
    v_xor_b32 v46, 0, v65
    v_add_u32 v46, s101, v46
    ds_read_b64_tr_b16 a[68:69], v46 offset:20480
    ds_read_b64_tr_b16 a[70:71], v46 offset:21504
    v_xor_b32 v46, 32, v65
    v_add_u32 v46, s101, v46
    ds_read_b64_tr_b16 a[76:77], v46 offset:20480
    ds_read_b64_tr_b16 a[78:79], v46 offset:21504
    v_xor_b32 v46, 64, v65
    v_add_u32 v46, s101, v46
    ds_read_b64_tr_b16 a[84:85], v46 offset:20480
    ds_read_b64_tr_b16 a[86:87], v46 offset:21504
    v_xor_b32 v46, 96, v65
    v_add_u32 v46, s101, v46
    ds_read_b64_tr_b16 a[92:93], v46 offset:20480
    ds_read_b64_tr_b16 a[94:95], v46 offset:21504
    s_waitcnt lgkmcnt(0)
    s_add_u32 m0, s101, 4096
    s_add_u32 s41, s46, 0
    s_add_u32 s41, s41, s99
    buffer_load_dwordx4 v68, s[8:11], s41 offen lds
    s_add_u32 m0, s101, 5120
    s_add_u32 s41, s46, 262144
    s_add_u32 s41, s41, s99
    buffer_load_dwordx4 v68, s[8:11], s41 offen lds
    s_add_u32 m0, s101, 6144
    s_add_u32 s41, s46, 32768
    s_add_u32 s41, s41, s99
    buffer_load_dwordx4 v68, s[8:11], s41 offen lds
    s_add_u32 m0, s101, 7168
    s_add_u32 s41, s46, 294912
    s_add_u32 s41, s41, s99
    buffer_load_dwordx4 v68, s[8:11], s41 offen lds
    s_waitcnt vmcnt(16)
    v_xor_b32 v46, 0, v65
    v_add_u32 v46, s101, v46
    ds_read_b64_tr_b16 a[96:97], v46 offset:24576
    ds_read_b64_tr_b16 a[98:99], v46 offset:25600
    v_xor_b32 v46, 32, v65
    v_add_u32 v46, s101, v46
    ds_read_b64_tr_b16 a[104:105], v46 offset:24576
    ds_read_b64_tr_b16 a[106:107], v46 offset:25600
    v_xor_b32 v46, 64, v65
    v_add_u32 v46, s101, v46
    ds_read_b64_tr_b16 a[112:113], v46 offset:24576
    ds_read_b64_tr_b16 a[114:115], v46 offset:25600
    v_xor_b32 v46, 96, v65
    v_add_u32 v46, s101, v46
    ds_read_b64_tr_b16 a[120:121], v46 offset:24576
    ds_read_b64_tr_b16 a[122:123], v46 offset:25600
    s_waitcnt lgkmcnt(0)
    s_add_u32 m0, s101, 8192
    s_add_u32 s41, s46, 65536
    s_add_u32 s41, s41, s99
    buffer_load_dwordx4 v68, s[8:11], s41 offen lds
    s_add_u32 m0, s101, 9216
    s_add_u32 s41, s46, 327680
    s_add_u32 s41, s41, s99
    buffer_load_dwordx4 v68, s[8:11], s41 offen lds
    s_add_u32 m0, s101, 10240
    s_add_u32 s41, s46, 98304
    s_add_u32 s41, s41, s99
    buffer_load_dwordx4 v68, s[8:11], s41 offen lds
    s_add_u32 m0, s101, 11264
    s_add_u32 s41, s46, 360448
    s_add_u32 s41, s41, s99
    buffer_load_dwordx4 v68, s[8:11], s41 offen lds
    s_waitcnt vmcnt(16)
    v_xor_b32 v46, 0, v65
    v_add_u32 v46, s101, v46
    ds_read_b64_tr_b16 a[100:101], v46 offset:28672
    ds_read_b64_tr_b16 a[102:103], v46 offset:29696
    v_xor_b32 v46, 32, v65
    v_add_u32 v46, s101, v46
    ds_read_b64_tr_b16 a[108:109], v46 offset:28672
    ds_read_b64_tr_b16 a[110:111], v46 offset:29696
    v_xor_b32 v46, 64, v65
    v_add_u32 v46, s101, v46
    ds_read_b64_tr_b16 a[116:117], v46 offset:28672
    ds_read_b64_tr_b16 a[118:119], v46 offset:29696
    v_xor_b32 v46, 96, v65
    v_add_u32 v46, s101, v46
    ds_read_b64_tr_b16 a[124:125], v46 offset:28672
    ds_read_b64_tr_b16 a[126:127], v46 offset:29696
    s_waitcnt lgkmcnt(0)
    s_add_u32 m0, s101, 12288
    s_add_u32 s41, s46, 4194304
    buffer_load_dwordx4 v70, s[8:11], s41 offen lds
    s_add_u32 m0, s101, 13312
    s_add_u32 s41, s46, 4210688
    buffer_load_dwordx4 v70, s[8:11], s41 offen lds
    s_add_u32 m0, s101, 14336
    s_add_u32 s41, s46, 4325376
    buffer_load_dwordx4 v70, s[8:11], s41 offen lds
    s_add_u32 m0, s101, 15360
    s_add_u32 s41, s46, 4341760
    buffer_load_dwordx4 v70, s[8:11], s41 offen lds
    s_waitcnt vmcnt(16)
    v_xor_b32 v46, 0, v65
    v_add_u32 v46, s64, v46
    ds_read_b64_tr_b16 a[128:129], v46 offset:0
    ds_read_b64_tr_b16 a[130:131], v46 offset:1024
    v_xor_b32 v46, 32, v65
    v_add_u32 v46, s64, v46
    ds_read_b64_tr_b16 a[136:137], v46 offset:0
    ds_read_b64_tr_b16 a[138:139], v46 offset:1024
    v_xor_b32 v46, 64, v65
    v_add_u32 v46, s64, v46
    ds_read_b64_tr_b16 a[144:145], v46 offset:0
    ds_read_b64_tr_b16 a[146:147], v46 offset:1024
    v_xor_b32 v46, 96, v65
    v_add_u32 v46, s64, v46
    ds_read_b64_tr_b16 a[152:153], v46 offset:0
    ds_read_b64_tr_b16 a[154:155], v46 offset:1024
    s_waitcnt lgkmcnt(0)
    s_add_u32 m0, s101, 16384
    s_add_u32 s41, s46, 4456448
    buffer_load_dwordx4 v70, s[8:11], s41 offen lds
    s_add_u32 m0, s101, 17408
    s_add_u32 s41, s46, 4472832
    buffer_load_dwordx4 v70, s[8:11], s41 offen lds
    s_add_u32 m0, s101, 18432
    s_add_u32 s41, s46, 4587520
    buffer_load_dwordx4 v70, s[8:11], s41 offen lds
    s_add_u32 m0, s101, 19456
    s_add_u32 s41, s46, 4603904
    buffer_load_dwordx4 v70, s[8:11], s41 offen lds
    s_waitcnt vmcnt(16)
    v_xor_b32 v46, 0, v65
    v_add_u32 v46, s101, v46
    ds_read_b64_tr_b16 a[132:133], v46 offset:0
    ds_read_b64_tr_b16 a[134:135], v46 offset:1024
    v_xor_b32 v46, 32, v65
    v_add_u32 v46, s101, v46
    ds_read_b64_tr_b16 a[140:141], v46 offset:0
    ds_read_b64_tr_b16 a[142:143], v46 offset:1024
    v_xor_b32 v46, 64, v65
    v_add_u32 v46, s101, v46
    ds_read_b64_tr_b16 a[148:149], v46 offset:0
    ds_read_b64_tr_b16 a[150:151], v46 offset:1024
    v_xor_b32 v46, 96, v65
    v_add_u32 v46, s101, v46
    ds_read_b64_tr_b16 a[156:157], v46 offset:0
    ds_read_b64_tr_b16 a[158:159], v46 offset:1024
    s_waitcnt lgkmcnt(0)
    s_add_u32 m0, s101, 20480
    s_add_u32 s41, s43, 73728
    buffer_load_dwordx4 v71, s[20:23], s41 offen lds
    s_add_u32 m0, s101, 21504
    s_add_u32 s41, s43, 76032
    buffer_load_dwordx4 v71, s[20:23], s41 offen lds
    s_add_u32 m0, s101, 22528
    s_add_u32 s41, s43, 82944
    buffer_load_dwordx4 v71, s[20:23], s41 offen lds
    s_add_u32 m0, s101, 23552
    s_add_u32 s41, s43, 85248
    buffer_load_dwordx4 v71, s[20:23], s41 offen lds
    s_waitcnt vmcnt(16)
    v_xor_b32 v46, 0, v65
    v_add_u32 v46, s101, v46
    ds_read_b64_tr_b16 a[160:161], v46 offset:4096
    ds_read_b64_tr_b16 a[162:163], v46 offset:5120
    v_xor_b32 v46, 32, v65
    v_add_u32 v46, s101, v46
    ds_read_b64_tr_b16 a[168:169], v46 offset:4096
    ds_read_b64_tr_b16 a[170:171], v46 offset:5120
    v_xor_b32 v46, 64, v65
    v_add_u32 v46, s101, v46
    ds_read_b64_tr_b16 a[176:177], v46 offset:4096
    ds_read_b64_tr_b16 a[178:179], v46 offset:5120
    v_xor_b32 v46, 96, v65
    v_add_u32 v46, s101, v46
    ds_read_b64_tr_b16 a[184:185], v46 offset:4096
    ds_read_b64_tr_b16 a[186:187], v46 offset:5120
    s_waitcnt lgkmcnt(0)
    s_add_u32 m0, s101, 24576
    s_add_u32 s41, s43, 110592
    buffer_load_dwordx4 v71, s[20:23], s41 offen lds
    s_add_u32 m0, s101, 25600
    s_add_u32 s41, s43, 112896
    buffer_load_dwordx4 v71, s[20:23], s41 offen lds
    s_add_u32 m0, s101, 26624
    s_add_u32 s41, s43, 119808
    buffer_load_dwordx4 v71, s[20:23], s41 offen lds
    s_add_u32 m0, s101, 27648
    s_add_u32 s41, s43, 122112
    buffer_load_dwordx4 v71, s[20:23], s41 offen lds
    s_waitcnt vmcnt(16)
    v_xor_b32 v46, 0, v65
    v_add_u32 v46, s101, v46
    ds_read_b64_tr_b16 a[164:165], v46 offset:8192
    ds_read_b64_tr_b16 a[166:167], v46 offset:9216
    v_xor_b32 v46, 32, v65
    v_add_u32 v46, s101, v46
    ds_read_b64_tr_b16 a[172:173], v46 offset:8192
    ds_read_b64_tr_b16 a[174:175], v46 offset:9216
    v_xor_b32 v46, 64, v65
    v_add_u32 v46, s101, v46
    ds_read_b64_tr_b16 a[180:181], v46 offset:8192
    ds_read_b64_tr_b16 a[182:183], v46 offset:9216
    v_xor_b32 v46, 96, v65
    v_add_u32 v46, s101, v46
    ds_read_b64_tr_b16 a[188:189], v46 offset:8192
    ds_read_b64_tr_b16 a[190:191], v46 offset:9216
    s_waitcnt lgkmcnt(0)
    s_add_u32 m0, s101, 28672
    s_add_u32 s41, s43, 512
    buffer_load_dwordx4 v71, s[20:23], s41 offen lds
    s_add_u32 m0, s101, 29696
    s_add_u32 s41, s43, 2816
    buffer_load_dwordx4 v71, s[20:23], s41 offen lds
    s_add_u32 m0, s101, 30720
    s_add_u32 s41, s43, 9728
    buffer_load_dwordx4 v71, s[20:23], s41 offen lds
    s_add_u32 m0, s101, 31744
    s_add_u32 s41, s43, 12032
    buffer_load_dwordx4 v71, s[20:23], s41 offen lds
    s_waitcnt vmcnt(16)
    v_xor_b32 v46, 0, v65
    v_add_u32 v46, s101, v46
    ds_read_b64_tr_b16 a[192:193], v46 offset:12288
    ds_read_b64_tr_b16 a[194:195], v46 offset:13312
    v_xor_b32 v46, 32, v65
    v_add_u32 v46, s101, v46
    ds_read_b64_tr_b16 a[200:201], v46 offset:12288
    ds_read_b64_tr_b16 a[202:203], v46 offset:13312
    v_xor_b32 v46, 64, v65
    v_add_u32 v46, s101, v46
    ds_read_b64_tr_b16 a[208:209], v46 offset:12288
    ds_read_b64_tr_b16 a[210:211], v46 offset:13312
    v_xor_b32 v46, 96, v65
    v_add_u32 v46, s101, v46
    ds_read_b64_tr_b16 a[216:217], v46 offset:12288
    ds_read_b64_tr_b16 a[218:219], v46 offset:13312
    s_waitcnt lgkmcnt(0)
    s_add_u32 m0, s64, 0
    s_add_u32 s41, s43, 37376
    buffer_load_dwordx4 v71, s[20:23], s41 offen lds
    s_add_u32 m0, s64, 1024
    s_add_u32 s41, s43, 39680
    buffer_load_dwordx4 v71, s[20:23], s41 offen lds
    s_add_u32 m0, s64, 2048
    s_add_u32 s41, s43, 46592
    buffer_load_dwordx4 v71, s[20:23], s41 offen lds
    s_add_u32 m0, s64, 3072
    s_add_u32 s41, s43, 48896
    buffer_load_dwordx4 v71, s[20:23], s41 offen lds
    s_waitcnt vmcnt(16)
    v_xor_b32 v46, 0, v65
    v_add_u32 v46, s101, v46
    ds_read_b64_tr_b16 a[196:197], v46 offset:16384
    ds_read_b64_tr_b16 a[198:199], v46 offset:17408
    v_xor_b32 v46, 32, v65
    v_add_u32 v46, s101, v46
    ds_read_b64_tr_b16 a[204:205], v46 offset:16384
    ds_read_b64_tr_b16 a[206:207], v46 offset:17408
    v_xor_b32 v46, 64, v65
    v_add_u32 v46, s101, v46
    ds_read_b64_tr_b16 a[212:213], v46 offset:16384
    ds_read_b64_tr_b16 a[214:215], v46 offset:17408
    v_xor_b32 v46, 96, v65
    v_add_u32 v46, s101, v46
    ds_read_b64_tr_b16 a[220:221], v46 offset:16384
    ds_read_b64_tr_b16 a[222:223], v46 offset:17408
    s_waitcnt lgkmcnt(0)
    s_add_u32 m0, s101, 0
    s_add_u32 s41, s43, 74240
    buffer_load_dwordx4 v71, s[20:23], s41 offen lds
    s_add_u32 m0, s101, 1024
    s_add_u32 s41, s43, 76544
    buffer_load_dwordx4 v71, s[20:23], s41 offen lds
    s_add_u32 m0, s101, 2048
    s_add_u32 s41, s43, 83456
    buffer_load_dwordx4 v71, s[20:23], s41 offen lds
    s_add_u32 m0, s101, 3072
    s_add_u32 s41, s43, 85760
    buffer_load_dwordx4 v71, s[20:23], s41 offen lds
    s_waitcnt vmcnt(16)
    v_xor_b32 v46, 0, v65
    v_add_u32 v46, s101, v46
    ds_read_b64_tr_b16 v[152:153], v46 offset:20480
    ds_read_b64_tr_b16 v[154:155], v46 offset:21504
    v_xor_b32 v46, 32, v65
    v_add_u32 v46, s101, v46
    ds_read_b64_tr_b16 v[160:161], v46 offset:20480
    ds_read_b64_tr_b16 v[162:163], v46 offset:21504
    v_xor_b32 v46, 64, v65
    v_add_u32 v46, s101, v46
    ds_read_b64_tr_b16 v[168:169], v46 offset:20480
    ds_read_b64_tr_b16 v[170:171], v46 offset:21504
    v_xor_b32 v46, 96, v65
    v_add_u32 v46, s101, v46
    ds_read_b64_tr_b16 v[176:177], v46 offset:20480
    ds_read_b64_tr_b16 v[178:179], v46 offset:21504
    s_waitcnt lgkmcnt(0)
    s_add_u32 m0, s101, 4096
    s_add_u32 s41, s43, 111104
    buffer_load_dwordx4 v71, s[20:23], s41 offen lds
    s_add_u32 m0, s101, 5120
    s_add_u32 s41, s43, 113408
    buffer_load_dwordx4 v71, s[20:23], s41 offen lds
    s_add_u32 m0, s101, 6144
    s_add_u32 s41, s43, 120320
    buffer_load_dwordx4 v71, s[20:23], s41 offen lds
    s_add_u32 m0, s101, 7168
    s_add_u32 s41, s43, 122624
    buffer_load_dwordx4 v71, s[20:23], s41 offen lds
    s_waitcnt vmcnt(16)
    v_xor_b32 v46, 0, v65
    v_add_u32 v46, s101, v46
    ds_read_b64_tr_b16 v[156:157], v46 offset:24576
    ds_read_b64_tr_b16 v[158:159], v46 offset:25600
    v_xor_b32 v46, 32, v65
    v_add_u32 v46, s101, v46
    ds_read_b64_tr_b16 v[164:165], v46 offset:24576
    ds_read_b64_tr_b16 v[166:167], v46 offset:25600
    v_xor_b32 v46, 64, v65
    v_add_u32 v46, s101, v46
    ds_read_b64_tr_b16 v[172:173], v46 offset:24576
    ds_read_b64_tr_b16 v[174:175], v46 offset:25600
    v_xor_b32 v46, 96, v65
    v_add_u32 v46, s101, v46
    ds_read_b64_tr_b16 v[180:181], v46 offset:24576
    ds_read_b64_tr_b16 v[182:183], v46 offset:25600
    s_waitcnt lgkmcnt(0)
    s_add_u32 m0, s101, 8192
    s_add_u32 s41, s42, 2097152
    s_add_u32 s41, s41, s96
    buffer_load_dwordx4 v66, s[16:19], s41 offen lds
    s_add_u32 m0, s101, 9216
    s_add_u32 s41, s42, 2129920
    s_add_u32 s41, s41, s96
    buffer_load_dwordx4 v66, s[16:19], s41 offen lds
    s_add_u32 m0, s101, 10240
    s_add_u32 s41, s42, 2162688
    s_add_u32 s41, s41, s96
    buffer_load_dwordx4 v66, s[16:19], s41 offen lds
    s_add_u32 m0, s101, 11264
    s_add_u32 s41, s42, 2195456
    s_add_u32 s41, s41, s96
    buffer_load_dwordx4 v66, s[16:19], s41 offen lds
    s_waitcnt vmcnt(16)
    v_xor_b32 v46, 0, v65
    v_add_u32 v46, s101, v46
    ds_read_b64_tr_b16 v[184:185], v46 offset:28672
    ds_read_b64_tr_b16 v[186:187], v46 offset:29696
    v_xor_b32 v46, 32, v65
    v_add_u32 v46, s101, v46
    ds_read_b64_tr_b16 v[192:193], v46 offset:28672
    ds_read_b64_tr_b16 v[194:195], v46 offset:29696
    v_xor_b32 v46, 64, v65
    v_add_u32 v46, s101, v46
    ds_read_b64_tr_b16 v[200:201], v46 offset:28672
    ds_read_b64_tr_b16 v[202:203], v46 offset:29696
    v_xor_b32 v46, 96, v65
    v_add_u32 v46, s101, v46
    ds_read_b64_tr_b16 v[208:209], v46 offset:28672
    ds_read_b64_tr_b16 v[210:211], v46 offset:29696
    s_waitcnt lgkmcnt(0)
    s_add_u32 m0, s101, 12288
    s_add_u32 s41, s42, 2097152
    s_add_u32 s41, s41, s97
    buffer_load_dwordx4 v66, s[16:19], s41 offen lds
    s_add_u32 m0, s101, 13312
    s_add_u32 s41, s42, 2129920
    s_add_u32 s41, s41, s97
    buffer_load_dwordx4 v66, s[16:19], s41 offen lds
    s_add_u32 m0, s101, 14336
    s_add_u32 s41, s42, 2162688
    s_add_u32 s41, s41, s97
    buffer_load_dwordx4 v66, s[16:19], s41 offen lds
    s_add_u32 m0, s101, 15360
    s_add_u32 s41, s42, 2195456
    s_add_u32 s41, s41, s97
    buffer_load_dwordx4 v66, s[16:19], s41 offen lds
    s_waitcnt vmcnt(16)
    v_xor_b32 v46, 0, v65
    v_add_u32 v46, s64, v46
    ds_read_b64_tr_b16 v[188:189], v46 offset:0
    ds_read_b64_tr_b16 v[190:191], v46 offset:1024
    v_xor_b32 v46, 32, v65
    v_add_u32 v46, s64, v46
    ds_read_b64_tr_b16 v[196:197], v46 offset:0
    ds_read_b64_tr_b16 v[198:199], v46 offset:1024
    v_xor_b32 v46, 64, v65
    v_add_u32 v46, s64, v46
    ds_read_b64_tr_b16 v[204:205], v46 offset:0
    ds_read_b64_tr_b16 v[206:207], v46 offset:1024
    v_xor_b32 v46, 96, v65
    v_add_u32 v46, s64, v46
    ds_read_b64_tr_b16 v[212:213], v46 offset:0
    ds_read_b64_tr_b16 v[214:215], v46 offset:1024
    s_waitcnt lgkmcnt(0)
    s_add_u32 m0, s101, 16384
    s_add_u32 s41, s42, 0
    s_add_u32 s41, s41, s96
    buffer_load_dwordx4 v66, s[16:19], s41 offen lds
    s_add_u32 m0, s101, 17408
    s_add_u32 s41, s42, 32768
    s_add_u32 s41, s41, s96
    buffer_load_dwordx4 v66, s[16:19], s41 offen lds
    s_add_u32 m0, s101, 18432
    s_add_u32 s41, s42, 65536
    s_add_u32 s41, s41, s96
    buffer_load_dwordx4 v66, s[16:19], s41 offen lds
    s_add_u32 m0, s101, 19456
    s_add_u32 s41, s42, 98304
    s_add_u32 s41, s41, s96
    buffer_load_dwordx4 v66, s[16:19], s41 offen lds
    s_waitcnt vmcnt(16)
    v_xor_b32 v46, 0, v65
    v_add_u32 v46, s101, v46
    ds_read_b64_tr_b16 v[216:217], v46 offset:0
    ds_read_b64_tr_b16 v[218:219], v46 offset:1024
    v_xor_b32 v46, 32, v65
    v_add_u32 v46, s101, v46
    ds_read_b64_tr_b16 v[224:225], v46 offset:0
    ds_read_b64_tr_b16 v[226:227], v46 offset:1024
    v_xor_b32 v46, 64, v65
    v_add_u32 v46, s101, v46
    ds_read_b64_tr_b16 v[232:233], v46 offset:0
    ds_read_b64_tr_b16 v[234:235], v46 offset:1024
    v_xor_b32 v46, 96, v65
    v_add_u32 v46, s101, v46
    ds_read_b64_tr_b16 v[240:241], v46 offset:0
    ds_read_b64_tr_b16 v[242:243], v46 offset:1024
    s_waitcnt lgkmcnt(0)
    s_add_u32 m0, s101, 20480
    s_add_u32 s41, s42, 0
    s_add_u32 s41, s41, s97
    buffer_load_dwordx4 v66, s[16:19], s41 offen lds
    s_add_u32 m0, s101, 21504
    s_add_u32 s41, s42, 32768
    s_add_u32 s41, s41, s97
    buffer_load_dwordx4 v66, s[16:19], s41 offen lds
    s_add_u32 m0, s101, 22528
    s_add_u32 s41, s42, 65536
    s_add_u32 s41, s41, s97
    buffer_load_dwordx4 v66, s[16:19], s41 offen lds
    s_add_u32 m0, s101, 23552
    s_add_u32 s41, s42, 98304
    s_add_u32 s41, s41, s97
    buffer_load_dwordx4 v66, s[16:19], s41 offen lds
    s_waitcnt vmcnt(16)
    v_xor_b32 v46, 0, v65
    v_add_u32 v46, s101, v46
    ds_read_b64_tr_b16 v[220:221], v46 offset:4096
    ds_read_b64_tr_b16 v[222:223], v46 offset:5120
    v_xor_b32 v46, 32, v65
    v_add_u32 v46, s101, v46
    ds_read_b64_tr_b16 v[228:229], v46 offset:4096
    ds_read_b64_tr_b16 v[230:231], v46 offset:5120
    v_xor_b32 v46, 64, v65
    v_add_u32 v46, s101, v46
    ds_read_b64_tr_b16 v[236:237], v46 offset:4096
    ds_read_b64_tr_b16 v[238:239], v46 offset:5120
    v_xor_b32 v46, 96, v65
    v_add_u32 v46, s101, v46
    ds_read_b64_tr_b16 v[244:245], v46 offset:4096
    ds_read_b64_tr_b16 v[246:247], v46 offset:5120
    s_waitcnt lgkmcnt(0)
    s_add_u32 m0, s101, 24576
    s_add_u32 s41, s42, 4194304
    buffer_load_dwordx4 v67, s[16:19], s41 offen lds
    s_add_u32 m0, s101, 25600
    s_add_u32 s41, s42, 4325376
    buffer_load_dwordx4 v67, s[16:19], s41 offen lds
    s_add_u32 m0, s101, 26624
    s_add_u32 s41, s42, 4456448
    buffer_load_dwordx4 v67, s[16:19], s41 offen lds
    s_add_u32 m0, s101, 27648
    s_add_u32 s41, s42, 4587520
    buffer_load_dwordx4 v67, s[16:19], s41 offen lds
    s_waitcnt vmcnt(16)
    v_xor_b32 v46, 0, v64
    v_add_u32 v46, s101, v46
    ds_read_b64_tr_b16 a[224:225], v46 offset:8192
    ds_read_b64_tr_b16 a[226:227], v46 offset:8704
    v_xor_b32 v46, 32, v64
    v_add_u32 v46, s101, v46
    ds_read_b64_tr_b16 a[232:233], v46 offset:8192
    ds_read_b64_tr_b16 a[234:235], v46 offset:8704
    v_xor_b32 v46, 0, v64
    v_add_u32 v46, s101, v46
    ds_read_b64_tr_b16 a[228:229], v46 offset:10240
    ds_read_b64_tr_b16 a[230:231], v46 offset:10752
    v_xor_b32 v46, 32, v64
    v_add_u32 v46, s101, v46
    ds_read_b64_tr_b16 a[236:237], v46 offset:10240
    ds_read_b64_tr_b16 a[238:239], v46 offset:10752
    s_waitcnt lgkmcnt(0)
    s_add_u32 m0, s101, 28672
    s_add_u32 s41, s42, 2097152
    s_add_u32 s41, s41, s98
    buffer_load_dwordx4 v66, s[16:19], s41 offen lds
    s_add_u32 m0, s101, 29696
    s_add_u32 s41, s42, 2129920
    s_add_u32 s41, s41, s98
    buffer_load_dwordx4 v66, s[16:19], s41 offen lds
    s_add_u32 m0, s101, 30720
    s_add_u32 s41, s42, 2162688
    s_add_u32 s41, s41, s98
    buffer_load_dwordx4 v66, s[16:19], s41 offen lds
    s_add_u32 m0, s101, 31744
    s_add_u32 s41, s42, 2195456
    s_add_u32 s41, s41, s98
    buffer_load_dwordx4 v66, s[16:19], s41 offen lds
    s_waitcnt vmcnt(16)
    v_xor_b32 v46, 0, v64
    v_add_u32 v46, s101, v46
    ds_read_b64_tr_b16 a[240:241], v46 offset:12288
    ds_read_b64_tr_b16 a[242:243], v46 offset:12800
    v_xor_b32 v46, 32, v64
    v_add_u32 v46, s101, v46
    ds_read_b64_tr_b16 a[248:249], v46 offset:12288
    ds_read_b64_tr_b16 a[250:251], v46 offset:12800
    v_xor_b32 v46, 0, v64
    v_add_u32 v46, s101, v46
    ds_read_b64_tr_b16 a[244:245], v46 offset:14336
    ds_read_b64_tr_b16 a[246:247], v46 offset:14848
    v_xor_b32 v46, 32, v64
    v_add_u32 v46, s101, v46
    ds_read_b64_tr_b16 a[252:253], v46 offset:14336
    ds_read_b64_tr_b16 a[254:255], v46 offset:14848
    s_waitcnt lgkmcnt(0)
    s_add_u32 m0, s64, 0
    s_add_u32 s41, s42, 0
    s_add_u32 s41, s41, s98
    buffer_load_dwordx4 v66, s[16:19], s41 offen lds
    s_add_u32 m0, s64, 1024
    s_add_u32 s41, s42, 32768
    s_add_u32 s41, s41, s98
    buffer_load_dwordx4 v66, s[16:19], s41 offen lds
    s_add_u32 m0, s64, 2048
    s_add_u32 s41, s42, 65536
    s_add_u32 s41, s41, s98
    buffer_load_dwordx4 v66, s[16:19], s41 offen lds
    s_add_u32 m0, s64, 3072
    s_add_u32 s41, s42, 98304
    s_add_u32 s41, s41, s98
    buffer_load_dwordx4 v66, s[16:19], s41 offen lds
    s_waitcnt vmcnt(16)
    v_xor_b32 v46, 0, v64
    v_add_u32 v46, s101, v46
    ds_read_b64_tr_b16 v[72:73], v46 offset:16384
    ds_read_b64_tr_b16 v[74:75], v46 offset:16896
    v_xor_b32 v46, 32, v64
    v_add_u32 v46, s101, v46
    ds_read_b64_tr_b16 v[80:81], v46 offset:16384
    ds_read_b64_tr_b16 v[82:83], v46 offset:16896
    v_xor_b32 v46, 0, v64
    v_add_u32 v46, s101, v46
    ds_read_b64_tr_b16 v[76:77], v46 offset:18432
    ds_read_b64_tr_b16 v[78:79], v46 offset:18944
    v_xor_b32 v46, 32, v64
    v_add_u32 v46, s101, v46
    ds_read_b64_tr_b16 v[84:85], v46 offset:18432
    ds_read_b64_tr_b16 v[86:87], v46 offset:18944
    s_waitcnt lgkmcnt(0)
    s_add_u32 m0, s101, 0
    s_add_u32 s41, s46, 2097152
    s_add_u32 s41, s41, s96
    buffer_load_dwordx4 v68, s[8:11], s41 offen lds
    s_add_u32 m0, s101, 1024
    s_add_u32 s41, s46, 2359296
    s_add_u32 s41, s41, s96
    buffer_load_dwordx4 v68, s[8:11], s41 offen lds
    s_add_u32 m0, s101, 2048
    s_add_u32 s41, s46, 2129920
    s_add_u32 s41, s41, s96
    buffer_load_dwordx4 v68, s[8:11], s41 offen lds
    s_add_u32 m0, s101, 3072
    s_add_u32 s41, s46, 2392064
    s_add_u32 s41, s41, s96
    buffer_load_dwordx4 v68, s[8:11], s41 offen lds
    s_waitcnt vmcnt(16)
    v_xor_b32 v46, 0, v64
    v_add_u32 v46, s101, v46
    ds_read_b64_tr_b16 v[88:89], v46 offset:20480
    ds_read_b64_tr_b16 v[90:91], v46 offset:20992
    v_xor_b32 v46, 32, v64
    v_add_u32 v46, s101, v46
    ds_read_b64_tr_b16 v[96:97], v46 offset:20480
    ds_read_b64_tr_b16 v[98:99], v46 offset:20992
    v_xor_b32 v46, 0, v64
    v_add_u32 v46, s101, v46
    ds_read_b64_tr_b16 v[92:93], v46 offset:22528
    ds_read_b64_tr_b16 v[94:95], v46 offset:23040
    v_xor_b32 v46, 32, v64
    v_add_u32 v46, s101, v46
    ds_read_b64_tr_b16 v[100:101], v46 offset:22528
    ds_read_b64_tr_b16 v[102:103], v46 offset:23040
    s_waitcnt lgkmcnt(0)
    s_add_u32 m0, s101, 4096
    s_add_u32 s41, s46, 2162688
    s_add_u32 s41, s41, s96
    buffer_load_dwordx4 v68, s[8:11], s41 offen lds
    s_add_u32 m0, s101, 5120
    s_add_u32 s41, s46, 2424832
    s_add_u32 s41, s41, s96
    buffer_load_dwordx4 v68, s[8:11], s41 offen lds
    s_add_u32 m0, s101, 6144
    s_add_u32 s41, s46, 2195456
    s_add_u32 s41, s41, s96
    buffer_load_dwordx4 v68, s[8:11], s41 offen lds
    s_add_u32 m0, s101, 7168
    s_add_u32 s41, s46, 2457600
    s_add_u32 s41, s41, s96
    buffer_load_dwordx4 v68, s[8:11], s41 offen lds
    s_waitcnt vmcnt(16)
    v_xor_b32 v46, 0, v64
    v_add_u32 v46, s101, v46
    ds_read_b64_tr_b16 v[104:105], v46 offset:24576
    ds_read_b64_tr_b16 v[106:107], v46 offset:25088
    v_xor_b32 v46, 32, v64
    v_add_u32 v46, s101, v46
    ds_read_b64_tr_b16 v[112:113], v46 offset:24576
    ds_read_b64_tr_b16 v[114:115], v46 offset:25088
    v_xor_b32 v46, 0, v64
    v_add_u32 v46, s101, v46
    ds_read_b64_tr_b16 v[108:109], v46 offset:26624
    ds_read_b64_tr_b16 v[110:111], v46 offset:27136
    v_xor_b32 v46, 32, v64
    v_add_u32 v46, s101, v46
    ds_read_b64_tr_b16 v[116:117], v46 offset:26624
    ds_read_b64_tr_b16 v[118:119], v46 offset:27136
    s_waitcnt lgkmcnt(0)
    s_add_u32 m0, s101, 8192
    s_add_u32 s41, s46, 2097152
    s_add_u32 s41, s41, s97
    buffer_load_dwordx4 v68, s[8:11], s41 offen lds
    s_add_u32 m0, s101, 9216
    s_add_u32 s41, s46, 2359296
    s_add_u32 s41, s41, s97
    buffer_load_dwordx4 v68, s[8:11], s41 offen lds
    s_add_u32 m0, s101, 10240
    s_add_u32 s41, s46, 2129920
    s_add_u32 s41, s41, s97
    buffer_load_dwordx4 v68, s[8:11], s41 offen lds
    s_add_u32 m0, s101, 11264
    s_add_u32 s41, s46, 2392064
    s_add_u32 s41, s41, s97
    buffer_load_dwordx4 v68, s[8:11], s41 offen lds
    s_waitcnt vmcnt(16)
    v_xor_b32 v46, 0, v64
    v_add_u32 v46, s101, v46
    ds_read_b64_tr_b16 v[120:121], v46 offset:28672
    ds_read_b64_tr_b16 v[122:123], v46 offset:29184
    v_xor_b32 v46, 32, v64
    v_add_u32 v46, s101, v46
    ds_read_b64_tr_b16 v[128:129], v46 offset:28672
    ds_read_b64_tr_b16 v[130:131], v46 offset:29184
    v_xor_b32 v46, 0, v64
    v_add_u32 v46, s101, v46
    ds_read_b64_tr_b16 v[124:125], v46 offset:30720
    ds_read_b64_tr_b16 v[126:127], v46 offset:31232
    v_xor_b32 v46, 32, v64
    v_add_u32 v46, s101, v46
    ds_read_b64_tr_b16 v[132:133], v46 offset:30720
    ds_read_b64_tr_b16 v[134:135], v46 offset:31232
    s_waitcnt lgkmcnt(0)
    s_add_u32 m0, s101, 12288
    s_add_u32 s41, s46, 2162688
    s_add_u32 s41, s41, s97
    buffer_load_dwordx4 v68, s[8:11], s41 offen lds
    s_add_u32 m0, s101, 13312
    s_add_u32 s41, s46, 2424832
    s_add_u32 s41, s41, s97
    buffer_load_dwordx4 v68, s[8:11], s41 offen lds
    s_add_u32 m0, s101, 14336
    s_add_u32 s41, s46, 2195456
    s_add_u32 s41, s41, s97
    buffer_load_dwordx4 v68, s[8:11], s41 offen lds
    s_add_u32 m0, s101, 15360
    s_add_u32 s41, s46, 2457600
    s_add_u32 s41, s41, s97
    buffer_load_dwordx4 v68, s[8:11], s41 offen lds
    s_waitcnt vmcnt(16)
    v_xor_b32 v46, 0, v64
    v_add_u32 v46, s64, v46
    ds_read_b64_tr_b16 v[136:137], v46 offset:0
    ds_read_b64_tr_b16 v[138:139], v46 offset:512
    v_xor_b32 v46, 32, v64
    v_add_u32 v46, s64, v46
    ds_read_b64_tr_b16 v[144:145], v46 offset:0
    ds_read_b64_tr_b16 v[146:147], v46 offset:512
    v_xor_b32 v46, 0, v64
    v_add_u32 v46, s64, v46
    ds_read_b64_tr_b16 v[140:141], v46 offset:2048
    ds_read_b64_tr_b16 v[142:143], v46 offset:2560
    v_xor_b32 v46, 32, v64
    v_add_u32 v46, s64, v46
    ds_read_b64_tr_b16 v[148:149], v46 offset:2048
    ds_read_b64_tr_b16 v[150:151], v46 offset:2560
    s_waitcnt lgkmcnt(0)
    s_add_u32 m0, s101, 16384
    s_add_u32 s41, s43, 0
    buffer_load_dwordx4 v71, s[20:23], s41 offen lds
    s_add_u32 m0, s101, 17408
    s_add_u32 s41, s43, 2304
    buffer_load_dwordx4 v71, s[20:23], s41 offen lds
    s_add_u32 m0, s101, 18432
    s_add_u32 s41, s43, 9216
    buffer_load_dwordx4 v71, s[20:23], s41 offen lds
    s_add_u32 m0, s101, 19456
    s_add_u32 s41, s43, 11520
    buffer_load_dwordx4 v71, s[20:23], s41 offen lds
    s_waitcnt vmcnt(16)
    v_xor_b32 v46, 0, v65
    v_add_u32 v46, s101, v46
    ds_read_b64_tr_b16 v[10:11], v46 offset:0
    ds_read_b64_tr_b16 v[12:13], v46 offset:1024
    v_xor_b32 v46, 32, v65
    v_add_u32 v46, s101, v46
    ds_read_b64_tr_b16 v[14:15], v46 offset:0
    ds_read_b64_tr_b16 v[16:17], v46 offset:1024
    v_xor_b32 v46, 64, v65
    v_add_u32 v46, s101, v46
    ds_read_b64_tr_b16 v[18:19], v46 offset:0
    ds_read_b64_tr_b16 v[20:21], v46 offset:1024
    v_xor_b32 v46, 96, v65
    v_add_u32 v46, s101, v46
    ds_read_b64_tr_b16 v[22:23], v46 offset:0
    ds_read_b64_tr_b16 v[24:25], v46 offset:1024
    s_waitcnt lgkmcnt(0)
    s_add_u32 m0, s101, 20480
    s_add_u32 s41, s43, 36864
    buffer_load_dwordx4 v71, s[20:23], s41 offen lds
    s_add_u32 m0, s101, 21504
    s_add_u32 s41, s43, 39168
    buffer_load_dwordx4 v71, s[20:23], s41 offen lds
    s_add_u32 m0, s101, 22528
    s_add_u32 s41, s43, 46080
    buffer_load_dwordx4 v71, s[20:23], s41 offen lds
    s_add_u32 m0, s101, 23552
    s_add_u32 s41, s43, 48384
    buffer_load_dwordx4 v71, s[20:23], s41 offen lds
    ds_write_b128 v8, v[10:13] offset:0
    ds_write_b128 v8, v[14:17] offset:1024
    ds_write_b128 v8, v[18:21] offset:2048
    ds_write_b128 v8, v[22:25] offset:3072
    s_waitcnt vmcnt(16)
    v_xor_b32 v46, 0, v65
    v_add_u32 v46, s101, v46
    ds_read_b64_tr_b16 v[10:11], v46 offset:4096
    ds_read_b64_tr_b16 v[12:13], v46 offset:5120
    v_xor_b32 v46, 32, v65
    v_add_u32 v46, s101, v46
    ds_read_b64_tr_b16 v[14:15], v46 offset:4096
    ds_read_b64_tr_b16 v[16:17], v46 offset:5120
    v_xor_b32 v46, 64, v65
    v_add_u32 v46, s101, v46
    ds_read_b64_tr_b16 v[18:19], v46 offset:4096
    ds_read_b64_tr_b16 v[20:21], v46 offset:5120
    v_xor_b32 v46, 96, v65
    v_add_u32 v46, s101, v46
    ds_read_b64_tr_b16 v[22:23], v46 offset:4096
    ds_read_b64_tr_b16 v[24:25], v46 offset:5120
    s_waitcnt lgkmcnt(0)
    s_add_u32 m0, s101, 24576
    s_add_u32 s41, s42, 2097152
    s_add_u32 s41, s41, s99
    buffer_load_dwordx4 v66, s[16:19], s41 offen lds
    s_add_u32 m0, s101, 25600
    s_add_u32 s41, s42, 2129920
    s_add_u32 s41, s41, s99
    buffer_load_dwordx4 v66, s[16:19], s41 offen lds
    s_add_u32 m0, s101, 26624
    s_add_u32 s41, s42, 2162688
    s_add_u32 s41, s41, s99
    buffer_load_dwordx4 v66, s[16:19], s41 offen lds
    s_add_u32 m0, s101, 27648
    s_add_u32 s41, s42, 2195456
    s_add_u32 s41, s41, s99
    buffer_load_dwordx4 v66, s[16:19], s41 offen lds
    ds_write_b128 v8, v[10:13] offset:4096
    ds_write_b128 v8, v[14:17] offset:5120
    ds_write_b128 v8, v[18:21] offset:6144
    ds_write_b128 v8, v[22:25] offset:7168
    s_waitcnt vmcnt(16)
    v_xor_b32 v46, 0, v65
    v_add_u32 v46, s101, v46
    ds_read_b64_tr_b16 v[10:11], v46 offset:8192
    ds_read_b64_tr_b16 v[12:13], v46 offset:9216
    v_xor_b32 v46, 32, v65
    v_add_u32 v46, s101, v46
    ds_read_b64_tr_b16 v[14:15], v46 offset:8192
    ds_read_b64_tr_b16 v[16:17], v46 offset:9216
    v_xor_b32 v46, 64, v65
    v_add_u32 v46, s101, v46
    ds_read_b64_tr_b16 v[18:19], v46 offset:8192
    ds_read_b64_tr_b16 v[20:21], v46 offset:9216
    v_xor_b32 v46, 96, v65
    v_add_u32 v46, s101, v46
    ds_read_b64_tr_b16 v[22:23], v46 offset:8192
    ds_read_b64_tr_b16 v[24:25], v46 offset:9216
    s_waitcnt lgkmcnt(0)
    s_add_u32 m0, s101, 28672
    s_add_u32 s41, s42, 0
    s_add_u32 s41, s41, s99
    buffer_load_dwordx4 v66, s[16:19], s41 offen lds
    s_add_u32 m0, s101, 29696
    s_add_u32 s41, s42, 32768
    s_add_u32 s41, s41, s99
    buffer_load_dwordx4 v66, s[16:19], s41 offen lds
    s_add_u32 m0, s101, 30720
    s_add_u32 s41, s42, 65536
    s_add_u32 s41, s41, s99
    buffer_load_dwordx4 v66, s[16:19], s41 offen lds
    s_add_u32 m0, s101, 31744
    s_add_u32 s41, s42, 98304
    s_add_u32 s41, s41, s99
    buffer_load_dwordx4 v66, s[16:19], s41 offen lds
    ds_write_b128 v8, v[10:13] offset:8192
    ds_write_b128 v8, v[14:17] offset:9216
    ds_write_b128 v8, v[18:21] offset:10240
    ds_write_b128 v8, v[22:25] offset:11264
    s_waitcnt vmcnt(16)
    v_xor_b32 v46, 0, v65
    v_add_u32 v46, s101, v46
    ds_read_b64_tr_b16 v[10:11], v46 offset:12288
    ds_read_b64_tr_b16 v[12:13], v46 offset:13312
    v_xor_b32 v46, 32, v65
    v_add_u32 v46, s101, v46
    ds_read_b64_tr_b16 v[14:15], v46 offset:12288
    ds_read_b64_tr_b16 v[16:17], v46 offset:13312
    v_xor_b32 v46, 64, v65
    v_add_u32 v46, s101, v46
    ds_read_b64_tr_b16 v[18:19], v46 offset:12288
    ds_read_b64_tr_b16 v[20:21], v46 offset:13312
    v_xor_b32 v46, 96, v65
    v_add_u32 v46, s101, v46
    ds_read_b64_tr_b16 v[22:23], v46 offset:12288
    ds_read_b64_tr_b16 v[24:25], v46 offset:13312
    s_waitcnt lgkmcnt(0)
    s_add_u32 m0, s64, 0
    s_add_u32 s41, s44, 0
    buffer_load_dwordx4 v69, s[20:23], s41 offen lds
    s_add_u32 m0, s64, 1024
    s_add_u32 s41, s44, 9216
    buffer_load_dwordx4 v69, s[20:23], s41 offen lds
    s_add_u32 m0, s64, 2048
    s_add_u32 s41, s44, 36864
    buffer_load_dwordx4 v69, s[20:23], s41 offen lds
    s_add_u32 m0, s64, 3072
    s_add_u32 s41, s44, 46080
    buffer_load_dwordx4 v69, s[20:23], s41 offen lds
    ds_write_b128 v8, v[10:13] offset:12288
    ds_write_b128 v8, v[14:17] offset:13312
    ds_write_b128 v8, v[18:21] offset:14336
    ds_write_b128 v8, v[22:25] offset:15360
    s_waitcnt vmcnt(16)
    v_xor_b32 v46, 0, v65
    v_add_u32 v46, s101, v46
    ds_read_b64_tr_b16 v[10:11], v46 offset:16384
    ds_read_b64_tr_b16 v[12:13], v46 offset:17408
    v_xor_b32 v46, 32, v65
    v_add_u32 v46, s101, v46
    ds_read_b64_tr_b16 v[14:15], v46 offset:16384
    ds_read_b64_tr_b16 v[16:17], v46 offset:17408
    v_xor_b32 v46, 64, v65
    v_add_u32 v46, s101, v46
    ds_read_b64_tr_b16 v[18:19], v46 offset:16384
    ds_read_b64_tr_b16 v[20:21], v46 offset:17408
    v_xor_b32 v46, 96, v65
    v_add_u32 v46, s101, v46
    ds_read_b64_tr_b16 v[22:23], v46 offset:16384
    ds_read_b64_tr_b16 v[24:25], v46 offset:17408
    s_waitcnt lgkmcnt(0)
    ds_write_b128 v8, v[10:13] offset:16384
    ds_write_b128 v8, v[14:17] offset:17408
    ds_write_b128 v8, v[18:21] offset:18432
    ds_write_b128 v8, v[22:25] offset:19456
    s_waitcnt vmcnt(12)
    v_xor_b32 v46, 0, v65
    v_add_u32 v46, s101, v46
    ds_read_b64_tr_b16 v[10:11], v46 offset:20480
    ds_read_b64_tr_b16 v[12:13], v46 offset:21504
    v_xor_b32 v46, 32, v65
    v_add_u32 v46, s101, v46
    ds_read_b64_tr_b16 v[14:15], v46 offset:20480
    ds_read_b64_tr_b16 v[16:17], v46 offset:21504
    v_xor_b32 v46, 64, v65
    v_add_u32 v46, s101, v46
    ds_read_b64_tr_b16 v[18:19], v46 offset:20480
    ds_read_b64_tr_b16 v[20:21], v46 offset:21504
    v_xor_b32 v46, 96, v65
    v_add_u32 v46, s101, v46
    ds_read_b64_tr_b16 v[22:23], v46 offset:20480
    ds_read_b64_tr_b16 v[24:25], v46 offset:21504
    s_waitcnt lgkmcnt(0)
    ds_write_b128 v8, v[10:13] offset:20480
    ds_write_b128 v8, v[14:17] offset:21504
    ds_write_b128 v8, v[18:21] offset:22528
    ds_write_b128 v8, v[22:25] offset:23552
    s_waitcnt vmcnt(8)
    v_xor_b32 v46, 0, v64
    v_add_u32 v46, s101, v46
    ds_read_b64_tr_b16 v[10:11], v46 offset:24576
    ds_read_b64_tr_b16 v[12:13], v46 offset:25088
    v_xor_b32 v46, 32, v64
    v_add_u32 v46, s101, v46
    ds_read_b64_tr_b16 v[14:15], v46 offset:24576
    ds_read_b64_tr_b16 v[16:17], v46 offset:25088
    v_xor_b32 v46, 0, v64
    v_add_u32 v46, s101, v46
    ds_read_b64_tr_b16 v[18:19], v46 offset:26624
    ds_read_b64_tr_b16 v[20:21], v46 offset:27136
    v_xor_b32 v46, 32, v64
    v_add_u32 v46, s101, v46
    ds_read_b64_tr_b16 v[22:23], v46 offset:26624
    ds_read_b64_tr_b16 v[24:25], v46 offset:27136
    s_waitcnt lgkmcnt(0)
    v_mov_b32 v47, 128
    v_lshrrev_b32 v48, 2, v1
    s_lshl_b32 s68, s3, 12
    s_add_u32 s68, s68, 51904512
    global_load_dword v47, v47, s[28:29] sc1
    buffer_load_dword v48, v48, s[24:27], s68 offen sc1
    ds_write_b128 v8, v[10:13] offset:24576
    ds_write_b128 v8, v[14:17] offset:25600
    ds_write_b128 v8, v[18:21] offset:26624
    ds_write_b128 v8, v[22:25] offset:27648
    s_waitcnt vmcnt(6)
    v_xor_b32 v46, 0, v64
    v_add_u32 v46, s101, v46
    ds_read_b64_tr_b16 v[10:11], v46 offset:28672
    ds_read_b64_tr_b16 v[12:13], v46 offset:29184
    v_xor_b32 v46, 32, v64
    v_add_u32 v46, s101, v46
    ds_read_b64_tr_b16 v[14:15], v46 offset:28672
    ds_read_b64_tr_b16 v[16:17], v46 offset:29184
    v_xor_b32 v46, 0, v64
    v_add_u32 v46, s101, v46
    ds_read_b64_tr_b16 v[18:19], v46 offset:30720
    ds_read_b64_tr_b16 v[20:21], v46 offset:31232
    v_xor_b32 v46, 32, v64
    v_add_u32 v46, s101, v46
    ds_read_b64_tr_b16 v[22:23], v46 offset:30720
    ds_read_b64_tr_b16 v[24:25], v46 offset:31232
    s_waitcnt lgkmcnt(0)
    ds_write_b128 v8, v[10:13] offset:28672
    ds_write_b128 v8, v[14:17] offset:29696
    ds_write_b128 v8, v[18:21] offset:30720
    ds_write_b128 v8, v[22:25] offset:31744
    s_waitcnt vmcnt(2)
    v_xor_b32 v46, 0, v64
    v_add_u32 v46, s64, v46
    ds_read_b64_tr_b16 v[10:11], v46 offset:0
    ds_read_b64_tr_b16 v[12:13], v46 offset:512
    v_xor_b32 v46, 32, v64
    v_add_u32 v46, s64, v46
    ds_read_b64_tr_b16 v[248:249], v46 offset:0
    ds_read_b64_tr_b16 v[250:251], v46 offset:512
    v_xor_b32 v46, 0, v64
    v_add_u32 v46, s64, v46
    ds_read_b64_tr_b16 v[18:19], v46 offset:2048
    ds_read_b64_tr_b16 v[20:21], v46 offset:2560
    v_xor_b32 v46, 32, v64
    v_add_u32 v46, s64, v46
    ds_read_b64_tr_b16 v[252:253], v46 offset:2048
    ds_read_b64_tr_b16 v[254:255], v46 offset:2560
    s_waitcnt lgkmcnt(0)
    ds_write_b128 v8, v[10:13] offset:32768
    ds_write_b128 v8, v[18:21] offset:33792
    s_barrier
    ds_write_b128 v1, v[42:45] offset:14336
    v_mov_b32 v10, 128
    s_mov_b32 s47, 0
    s_waitcnt vmcnt(0)
    v_readfirstlane_b32 s41, v47
    s_nop 0
    s_and_b32 s42, s41, 0xff
    s_cmp_ge_u32 s42, 32
    s_nop 1
    s_cbranch_scc1 C_rdv_done
C_rdv_loop:
    global_load_dword v12, v10, s[28:29] sc1
    s_add_u32 s47, s47, 1
    s_waitcnt vmcnt(0)
    v_readfirstlane_b32 s41, v12
    s_cmp_gt_u32 s47, 20000
    s_nop 3
    s_cbranch_scc1 C_rdv_done
    s_and_b32 s42, s41, 0xff
    s_cmp_ge_u32 s42, 32
    s_cbranch_scc1 C_rdv_done
    s_sleep 4
    s_branch C_rdv_loop
C_rdv_done:
    s_lshl_b32 s42, s76, 5
    s_cmp_eq_u32 s41, s42
    s_cselect_b32 s39, 1, 0
    s_mov_b32 s32, 0
    s_lshl_b32 s101, s3, 20
    s_mov_b32 s35, 51380224
    s_mov_b32 s34, 51445760
    s_mov_b32 s37, 64
    s_lshl_b32 s100, s4, 10
    s_sub_u32 s100, s100, 2048
    s_mov_b32 s12, s24
    s_mov_b32 s13, s25
    s_cmp_ge_u32 s4, 2
    s_cselect_b32 s14, 268435456, 0
    s_mov_b32 s96, s24
    s_mov_b32 s97, s25
    s_cmp_eq_u32 s38, 1
    s_cselect_b32 s98, 268435456, 0
    s_mov_b32 s99, 0x20000
    s_add_u32 m0, s77, 16384
    s_mov_b32 s46, 0
    v_cmp_eq_u32 vcc, 0x01010101, v48
    s_nop 0
    s_ff0_i32_b64 s37, vcc
    s_min_u32 s37, s37, 64
    s_cmp_gt_u32 s37, 0
    s_nop 0
    s_cbranch_scc1 C_kv0_d
    v_lshrrev_b32 v17, 2, v1
    s_mov_b32 s47, 0
C_kv0:
    buffer_load_dword v16, v17, s[24:27], s68 offen sc1
    s_add_u32 s47, s47, 1
    s_waitcnt vmcnt(0)
    v_cmp_eq_u32 vcc, 0x01010101, v16
    s_nop 0
    s_ff0_i32_b64 s37, vcc
    s_min_u32 s37, s37, 64
    s_cmp_gt_u32 s47, 160000
    s_nop 0
    s_cbranch_scc1 C_kv0_d
    s_cmp_gt_u32 s37, s46
    s_cbranch_scc1 C_kv0_d
    s_sleep 4
    s_branch C_kv0
C_kv0_d:
    s_cmp_eq_u32 s39, 0
    s_cbranch_scc1 C_S_pre
C_F_pre:
    ds_read_b128 v[42:45], v8 offset:0
    ds_read_b128 v[46:49], v8 offset:4096
    ds_read_b128 v[50:53], v8 offset:1024
    ds_read_b128 v[54:57], v8 offset:5120
    s_lshr_b32 s60, s101, 1
    s_add_u32 s60, s60, 33554432
    s_lshr_b32 s42, s77, 2
    s_add_u32 s62, s60, s42
    s_add_u32 s62, s62, 4096
    s_add_u32 s60, s60, s100
    s_add_u32 s64, s101, s77
    s_add_u32 s63, s64, 8192
    s_cmp_lt_u32 s32, 63
    s_cselect_b32 s41, 16384, 0
    s_add_u32 s101, s101, s41
    s_add_u32 s61, s101, s78
    s_add_u32 s46, s32, 1
    s_min_u32 s46, s46, 63
    s_add_u32 s70, s34, s75
    s_add_u32 s69, s70, s77
    s_add_u32 s70, s70, 8192
    v_mov_b64 v[10:11], 0
    v_mov_b64 v[12:13], 0
    v_mov_b64 v[14:15], 0
    v_mov_b64 v[16:17], 0
    v_mov_b64 v[18:19], 0
    v_mov_b64 v[20:21], 0
    v_mov_b64 v[22:23], 0
    v_mov_b64 v[24:25], 0
    v_mov_b64 v[26:27], 0
    v_mov_b64 v[28:29], 0
    v_mov_b64 v[30:31], 0
    v_mov_b64 v[32:33], 0
    v_add_u32 v63, s77, v1
    v_xor_b32 v62, 2048, v63
    s_and_b32 s33, s32, 1
    s_sub_u32 s79, 0, s33
    s_waitcnt vmcnt(0) lgkmcnt(0)
    s_branch C_F_top
C_F_gather:
C_F_gather2:
    v_cmp_eq_u32 vcc, 0x01010101, v0
    s_nop 0
    s_ff0_i32_b64 s37, vcc
    s_min_u32 s37, s37, 64
    v_mov_b64 v[10:11], 0
    v_mov_b64 v[12:13], 0
    v_mov_b64 v[14:15], 0
    v_mov_b64 v[16:17], 0
    v_mov_b64 v[18:19], 0
    v_mov_b64 v[20:21], 0
    v_mov_b64 v[22:23], 0
    v_mov_b64 v[24:25], 0
    v_mov_b64 v[26:27], 0
    v_mov_b64 v[28:29], 0
    v_mov_b64 v[30:31], 0
    v_mov_b64 v[32:33], 0
    v_add_u32 v63, s77, v1
    v_xor_b32 v62, 2048, v63
    s_and_b32 s33, s32, 1
    s_sub_u32 s79, 0, s33
    s_mov_b32 s47, 0
    s_mov_b32 s35, s34
    s_add_u32 s34, s34, 65536
    s_cmp_eq_u32 s34, 51576832
    s_cselect_b32 s34, 51380224, s34
    s_cmp_lg_u32 s38, 1
    s_cbranch_scc1 C_F_g_poll
    s_waitcnt vmcnt(2)
    v_max3_u32 v0, v34, v36, v58
    v_max_u32 v0, v0, v60
    v_cmp_eq_u32 vcc, s50, v0
    s_cbranch_vccz C_F_top
C_F_g_poll:
    buffer_load_dwordx4 v[34:37], v1, s[24:27], s69 offen sc1
    buffer_load_dwordx4 v[58:61], v1, s[24:27], s70 offen sc1
    s_add_u32 s47, s47, 1
    s_cmp_gt_u32 s47, 60000
    s_cbranch_scc1 C_F_g_out
    s_waitcnt vmcnt(0)
    v_max3_u32 v0, v34, v36, v58
    v_max_u32 v0, v0, v60
    v_cmp_eq_u32 vcc, s50, v0
    s_cbranch_vccnz C_F_g_poll
C_F_top:
    v_smfmac_f32_16x16x64_bf16 v[10:13], v[34:37], v[42:49], v3
    ds_read_b128 v[42:45], v8 offset:2048
    ds_read_b128 v[46:49], v8 offset:6144
    v_smfmac_f32_16x16x64_bf16 v[14:17], v[34:37], v[50:57], v3
    ds_read_b128 v[50:53], v8 offset:3072
    ds_read_b128 v[54:57], v8 offset:7168
    v_smfmac_f32_16x16x64_bf16 v[26:29], v[34:37], a[224:231], v3
    ds_write_b128 v63, v[34:37] offset:0
    v_smfmac_f32_16x16x64_bf16 v[30:33], v[34:37], a[232:239], v3
    s_cmp_le_u32 s37, s46
    s_cbranch_scc1 C_F_kvw
C_F_kvr:
    v_smfmac_f32_16x16x64_bf16 v[10:13], v[58:61], a[192:199], v3
    s_cmp_lg_u32 s32, 0
    s_cselect_b64 exec, -1, 0
    buffer_load_dwordx4 v[38:41], v1, s[24:27], s69 offen offset:1024 sc1
    s_mov_b64 exec, -1
    v_smfmac_f32_16x16x64_bf16 v[14:17], v[58:61], a[200:207], v3
    s_waitcnt lgkmcnt(3)
    buffer_load_dwordx4 v1, s[24:27], s64 offen sc1 lds
    v_smfmac_f32_16x16x64_bf16 v[18:21], v[34:37], v[42:49], v3
    s_waitcnt lgkmcnt(1)
    v_lshrrev_b32 v0, 5, v1
    v_smfmac_f32_16x16x64_bf16 v[22:25], v[34:37], v[50:57], v3
    ds_read_b128 v[42:45], v8 offset:8192
    v_smfmac_f32_16x16x64_bf16 v[18:21], v[58:61], a[208:215], v3
    s_waitcnt lgkmcnt(1)
    s_barrier
    ds_read_b128 v[34:37], v62 offset:0
    ds_read_b128 v[46:49], v8 offset:12288
    ds_read_b128 v[50:53], v8 offset:9216
    v_smfmac_f32_16x16x64_bf16 v[22:25], v[58:61], a[216:223], v3
    buffer_load_dwordx4 v1, s[24:27], s64 offen offset:1024 sc1 lds
    ds_read_b128 v[54:57], v8 offset:13312
    v_smfmac_f32_16x16x64_bf16 v[26:29], v[58:61], v[104:111], v3
    v_xor_b32 v62, 4096, v63
    buffer_load_dwordx4 v[64:67], v1, s[24:27], s63 offen sc1
    v_smfmac_f32_16x16x64_bf16 v[30:33], v[58:61], v[112:119], v3
    s_waitcnt lgkmcnt(2)
    ds_read_b128 v[58:61], v62 offset:0
    buffer_load_dwordx4 v[68:71], v1, s[24:27], s63 offen offset:1024 sc1
    v_smfmac_f32_16x16x64_bf16 v[10:13], v[34:37], v[42:49], v3
    s_waitcnt lgkmcnt(1)
    ds_read_b128 v[42:45], v8 offset:10240
    v_smfmac_f32_16x16x64_bf16 v[14:17], v[34:37], v[50:57], v3
    v_lshlrev_b32 v0, 7, v0
    v_smfmac_f32_16x16x64_bf16 v[26:29], v[34:37], a[240:247], v3
    ds_read_b128 v[46:49], v8 offset:14336
    ds_read_b128 v[50:53], v8 offset:11264
    v_smfmac_f32_16x16x64_bf16 v[30:33], v[34:37], a[248:255], v3
    s_waitcnt lgkmcnt(3)
    buffer_load_dword v0, v0, s[24:27], s61 offen sc1
    ds_read_b128 v[54:57], v8 offset:15360
    v_smfmac_f32_16x16x64_bf16 v[10:13], v[58:61], a[64:71], v3
    v_xor_b32 v62, 6144, v63
    v_smfmac_f32_16x16x64_bf16 v[14:17], v[58:61], a[72:79], v3
    s_waitcnt lgkmcnt(2)
    v_lshrrev_b32 v0, 2, v1
    v_smfmac_f32_16x16x64_bf16 v[18:21], v[34:37], v[42:49], v3
    s_waitcnt lgkmcnt(0)
    buffer_load_dword v0, v0, s[24:27], s68 offen sc1
    v_smfmac_f32_16x16x64_bf16 v[22:25], v[34:37], v[50:57], v3
    ds_read_b128 v[34:37], v62 offset:0
    ds_read_b128 v[42:45], v8 offset:24576
    v_smfmac_f32_16x16x64_bf16 v[18:21], v[58:61], a[80:87], v3
    s_waitcnt vmcnt(6)
    v_cmp_eq_u32 s[44:45], s50, v38
    ds_read_b128 v[46:49], v8 offset:26624
    ds_read_b128 v[50:53], v8 offset:25600
    v_smfmac_f32_16x16x64_bf16 v[22:25], v[58:61], a[88:95], v3
    v_cmp_eq_u32 vcc, s50, v40
    ds_read_b128 v[54:57], v8 offset:27648
    v_smfmac_f32_16x16x64_bf16 v[26:29], v[58:61], v[120:127], v3
    s_or_b64 vcc, vcc, s[44:45]
    s_cbranch_scc1 C_F_late1
C_F_late1r:
    ds_write_b128 v63, v[38:41] offset:1024
    v_smfmac_f32_16x16x64_bf16 v[30:33], v[58:61], v[128:135], v3
    s_waitcnt lgkmcnt(5)
    v_xor_b32 v62, 2048, v63
    v_smfmac_f32_16x16x64_bf16 v[10:13], v[34:37], a[128:135], v3
    v_smfmac_f32_16x16x64_bf16 v[14:17], v[34:37], a[136:143], v3
    v_smfmac_f32_16x16x64_bf16 v[18:21], v[34:37], a[144:151], v3
    v_smfmac_f32_16x16x64_bf16 v[22:25], v[34:37], a[152:159], v3
    s_waitcnt lgkmcnt(3)
    v_smfmac_f32_16x16x64_bf16 v[26:29], v[34:37], v[42:49], v3
    s_waitcnt lgkmcnt(0)
    s_barrier
    ds_read_b128 v[58:61], v62 offset:1024
    v_smfmac_f32_16x16x64_bf16 v[30:33], v[34:37], v[50:57], v3
    v_xor_b32 v62, 4096, v63
    v_smfmac_f32_16x16x64_bf16 v[10:13], v[38:41], a[0:7], v3
    ds_read_b128 v[34:37], v62 offset:1024
    v_smfmac_f32_16x16x64_bf16 v[14:17], v[38:41], a[8:15], v3
    v_xor_b32 v62, 6144, v63
    v_smfmac_f32_16x16x64_bf16 v[18:21], v[38:41], a[16:23], v3
    v_smfmac_f32_16x16x64_bf16 v[22:25], v[38:41], a[24:31], v3
    s_waitcnt lgkmcnt(1)
    ds_read_b128 v[38:41], v62 offset:1024
    v_smfmac_f32_16x16x64_bf16 v[10:13], v[58:61], a[32:39], v3
    ds_read_b128 v[42:45], v8 offset:28672
    v_smfmac_f32_16x16x64_bf16 v[14:17], v[58:61], a[40:47], v3
    s_waitcnt lgkmcnt(2)
    ds_read_b128 v[46:49], v8 offset:30720
    v_smfmac_f32_16x16x64_bf16 v[10:13], v[34:37], a[96:103], v3
    ds_read_b128 v[50:53], v8 offset:29696
    v_smfmac_f32_16x16x64_bf16 v[14:17], v[34:37], a[104:111], v3
    s_waitcnt lgkmcnt(3)
    ds_read_b128 v[54:57], v8 offset:31744
    v_smfmac_f32_16x16x64_bf16 v[10:13], v[38:41], a[160:167], v3
    v_smfmac_f32_16x16x64_bf16 v[14:17], v[38:41], a[168:175], v3
    v_smfmac_f32_16x16x64_bf16 v[18:21], v[58:61], a[48:55], v3
    v_add_f32 v10, v10, v12
    v_smfmac_f32_16x16x64_bf16 v[22:25], v[58:61], a[56:63], v3
    v_add_f32 v11, v11, v13
    v_smfmac_f32_16x16x64_bf16 v[18:21], v[34:37], a[112:119], v3
    v_cvt_pk_bf16_f32 v12, v10, v11
    v_smfmac_f32_16x16x64_bf16 v[22:25], v[34:37], a[120:127], v3
    v_add_f32 v14, v14, v16
    ds_write_b32 v4, v12 offset:0
    v_smfmac_f32_16x16x64_bf16 v[18:21], v[38:41], a[176:183], v3
    v_add_f32 v15, v15, v17
    v_smfmac_f32_16x16x64_bf16 v[22:25], v[38:41], a[184:191], v3
    v_cvt_pk_bf16_f32 v13, v14, v15
    v_smfmac_f32_16x16x64_bf16 v[26:29], v[58:61], v[88:95], v3
    ds_write_b32 v4, v13 offset:512
    v_add_f32 v18, v18, v20
    v_add_f32 v19, v19, v21
    v_cvt_pk_bf16_f32 v14, v18, v19
    ds_write_b32 v4, v14 offset:1024
    v_add_f32 v22, v22, v24
    v_add_f32 v23, v23, v25
    v_cvt_pk_bf16_f32 v15, v22, v23
    ds_write_b32 v4, v15 offset:1536
    v_smfmac_f32_16x16x64_bf16 v[30:33], v[58:61], v[96:103], v3
    s_waitcnt lgkmcnt(6)
    buffer_store_dwordx4 v[12:15], v1, s[12:15], s60 offen sc1
    v_smfmac_f32_16x16x64_bf16 v[26:29], v[38:41], v[42:49], v3
    s_waitcnt lgkmcnt(4)
    v_smfmac_f32_16x16x64_bf16 v[30:33], v[38:41], v[50:57], v3
    ds_read_b128 v[38:41], v63 offset:1024
    v_smfmac_f32_16x16x64_bf16 v[26:29], v[34:37], v[136:143], v3
    s_waitcnt lgkmcnt(1) vmcnt(3)
    s_barrier
    ds_read_b64_tr_b16 v[22:23], v2 offset:8192
    ds_read_b64_tr_b16 v[24:25], v2 offset:8704
    ds_read_b128 v[42:45], v1 offset:16384
    ds_read_b128 v[46:49], v1 offset:20480
    ds_read_b64_tr_b16 v[58:59], v2 offset:9216
    ds_read_b64_tr_b16 v[60:61], v2 offset:9728
    ds_read_b128 v[50:53], v1 offset:17408
    ds_read_b128 v[54:57], v1 offset:21504
    v_smfmac_f32_16x16x64_bf16 v[30:33], v[34:37], v[144:151], v3
    s_waitcnt lgkmcnt(8)
    ds_read_b64_tr_b16 v[34:35], v2 offset:10240
    ds_read_b64_tr_b16 v[36:37], v2 offset:10752
    v_smfmac_f32_16x16x64_bf16 v[26:29], v[38:41], v[72:79], v3
    v_smfmac_f32_16x16x64_bf16 v[30:33], v[38:41], v[80:87], v3
    s_waitcnt lgkmcnt(8)
    ds_read_b64_tr_b16 v[38:39], v2 offset:11264
    ds_read_b64_tr_b16 v[40:41], v2 offset:11776
    v_mfma_f32_16x16x32_bf16 v[18:21], v[22:25], v[22:25], 0
    s_waitcnt lgkmcnt(9)
    v_mfma_f32_16x16x32_bf16 v[10:13], v[42:45], v[22:25], 0
    s_waitcnt lgkmcnt(8)
    ds_read_b128 v[42:45], v1 offset:18432
    v_mfma_f32_16x16x32_bf16 v[14:17], v[46:49], v[22:25], 0
    s_waitcnt lgkmcnt(7)
    ds_read_b128 v[46:49], v1 offset:22528
    v_mov_b64 v[22:23], s[72:73]
    v_mfma_f32_16x16x32_bf16 v[18:21], v[58:61], v[58:61], v[18:21]
    s_waitcnt lgkmcnt(7)
    v_add_f32 v26, v26, v28
    v_mfma_f32_16x16x32_bf16 v[10:13], v[50:53], v[58:61], v[10:13]
    s_waitcnt lgkmcnt(6)
    ds_read_b128 v[50:53], v1 offset:19456
    v_add_f32 v27, v27, v29
    v_mfma_f32_16x16x32_bf16 v[14:17], v[54:57], v[58:61], v[14:17]
    s_waitcnt lgkmcnt(5)
    ds_read_b128 v[54:57], v1 offset:23552
    v_mov_b64 v[24:25], s[72:73]
    v_mfma_f32_16x16x32_bf16 v[18:21], v[34:37], v[34:37], v[18:21]
    s_waitcnt lgkmcnt(3)
    v_add_f32 v30, v30, v32
    v_mfma_f32_16x16x32_bf16 v[10:13], v[42:45], v[34:37], v[10:13]
    s_waitcnt lgkmcnt(2)
    v_add_f32 v31, v31, v33
    v_mfma_f32_16x16x32_bf16 v[14:17], v[46:49], v[34:37], v[14:17]
    ds_read_b128 v[42:45], v8 offset:16384
    ds_read_b128 v[46:49], v8 offset:20480
    v_mfma_f32_16x16x32_bf16 v[18:21], v[38:41], v[38:41], v[18:21]
    s_waitcnt lgkmcnt(3)
    v_cvt_pk_bf16_f32 v28, v26, v27
    v_mfma_f32_16x16x32_bf16 v[10:13], v[50:53], v[38:41], v[10:13]
    s_waitcnt lgkmcnt(2)
    v_cvt_pk_bf16_f32 v29, v30, v31
    v_mfma_f32_16x16x32_bf16 v[14:17], v[54:57], v[38:41], v[14:17]
    ds_read_b128 v[50:53], v8 offset:17408
    ds_read_b128 v[54:57], v8 offset:21504
    v_mul_f32 v18, s40, v18
    v_mul_f32 v19, s40, v19
    buffer_store_dwordx2 v[28:29], v2, s[24:27], s62 offen sc1
    s_cmp_eq_u32 s32, 63
    v_exp_f32 v62, v18
    v_exp_f32 v63, v19
    s_cbranch_scc1 C_end
    v_exp_f32 v26, v10
    v_exp_f32 v27, v11
    v_cvt_pk_bf16_f32 v20, v62, v63
    v_mov_b32 v21, 0
    v_exp_f32 v32, v12
    v_exp_f32 v33, v13
    v_mfma_f32_16x16x16_bf16 v[34:37], v[28:29], v[20:21], 0
    v_cvt_pk_bf16_f32 v63, v62, v63
    v_mov_b32 v62, 0
    v_cvt_pk_bf16_f32 v58, v26, v27
    v_exp_f32 v26, v14
    v_mfma_f32_16x16x16_bf16 v[38:41], v[28:29], v[62:63], 0
    v_exp_f32 v27, v15
    v_cvt_pk_bf16_f32 v59, v32, v33
    v_exp_f32 v62, v16
    v_mfma_f32_16x16x16_bf16 v[30:33], v[22:23], v[20:21], 0
    v_exp_f32 v63, v17
    v_cvt_pk_bf16_f32 v60, v26, v27
    v_cvt_pk_bf16_f32 v61, v62, v63
    s_nop 2
    v_mfma_f32_16x16x32_bf16 v[30:33], v[22:25], v[58:61], v[30:33]
    v_mfma_f32_16x16x32_bf16 v[34:37], v[64:67], v[58:61], v[34:37]
    v_mfma_f32_16x16x32_bf16 v[38:41], v[68:71], v[58:61], v[38:41]
    v_rcp_f32 v31, v30
    s_mov_b64 exec, s[48:49]
    s_nop 1
    v_pk_mul_f32 v[34:35], v[34:35], v[30:31] op_sel:[0,1] op_sel_hi:[1,1]
    v_pk_mul_f32 v[36:37], v[36:37], v[30:31] op_sel:[0,1] op_sel_hi:[1,1]
    v_cvt_pk_bf16_f32 v58, v34, v35
    v_cvt_pk_bf16_f32 v59, v36, v37
    ds_write_b64 v5, v[58:59] offset:0
    v_pk_mul_f32 v[38:39], v[38:39], v[30:31] op_sel:[0,1] op_sel_hi:[1,1]
    v_pk_mul_f32 v[40:41], v[40:41], v[30:31] op_sel:[0,1] op_sel_hi:[1,1]
    v_cvt_pk_bf16_f32 v60, v38, v39
    v_cvt_pk_bf16_f32 v61, v40, v41
    ds_write_b64 v5, v[60:61] offset:8
    v_max_f32 v32, v30, v31
    v_cmp_nlt_f32 vcc, v32, s74
    s_mov_b64 exec, -1
    s_cbranch_vccnz C_F_slow
C_F_slowret:
    ds_read_b128 v[34:37], v8 offset:32768
    ds_read_b128 v[38:41], v8 offset:33792
    v_mov_b64 v[18:19], 0
    v_mov_b64 v[20:21], 0
    v_mov_b64 v[22:23], 0
    v_mov_b64 v[24:25], 0
    v_mov_b64 v[64:65], 0
    v_mov_b64 v[66:67], 0
    v_mov_b64 v[68:69], 0
    v_mov_b64 v[70:71], 0
    s_waitcnt lgkmcnt(2)
    s_barrier
    ds_read_b128 v[10:13], v1 offset:12288
    ds_read_b128 v[14:17], v1 offset:13312
    v_mov_b64 v[26:27], 0
    v_mov_b64 v[28:29], 0
    v_mov_b64 v[30:31], 0
    v_mov_b64 v[32:33], 0
    s_waitcnt lgkmcnt(1)
    v_smfmac_f32_16x16x64_bf16 v[18:21], v[10:13], v[184:191], v3
    v_smfmac_f32_16x16x64_bf16 v[22:25], v[10:13], v[192:199], v3
    s_waitcnt lgkmcnt(0)
    v_smfmac_f32_16x16x64_bf16 v[18:21], v[14:17], v[216:223], v3
    v_smfmac_f32_16x16x64_bf16 v[22:25], v[14:17], v[224:231], v3
    v_smfmac_f32_16x16x64_bf16 v[64:67], v[10:13], v[200:207], v3
    v_add_f32 v18, v18, v20
    v_smfmac_f32_16x16x64_bf16 v[68:71], v[10:13], v[208:215], v3
    v_add_f32 v19, v19, v21
    v_cvt_pk_bf16_f32 v58, v18, v19
    v_smfmac_f32_16x16x64_bf16 v[64:67], v[14:17], v[232:239], v3
    v_bfi_b32 v58, 1, s33, v58
    v_add_f32 v22, v22, v24
    v_smfmac_f32_16x16x64_bf16 v[68:71], v[14:17], v[240:247], v3
    v_add_f32 v23, v23, v25
    v_cvt_pk_bf16_f32 v59, v22, v23
    v_smfmac_f32_16x16x64_bf16 v[26:29], v[10:13], v[34:41], v3
    v_add_f32 v64, v64, v66
    v_smfmac_f32_16x16x64_bf16 v[26:29], v[14:17], v[248:255], v3
    v_add_f32 v65, v65, v67
    v_cvt_pk_bf16_f32 v60, v64, v65
    v_add_f32 v68, v68, v70
    v_mov_b64 v[18:19], 0
    v_mov_b64 v[20:21], 0
    v_smfmac_f32_16x16x64_bf16 v[30:33], v[10:13], v[42:49], v3
    v_add_f32 v69, v69, v71
    v_cvt_pk_bf16_f32 v61, v68, v69
    buffer_store_dwordx4 v[58:61], v6, s[24:27], s66 offen
    v_smfmac_f32_16x16x64_bf16 v[18:21], v[10:13], v[50:57], v3
    ds_read_b128 v[42:45], v8 offset:18432
    v_add_f32 v26, v26, v28
    v_mov_b64 v[22:23], 0
    v_smfmac_f32_16x16x64_bf16 v[30:33], v[14:17], v[152:159], v3
    ds_read_b128 v[46:49], v8 offset:22528
    ds_read_b128 v[50:53], v8 offset:19456
    v_add_f32 v27, v27, v29
    v_cvt_pk_bf16_f32 v62, v26, v27
    v_bfi_b32 v62, 1, s33, v62
    buffer_store_dword v62, v9, s[24:27], s67 offen
    v_mov_b64 v[24:25], 0
    v_smfmac_f32_16x16x64_bf16 v[18:21], v[14:17], v[160:167], v3
    ds_read_b128 v[54:57], v8 offset:23552
    v_mov_b64 v[34:35], 0
    v_mov_b64 v[36:37], 0
    v_smfmac_f32_16x16x64_bf16 v[22:25], v[14:17], v[168:175], v3
    v_smfmac_f32_16x16x64_bf16 v[34:37], v[14:17], v[176:183], v3
    s_waitcnt lgkmcnt(2)
    v_add_f32 v30, v30, v32
    v_smfmac_f32_16x16x64_bf16 v[22:25], v[10:13], v[42:49], v3
    s_waitcnt lgkmcnt(0)
    v_add_f32 v31, v31, v33
    v_cvt_pk_bf16_f32 v58, v30, v31
    v_bfi_b32 v58, 1, s33, v58
    v_add_f32 v18, v18, v20
    v_smfmac_f32_16x16x64_bf16 v[34:37], v[10:13], v[50:57], v3
    v_add_f32 v19, v19, v21
    v_cvt_pk_bf16_f32 v59, v18, v19
    ds_read_b128 v[64:67], v1 offset:14336
    v_add_f32 v22, v22, v24
    v_add_f32 v23, v23, v25
    v_cvt_pk_bf16_f32 v60, v22, v23
    s_nop 1
    v_add_f32 v34, v34, v36
    v_add_f32 v35, v35, v37
    v_cvt_pk_bf16_f32 v61, v34, v35
    buffer_store_dwordx4 v[58:61], v6, s[24:27], s65 offen
    s_add_u32 s32, s32, 1
    ds_read_b128 v[42:45], v8 offset:0
    ds_read_b128 v[46:49], v8 offset:4096
    ds_read_b128 v[50:53], v8 offset:1024
    ds_read_b128 v[54:57], v8 offset:5120
    s_lshr_b32 s60, s101, 1
    s_add_u32 s60, s60, 33554432
    s_lshr_b32 s42, s77, 2
    s_add_u32 s62, s60, s42
    s_add_u32 s62, s62, 4096
    s_add_u32 s60, s60, s100
    s_add_u32 s64, s101, s77
    s_add_u32 s63, s64, 8192
    s_cmp_lt_u32 s32, 63
    s_cselect_b32 s41, 16384, 0
    s_add_u32 s101, s101, s41
    s_add_u32 s61, s101, s78
    s_add_u32 s46, s32, 1
    s_min_u32 s46, s46, 63
    s_add_u32 s70, s34, s75
    s_add_u32 s69, s70, s77
    s_add_u32 s70, s70, 8192
    s_mov_b32 s47, 0
    s_cmp_lg_u32 s38, 0
    s_waitcnt lgkmcnt(0)
    s_cbranch_scc1 C_F_notearly
C_F_r_poll:
    buffer_load_dwordx4 v[10:13], v1, s[24:27], s36 offen offset:0 sc1
    buffer_load_dwordx4 v[14:17], v1, s[24:27], s36 offen offset:1024 sc1
    buffer_load_dwordx4 v[18:21], v1, s[24:27], s36 offen offset:2048 sc1
    buffer_load_dwordx4 v[22:25], v1, s[24:27], s36 offen offset:3072 sc1
    s_add_u32 s47, s47, 1
    s_cmp_lt_u32 s47, 60000
    s_cselect_b32 s42, 1, 0
    s_waitcnt vmcnt(3)
    v_mfma_f32_16x16x32_bf16 v[68:71], v[64:67], v[10:13], 0
    s_waitcnt vmcnt(2)
    v_mfma_f32_16x16x32_bf16 v[68:71], v[64:67], v[14:17], v[68:71]
    v_bitop3_b32 v62, v10, v14, s79 bitop3:0x7e
    s_waitcnt vmcnt(1)
    v_mfma_f32_16x16x32_bf16 v[68:71], v[64:67], v[18:21], v[68:71]
    s_waitcnt vmcnt(0)
    v_mfma_f32_16x16x32_bf16 v[68:71], v[64:67], v[22:25], v[68:71]
    buffer_load_dwordx4 v[34:37], v1, s[96:99], s69 offen sc1
    buffer_load_dwordx4 v[58:61], v1, s[96:99], s70 offen sc1
    v_bitop3_b32 v63, v18, v22, s79 bitop3:0x7e
    v_bitop3_b32 v62, v62, v63, s42 bitop3:0xa8
    v_cmp_ne_u32 vcc, 0, v62
    s_nop 2
    v_add_f32_dpp v68, v68, v68 row_ror:8 row_mask:0xf bank_mask:0xf
    v_add_f32_dpp v69, v69, v69 row_ror:8 row_mask:0xf bank_mask:0xf
    v_add_f32_dpp v70, v70, v70 row_ror:8 row_mask:0xf bank_mask:0xf
    v_add_f32_dpp v71, v71, v71 row_ror:8 row_mask:0xf bank_mask:0xf
    v_cvt_pk_bf16_f32 v68, v68, v69
    v_cvt_pk_bf16_f32 v69, v70, v71
    s_cbranch_vccnz C_F_r_poll
    buffer_store_dwordx2 v[68:69], v7, s[24:27], s34 offen
    v_mov_b64 v[62:63], s[50:51]
    buffer_store_dwordx2 v[62:63], v7, s[24:27], s35 offen
    s_branch C_F_gather
C_F_notearly:
    s_cmp_eq_u32 s38, 2
    s_waitcnt vmcnt(0)
    s_cbranch_scc1 C_F_gather
    s_branch C_F_r_poll
C_F_g_out:
    s_waitcnt vmcnt(0)
    s_branch C_F_top
C_F_late1:
    s_mov_b32 s47, 0
C_F_late1l:
    buffer_load_dwordx4 v[38:41], v1, s[24:27], s69 offen offset:1024 sc1
    s_add_u32 s47, s47, 1
    s_waitcnt vmcnt(0)
    v_cmp_eq_u32 s[44:45], s50, v38
    v_cmp_eq_u32 vcc, s50, v40
    s_nop 0
    s_or_b64 vcc, vcc, s[44:45]
    s_cmp_gt_u32 s47, 20000
    s_cbranch_scc1 C_F_late1r
    s_cbranch_vccnz C_F_late1l
    s_branch C_F_late1r
C_F_kvw:
    s_nop 3
    v_lshrrev_b32 v65, 2, v1
    s_mov_b32 s47, 0
C_F_kvl:
    buffer_load_dword v64, v65, s[24:27], s68 offen sc1
    s_add_u32 s47, s47, 1
    s_waitcnt vmcnt(0)
    v_cmp_eq_u32 vcc, 0x01010101, v64
    s_nop 0
    s_ff0_i32_b64 s37, vcc
    s_min_u32 s37, s37, 64
    s_cmp_gt_u32 s47, 160000
    s_nop 0
    s_cbranch_scc1 C_F_kvl_d
    s_cmp_gt_u32 s37, s46
    s_cbranch_scc1 C_F_kvl_d
    s_sleep 4
    s_branch C_F_kvl
C_F_kvl_d:
    s_branch C_F_kvr
C_F_slow:
    s_nop 15
    v_max3_f32 v30, v10, v11, v12
    v_max3_f32 v31, v13, v14, v15
    v_max3_f32 v30, v30, v16, v17
    v_max3_f32 v31, v31, v18, v19
    v_max_f32 v30, v30, v31
    v_mov_b32 v31, v30
    s_nop 1
    v_permlane32_swap_b32 v30, v31
    v_max_f32 v30, v30, v31
    v_mov_b32 v31, v30
    s_nop 1
    v_permlane16_swap_b32 v30, v31
    v_max_f32 v30, v30, v31
    v_sub_f32 v10, v10, v30
    v_sub_f32 v11, v11, v30
    v_sub_f32 v12, v12, v30
    v_sub_f32 v13, v13, v30
    v_sub_f32 v14, v14, v30
    v_sub_f32 v15, v15, v30
    v_sub_f32 v16, v16, v30
    v_sub_f32 v17, v17, v30
    v_sub_f32 v18, v18, v30
    v_sub_f32 v19, v19, v30
    v_exp_f32 v10, v10
    v_exp_f32 v11, v11
    v_exp_f32 v12, v12
    v_exp_f32 v13, v13
    v_exp_f32 v14, v14
    v_exp_f32 v15, v15
    v_exp_f32 v16, v16
    v_exp_f32 v17, v17
    v_exp_f32 v18, v18
    v_exp_f32 v19, v19
    v_cvt_pk_bf16_f32 v58, v10, v11
    v_cvt_pk_bf16_f32 v59, v12, v13
    v_cvt_pk_bf16_f32 v60, v14, v15
    v_cvt_pk_bf16_f32 v61, v16, v17
    v_cvt_pk_bf16_f32 v20, v18, v19
    v_mov_b32 v21, 0
    v_mov_b32 v18, 0
    v_mov_b32 v19, v20
    v_mfma_f32_16x16x32_bf16 v[38:41], v[68:71], v[58:61], 0
    v_mfma_f32_16x16x32_bf16 v[34:37], v[64:67], v[58:61], 0
    v_mfma_f32_16x16x32_bf16 v[30:33], v[22:25], v[58:61], 0
    v_mfma_f32_16x16x16_bf16 v[38:41], v[28:29], v[18:19], v[38:41]
    v_mfma_f32_16x16x16_bf16 v[34:37], v[28:29], v[20:21], v[34:37]
    v_mfma_f32_16x16x16_bf16 v[30:33], v[22:23], v[20:21], v[30:33]
    s_nop 7
    v_rcp_f32 v31, v30
    s_mov_b64 exec, s[48:49]
    v_pk_mul_f32 v[34:35], v[34:35], v[30:31] op_sel:[0,1] op_sel_hi:[1,1]
    v_pk_mul_f32 v[36:37], v[36:37], v[30:31] op_sel:[0,1] op_sel_hi:[1,1]
    v_cvt_pk_bf16_f32 v58, v34, v35
    v_cvt_pk_bf16_f32 v59, v36, v37
    ds_write_b64 v5, v[58:59] offset:0
    v_pk_mul_f32 v[38:39], v[38:39], v[30:31] op_sel:[0,1] op_sel_hi:[1,1]
    v_pk_mul_f32 v[40:41], v[40:41], v[30:31] op_sel:[0,1] op_sel_hi:[1,1]
    v_cvt_pk_bf16_f32 v60, v38, v39
    v_cvt_pk_bf16_f32 v61, v40, v41
    ds_write_b64 v5, v[60:61] offset:8
    s_mov_b64 exec, -1
    s_waitcnt lgkmcnt(0)
    s_branch C_F_slowret
C_S_pre:
    ds_read_b128 v[42:45], v8 offset:0
    ds_read_b128 v[46:49], v8 offset:4096
    ds_read_b128 v[50:53], v8 offset:1024
    ds_read_b128 v[54:57], v8 offset:5120
    s_lshr_b32 s60, s101, 1
    s_add_u32 s60, s60, 33554432
    s_lshr_b32 s42, s77, 2
    s_add_u32 s62, s60, s42
    s_add_u32 s62, s62, 4096
    s_add_u32 s60, s60, s100
    s_add_u32 s64, s101, s77
    s_add_u32 s63, s64, 8192
    s_cmp_lt_u32 s32, 63
    s_cselect_b32 s41, 16384, 0
    s_add_u32 s101, s101, s41
    s_add_u32 s61, s101, s78
    s_add_u32 s46, s32, 1
    s_min_u32 s46, s46, 63
    s_add_u32 s70, s34, s75
    s_add_u32 s69, s70, s77
    s_add_u32 s70, s70, 8192
    v_mov_b64 v[10:11], 0
    v_mov_b64 v[12:13], 0
    v_mov_b64 v[14:15], 0
    v_mov_b64 v[16:17], 0
    v_mov_b64 v[18:19], 0
    v_mov_b64 v[20:21], 0
    v_mov_b64 v[22:23], 0
    v_mov_b64 v[24:25], 0
    v_mov_b64 v[26:27], 0
    v_mov_b64 v[28:29], 0
    v_mov_b64 v[30:31], 0
    v_mov_b64 v[32:33], 0
    v_add_u32 v63, s77, v1
    v_xor_b32 v62, 2048, v63
    s_and_b32 s33, s32, 1
    s_sub_u32 s79, 0, s33
    s_waitcnt vmcnt(0) lgkmcnt(0)
    s_branch C_S_top
C_S_gather:
C_S_gather2:
    v_cmp_eq_u32 vcc, 0x01010101, v0
    s_nop 0
    s_ff0_i32_b64 s37, vcc
    s_min_u32 s37, s37, 64
    v_mov_b64 v[10:11], 0
    v_mov_b64 v[12:13], 0
    v_mov_b64 v[14:15], 0
    v_mov_b64 v[16:17], 0
    v_mov_b64 v[18:19], 0
    v_mov_b64 v[20:21], 0
    v_mov_b64 v[22:23], 0
    v_mov_b64 v[24:25], 0
    v_mov_b64 v[26:27], 0
    v_mov_b64 v[28:29], 0
    v_mov_b64 v[30:31], 0
    v_mov_b64 v[32:33], 0
    v_add_u32 v63, s77, v1
    v_xor_b32 v62, 2048, v63
    s_and_b32 s33, s32, 1
    s_sub_u32 s79, 0, s33
    s_mov_b32 s47, 0
    s_mov_b32 s35, s34
    s_add_u32 s34, s34, 65536
    s_cmp_eq_u32 s34, 51576832
    s_cselect_b32 s34, 51380224, s34
    s_cmp_lg_u32 s38, 1
    s_cbranch_scc1 C_S_g_poll
    s_waitcnt vmcnt(2)
    v_max3_u32 v0, v34, v36, v58
    v_max_u32 v0, v0, v60
    v_cmp_eq_u32 vcc, s50, v0
    s_cbranch_vccz C_S_top
C_S_g_poll:
    buffer_load_dwordx4 v[34:37], v1, s[24:27], s69 offen sc1
    buffer_load_dwordx4 v[58:61], v1, s[24:27], s70 offen sc1
    s_add_u32 s47, s47, 1
    s_cmp_gt_u32 s47, 60000
    s_cbranch_scc1 C_S_g_out
    s_waitcnt vmcnt(0)
    v_max3_u32 v0, v34, v36, v58
    v_max_u32 v0, v0, v60
    v_cmp_eq_u32 vcc, s50, v0
    s_cbranch_vccnz C_S_g_poll
C_S_top:
    v_smfmac_f32_16x16x64_bf16 v[10:13], v[34:37], v[42:49], v3
    ds_read_b128 v[42:45], v8 offset:2048
    ds_read_b128 v[46:49], v8 offset:6144
    v_smfmac_f32_16x16x64_bf16 v[14:17], v[34:37], v[50:57], v3
    ds_read_b128 v[50:53], v8 offset:3072
    ds_read_b128 v[54:57], v8 offset:7168
    v_smfmac_f32_16x16x64_bf16 v[26:29], v[34:37], a[224:231], v3
    ds_write_b128 v63, v[34:37] offset:0
    v_smfmac_f32_16x16x64_bf16 v[30:33], v[34:37], a[232:239], v3
    s_cmp_le_u32 s37, s46
    s_cbranch_scc1 C_S_kvw
C_S_kvr:
    v_smfmac_f32_16x16x64_bf16 v[10:13], v[58:61], a[192:199], v3
    s_cmp_lg_u32 s32, 0
    s_cselect_b64 exec, -1, 0
    buffer_load_dwordx4 v[38:41], v1, s[24:27], s69 offen offset:1024 sc1
    s_mov_b64 exec, -1
    v_smfmac_f32_16x16x64_bf16 v[14:17], v[58:61], a[200:207], v3
    s_waitcnt lgkmcnt(3)
    buffer_load_dwordx4 v1, s[24:27], s64 offen sc1 lds
    v_smfmac_f32_16x16x64_bf16 v[18:21], v[34:37], v[42:49], v3
    s_waitcnt lgkmcnt(1)
    v_lshrrev_b32 v0, 5, v1
    v_smfmac_f32_16x16x64_bf16 v[22:25], v[34:37], v[50:57], v3
    ds_read_b128 v[42:45], v8 offset:8192
    v_smfmac_f32_16x16x64_bf16 v[18:21], v[58:61], a[208:215], v3
    s_waitcnt lgkmcnt(1)
    s_barrier
    ds_read_b128 v[34:37], v62 offset:0
    ds_read_b128 v[46:49], v8 offset:12288
    ds_read_b128 v[50:53], v8 offset:9216
    v_smfmac_f32_16x16x64_bf16 v[22:25], v[58:61], a[216:223], v3
    buffer_load_dwordx4 v1, s[24:27], s64 offen offset:1024 sc1 lds
    ds_read_b128 v[54:57], v8 offset:13312
    v_smfmac_f32_16x16x64_bf16 v[26:29], v[58:61], v[104:111], v3
    v_xor_b32 v62, 4096, v63
    buffer_load_dwordx4 v[64:67], v1, s[24:27], s63 offen sc1
    v_smfmac_f32_16x16x64_bf16 v[30:33], v[58:61], v[112:119], v3
    s_waitcnt lgkmcnt(2)
    ds_read_b128 v[58:61], v62 offset:0
    buffer_load_dwordx4 v[68:71], v1, s[24:27], s63 offen offset:1024 sc1
    v_smfmac_f32_16x16x64_bf16 v[10:13], v[34:37], v[42:49], v3
    s_waitcnt lgkmcnt(1)
    ds_read_b128 v[42:45], v8 offset:10240
    v_smfmac_f32_16x16x64_bf16 v[14:17], v[34:37], v[50:57], v3
    v_lshlrev_b32 v0, 7, v0
    v_smfmac_f32_16x16x64_bf16 v[26:29], v[34:37], a[240:247], v3
    ds_read_b128 v[46:49], v8 offset:14336
    ds_read_b128 v[50:53], v8 offset:11264
    v_smfmac_f32_16x16x64_bf16 v[30:33], v[34:37], a[248:255], v3
    s_waitcnt lgkmcnt(3)
    buffer_load_dword v0, v0, s[24:27], s61 offen sc1
    ds_read_b128 v[54:57], v8 offset:15360
    v_smfmac_f32_16x16x64_bf16 v[10:13], v[58:61], a[64:71], v3
    v_xor_b32 v62, 6144, v63
    v_smfmac_f32_16x16x64_bf16 v[14:17], v[58:61], a[72:79], v3
    s_waitcnt lgkmcnt(2)
    v_lshrrev_b32 v0, 2, v1
    v_smfmac_f32_16x16x64_bf16 v[18:21], v[34:37], v[42:49], v3
    s_waitcnt lgkmcnt(0)
    buffer_load_dword v0, v0, s[24:27], s68 offen sc1
    v_smfmac_f32_16x16x64_bf16 v[22:25], v[34:37], v[50:57], v3
    ds_read_b128 v[34:37], v62 offset:0
    ds_read_b128 v[42:45], v8 offset:24576
    v_smfmac_f32_16x16x64_bf16 v[18:21], v[58:61], a[80:87], v3
    s_waitcnt vmcnt(6)
    v_cmp_eq_u32 s[44:45], s50, v38
    ds_read_b128 v[46:49], v8 offset:26624
    ds_read_b128 v[50:53], v8 offset:25600
    v_smfmac_f32_16x16x64_bf16 v[22:25], v[58:61], a[88:95], v3
    v_cmp_eq_u32 vcc, s50, v40
    ds_read_b128 v[54:57], v8 offset:27648
    v_smfmac_f32_16x16x64_bf16 v[26:29], v[58:61], v[120:127], v3
    s_or_b64 vcc, vcc, s[44:45]
    s_cbranch_scc1 C_S_late1
C_S_late1r:
    ds_write_b128 v63, v[38:41] offset:1024
    v_smfmac_f32_16x16x64_bf16 v[30:33], v[58:61], v[128:135], v3
    s_waitcnt lgkmcnt(5)
    v_xor_b32 v62, 2048, v63
    v_smfmac_f32_16x16x64_bf16 v[10:13], v[34:37], a[128:135], v3
    v_smfmac_f32_16x16x64_bf16 v[14:17], v[34:37], a[136:143], v3
    v_smfmac_f32_16x16x64_bf16 v[18:21], v[34:37], a[144:151], v3
    v_smfmac_f32_16x16x64_bf16 v[22:25], v[34:37], a[152:159], v3
    s_waitcnt lgkmcnt(3)
    v_smfmac_f32_16x16x64_bf16 v[26:29], v[34:37], v[42:49], v3
    s_waitcnt lgkmcnt(0)
    s_barrier
    ds_read_b128 v[58:61], v62 offset:1024
    v_smfmac_f32_16x16x64_bf16 v[30:33], v[34:37], v[50:57], v3
    v_xor_b32 v62, 4096, v63
    v_smfmac_f32_16x16x64_bf16 v[10:13], v[38:41], a[0:7], v3
    ds_read_b128 v[34:37], v62 offset:1024
    v_smfmac_f32_16x16x64_bf16 v[14:17], v[38:41], a[8:15], v3
    v_xor_b32 v62, 6144, v63
    v_smfmac_f32_16x16x64_bf16 v[18:21], v[38:41], a[16:23], v3
    v_smfmac_f32_16x16x64_bf16 v[22:25], v[38:41], a[24:31], v3
    s_waitcnt lgkmcnt(1)
    ds_read_b128 v[38:41], v62 offset:1024
    v_smfmac_f32_16x16x64_bf16 v[10:13], v[58:61], a[32:39], v3
    ds_read_b128 v[42:45], v8 offset:28672
    v_smfmac_f32_16x16x64_bf16 v[14:17], v[58:61], a[40:47], v3
    s_waitcnt lgkmcnt(2)
    ds_read_b128 v[46:49], v8 offset:30720
    v_smfmac_f32_16x16x64_bf16 v[10:13], v[34:37], a[96:103], v3
    ds_read_b128 v[50:53], v8 offset:29696
    v_smfmac_f32_16x16x64_bf16 v[14:17], v[34:37], a[104:111], v3
    s_waitcnt lgkmcnt(3)
    ds_read_b128 v[54:57], v8 offset:31744
    v_smfmac_f32_16x16x64_bf16 v[10:13], v[38:41], a[160:167], v3
    v_smfmac_f32_16x16x64_bf16 v[14:17], v[38:41], a[168:175], v3
    v_smfmac_f32_16x16x64_bf16 v[18:21], v[58:61], a[48:55], v3
    v_add_f32 v10, v10, v12
    v_smfmac_f32_16x16x64_bf16 v[22:25], v[58:61], a[56:63], v3
    v_add_f32 v11, v11, v13
    v_smfmac_f32_16x16x64_bf16 v[18:21], v[34:37], a[112:119], v3
    v_cvt_pk_bf16_f32 v12, v10, v11
    v_smfmac_f32_16x16x64_bf16 v[22:25], v[34:37], a[120:127], v3
    v_add_f32 v14, v14, v16
    ds_write_b32 v4, v12 offset:0
    v_smfmac_f32_16x16x64_bf16 v[18:21], v[38:41], a[176:183], v3
    v_add_f32 v15, v15, v17
    v_smfmac_f32_16x16x64_bf16 v[22:25], v[38:41], a[184:191], v3
    v_cvt_pk_bf16_f32 v13, v14, v15
    v_smfmac_f32_16x16x64_bf16 v[26:29], v[58:61], v[88:95], v3
    ds_write_b32 v4, v13 offset:512
    v_add_f32 v18, v18, v20
    v_add_f32 v19, v19, v21
    v_cvt_pk_bf16_f32 v14, v18, v19
    ds_write_b32 v4, v14 offset:1024
    v_add_f32 v22, v22, v24
    v_add_f32 v23, v23, v25
    v_cvt_pk_bf16_f32 v15, v22, v23
    ds_write_b32 v4, v15 offset:1536
    v_smfmac_f32_16x16x64_bf16 v[30:33], v[58:61], v[96:103], v3
    s_waitcnt lgkmcnt(6)
    buffer_store_dwordx4 v[12:15], v1, s[12:15], s60 offen sc1
    v_smfmac_f32_16x16x64_bf16 v[26:29], v[38:41], v[42:49], v3
    s_waitcnt lgkmcnt(4)
    v_smfmac_f32_16x16x64_bf16 v[30:33], v[38:41], v[50:57], v3
    ds_read_b128 v[38:41], v63 offset:1024
    v_smfmac_f32_16x16x64_bf16 v[26:29], v[34:37], v[136:143], v3
    s_waitcnt lgkmcnt(1) vmcnt(3)
    s_barrier
    ds_read_b64_tr_b16 v[22:23], v2 offset:8192
    ds_read_b64_tr_b16 v[24:25], v2 offset:8704
    ds_read_b128 v[42:45], v1 offset:16384
    ds_read_b128 v[46:49], v1 offset:20480
    ds_read_b64_tr_b16 v[58:59], v2 offset:9216
    ds_read_b64_tr_b16 v[60:61], v2 offset:9728
    ds_read_b128 v[50:53], v1 offset:17408
    ds_read_b128 v[54:57], v1 offset:21504
    v_smfmac_f32_16x16x64_bf16 v[30:33], v[34:37], v[144:151], v3
    s_waitcnt lgkmcnt(8)
    ds_read_b64_tr_b16 v[34:35], v2 offset:10240
    ds_read_b64_tr_b16 v[36:37], v2 offset:10752
    v_smfmac_f32_16x16x64_bf16 v[26:29], v[38:41], v[72:79], v3
    v_smfmac_f32_16x16x64_bf16 v[30:33], v[38:41], v[80:87], v3
    s_waitcnt lgkmcnt(8)
    ds_read_b64_tr_b16 v[38:39], v2 offset:11264
    ds_read_b64_tr_b16 v[40:41], v2 offset:11776
    v_mfma_f32_16x16x32_bf16 v[18:21], v[22:25], v[22:25], 0
    s_waitcnt lgkmcnt(9)
    v_mfma_f32_16x16x32_bf16 v[10:13], v[42:45], v[22:25], 0
    s_waitcnt lgkmcnt(8)
    ds_read_b128 v[42:45], v1 offset:18432
    v_mfma_f32_16x16x32_bf16 v[14:17], v[46:49], v[22:25], 0
    s_waitcnt lgkmcnt(7)
    ds_read_b128 v[46:49], v1 offset:22528
    v_mov_b64 v[22:23], s[72:73]
    v_mfma_f32_16x16x32_bf16 v[18:21], v[58:61], v[58:61], v[18:21]
    s_waitcnt lgkmcnt(7)
    v_add_f32 v26, v26, v28
    v_mfma_f32_16x16x32_bf16 v[10:13], v[50:53], v[58:61], v[10:13]
    s_waitcnt lgkmcnt(6)
    ds_read_b128 v[50:53], v1 offset:19456
    v_add_f32 v27, v27, v29
    v_mfma_f32_16x16x32_bf16 v[14:17], v[54:57], v[58:61], v[14:17]
    s_waitcnt lgkmcnt(5)
    ds_read_b128 v[54:57], v1 offset:23552
    v_mov_b64 v[24:25], s[72:73]
    v_mfma_f32_16x16x32_bf16 v[18:21], v[34:37], v[34:37], v[18:21]
    s_waitcnt lgkmcnt(3)
    v_add_f32 v30, v30, v32
    v_mfma_f32_16x16x32_bf16 v[10:13], v[42:45], v[34:37], v[10:13]
    s_waitcnt lgkmcnt(2)
    v_add_f32 v31, v31, v33
    v_mfma_f32_16x16x32_bf16 v[14:17], v[46:49], v[34:37], v[14:17]
    ds_read_b128 v[42:45], v8 offset:16384
    ds_read_b128 v[46:49], v8 offset:20480
    v_mfma_f32_16x16x32_bf16 v[18:21], v[38:41], v[38:41], v[18:21]
    s_waitcnt lgkmcnt(3)
    v_cvt_pk_bf16_f32 v28, v26, v27
    v_mfma_f32_16x16x32_bf16 v[10:13], v[50:53], v[38:41], v[10:13]
    s_waitcnt lgkmcnt(2)
    v_cvt_pk_bf16_f32 v29, v30, v31
    v_mfma_f32_16x16x32_bf16 v[14:17], v[54:57], v[38:41], v[14:17]
    ds_read_b128 v[50:53], v8 offset:17408
    ds_read_b128 v[54:57], v8 offset:21504
    v_mul_f32 v18, s40, v18
    v_mul_f32 v19, s40, v19
    buffer_store_dwordx2 v[28:29], v2, s[24:27], s62 offen sc1
    s_cmp_eq_u32 s32, 63
    v_exp_f32 v62, v18
    v_exp_f32 v63, v19
    s_cbranch_scc1 C_end
    v_exp_f32 v26, v10
    v_exp_f32 v27, v11
    v_cvt_pk_bf16_f32 v20, v62, v63
    v_mov_b32 v21, 0
    v_exp_f32 v32, v12
    v_exp_f32 v33, v13
    v_mfma_f32_16x16x16_bf16 v[34:37], v[28:29], v[20:21], 0
    v_cvt_pk_bf16_f32 v63, v62, v63
    v_mov_b32 v62, 0
    v_cvt_pk_bf16_f32 v58, v26, v27
    v_exp_f32 v26, v14
    v_mfma_f32_16x16x16_bf16 v[38:41], v[28:29], v[62:63], 0
    v_exp_f32 v27, v15
    v_cvt_pk_bf16_f32 v59, v32, v33
    v_exp_f32 v62, v16
    v_mfma_f32_16x16x16_bf16 v[30:33], v[22:23], v[20:21], 0
    v_exp_f32 v63, v17
    v_cvt_pk_bf16_f32 v60, v26, v27
    v_cvt_pk_bf16_f32 v61, v62, v63
    s_nop 2
    v_mfma_f32_16x16x32_bf16 v[30:33], v[22:25], v[58:61], v[30:33]
    v_mfma_f32_16x16x32_bf16 v[34:37], v[64:67], v[58:61], v[34:37]
    v_mfma_f32_16x16x32_bf16 v[38:41], v[68:71], v[58:61], v[38:41]
    v_rcp_f32 v31, v30
    s_mov_b64 exec, s[48:49]
    s_nop 1
    v_pk_mul_f32 v[34:35], v[34:35], v[30:31] op_sel:[0,1] op_sel_hi:[1,1]
    v_pk_mul_f32 v[36:37], v[36:37], v[30:31] op_sel:[0,1] op_sel_hi:[1,1]
    v_cvt_pk_bf16_f32 v58, v34, v35
    v_cvt_pk_bf16_f32 v59, v36, v37
    ds_write_b64 v5, v[58:59] offset:0
    v_pk_mul_f32 v[38:39], v[38:39], v[30:31] op_sel:[0,1] op_sel_hi:[1,1]
    v_pk_mul_f32 v[40:41], v[40:41], v[30:31] op_sel:[0,1] op_sel_hi:[1,1]
    v_cvt_pk_bf16_f32 v60, v38, v39
    v_cvt_pk_bf16_f32 v61, v40, v41
    ds_write_b64 v5, v[60:61] offset:8
    v_max_f32 v32, v30, v31
    v_cmp_nlt_f32 vcc, v32, s74
    s_mov_b64 exec, -1
    s_cbranch_vccnz C_S_slow
C_S_slowret:
    ds_read_b128 v[34:37], v8 offset:32768
    ds_read_b128 v[38:41], v8 offset:33792
    v_mov_b64 v[18:19], 0
    v_mov_b64 v[20:21], 0
    v_mov_b64 v[22:23], 0
    v_mov_b64 v[24:25], 0
    v_mov_b64 v[64:65], 0
    v_mov_b64 v[66:67], 0
    v_mov_b64 v[68:69], 0
    v_mov_b64 v[70:71], 0
    s_waitcnt lgkmcnt(2)
    s_barrier
    ds_read_b128 v[10:13], v1 offset:12288
    ds_read_b128 v[14:17], v1 offset:13312
    v_mov_b64 v[26:27], 0
    v_mov_b64 v[28:29], 0
    v_mov_b64 v[30:31], 0
    v_mov_b64 v[32:33], 0
    s_waitcnt lgkmcnt(1)
    v_smfmac_f32_16x16x64_bf16 v[18:21], v[10:13], v[184:191], v3
    v_smfmac_f32_16x16x64_bf16 v[22:25], v[10:13], v[192:199], v3
    s_waitcnt lgkmcnt(0)
    v_smfmac_f32_16x16x64_bf16 v[18:21], v[14:17], v[216:223], v3
    v_smfmac_f32_16x16x64_bf16 v[22:25], v[14:17], v[224:231], v3
    v_smfmac_f32_16x16x64_bf16 v[64:67], v[10:13], v[200:207], v3
    v_add_f32 v18, v18, v20
    v_smfmac_f32_16x16x64_bf16 v[68:71], v[10:13], v[208:215], v3
    v_add_f32 v19, v19, v21
    v_cvt_pk_bf16_f32 v58, v18, v19
    v_smfmac_f32_16x16x64_bf16 v[64:67], v[14:17], v[232:239], v3
    v_bfi_b32 v58, 1, s33, v58
    v_add_f32 v22, v22, v24
    v_smfmac_f32_16x16x64_bf16 v[68:71], v[14:17], v[240:247], v3
    v_add_f32 v23, v23, v25
    v_cvt_pk_bf16_f32 v59, v22, v23
    v_smfmac_f32_16x16x64_bf16 v[26:29], v[10:13], v[34:41], v3
    v_add_f32 v64, v64, v66
    v_smfmac_f32_16x16x64_bf16 v[26:29], v[14:17], v[248:255], v3
    v_add_f32 v65, v65, v67
    v_cvt_pk_bf16_f32 v60, v64, v65
    v_add_f32 v68, v68, v70
    v_mov_b64 v[18:19], 0
    v_mov_b64 v[20:21], 0
    v_smfmac_f32_16x16x64_bf16 v[30:33], v[10:13], v[42:49], v3
    v_add_f32 v69, v69, v71
    v_cvt_pk_bf16_f32 v61, v68, v69
    buffer_store_dwordx4 v[58:61], v6, s[24:27], s66 offen sc1
    v_smfmac_f32_16x16x64_bf16 v[18:21], v[10:13], v[50:57], v3
    ds_read_b128 v[42:45], v8 offset:18432
    v_add_f32 v26, v26, v28
    v_mov_b64 v[22:23], 0
    v_smfmac_f32_16x16x64_bf16 v[30:33], v[14:17], v[152:159], v3
    ds_read_b128 v[46:49], v8 offset:22528
    ds_read_b128 v[50:53], v8 offset:19456
    v_add_f32 v27, v27, v29
    v_cvt_pk_bf16_f32 v62, v26, v27
    v_bfi_b32 v62, 1, s33, v62
    buffer_store_dword v62, v9, s[24:27], s67 offen sc1
    v_mov_b64 v[24:25], 0
    v_smfmac_f32_16x16x64_bf16 v[18:21], v[14:17], v[160:167], v3
    ds_read_b128 v[54:57], v8 offset:23552
    v_mov_b64 v[34:35], 0
    v_mov_b64 v[36:37], 0
    v_smfmac_f32_16x16x64_bf16 v[22:25], v[14:17], v[168:175], v3
    v_smfmac_f32_16x16x64_bf16 v[34:37], v[14:17], v[176:183], v3
    s_waitcnt lgkmcnt(2)
    v_add_f32 v30, v30, v32
    v_smfmac_f32_16x16x64_bf16 v[22:25], v[10:13], v[42:49], v3
    s_waitcnt lgkmcnt(0)
    v_add_f32 v31, v31, v33
    v_cvt_pk_bf16_f32 v58, v30, v31
    v_bfi_b32 v58, 1, s33, v58
    v_add_f32 v18, v18, v20
    v_smfmac_f32_16x16x64_bf16 v[34:37], v[10:13], v[50:57], v3
    v_add_f32 v19, v19, v21
    v_cvt_pk_bf16_f32 v59, v18, v19
    ds_read_b128 v[64:67], v1 offset:14336
    v_add_f32 v22, v22, v24
    v_add_f32 v23, v23, v25
    v_cvt_pk_bf16_f32 v60, v22, v23
    s_nop 1
    v_add_f32 v34, v34, v36
    v_add_f32 v35, v35, v37
    v_cvt_pk_bf16_f32 v61, v34, v35
    buffer_store_dwordx4 v[58:61], v6, s[24:27], s65 offen sc1
    s_add_u32 s32, s32, 1
    ds_read_b128 v[42:45], v8 offset:0
    ds_read_b128 v[46:49], v8 offset:4096
    ds_read_b128 v[50:53], v8 offset:1024
    ds_read_b128 v[54:57], v8 offset:5120
    s_lshr_b32 s60, s101, 1
    s_add_u32 s60, s60, 33554432
    s_lshr_b32 s42, s77, 2
    s_add_u32 s62, s60, s42
    s_add_u32 s62, s62, 4096
    s_add_u32 s60, s60, s100
    s_add_u32 s64, s101, s77
    s_add_u32 s63, s64, 8192
    s_cmp_lt_u32 s32, 63
    s_cselect_b32 s41, 16384, 0
    s_add_u32 s101, s101, s41
    s_add_u32 s61, s101, s78
    s_add_u32 s46, s32, 1
    s_min_u32 s46, s46, 63
    s_add_u32 s70, s34, s75
    s_add_u32 s69, s70, s77
    s_add_u32 s70, s70, 8192
    s_mov_b32 s47, 0
    s_cmp_lg_u32 s38, 0
    s_waitcnt lgkmcnt(0)
    s_cbranch_scc1 C_S_notearly
C_S_r_poll:
    buffer_load_dwordx4 v[10:13], v1, s[24:27], s36 offen offset:0 sc1
    buffer_load_dwordx4 v[14:17], v1, s[24:27], s36 offen offset:1024 sc1
    buffer_load_dwordx4 v[18:21], v1, s[24:27], s36 offen offset:2048 sc1
    buffer_load_dwordx4 v[22:25], v1, s[24:27], s36 offen offset:3072 sc1
    s_add_u32 s47, s47, 1
    s_cmp_lt_u32 s47, 60000
    s_cselect_b32 s42, 1, 0
    s_waitcnt vmcnt(3)
    v_mfma_f32_16x16x32_bf16 v[68:71], v[64:67], v[10:13], 0
    s_waitcnt vmcnt(2)
    v_mfma_f32_16x16x32_bf16 v[68:71], v[64:67], v[14:17], v[68:71]
    v_bitop3_b32 v62, v10, v14, s79 bitop3:0x7e
    s_waitcnt vmcnt(1)
    v_mfma_f32_16x16x32_bf16 v[68:71], v[64:67], v[18:21], v[68:71]
    s_waitcnt vmcnt(0)
    v_mfma_f32_16x16x32_bf16 v[68:71], v[64:67], v[22:25], v[68:71]
    buffer_load_dwordx4 v[34:37], v1, s[96:99], s69 offen sc1
    buffer_load_dwordx4 v[58:61], v1, s[96:99], s70 offen sc1
    v_bitop3_b32 v63, v18, v22, s79 bitop3:0x7e
    v_bitop3_b32 v62, v62, v63, s42 bitop3:0xa8
    v_cmp_ne_u32 vcc, 0, v62
    s_nop 2
    v_add_f32_dpp v68, v68, v68 row_ror:8 row_mask:0xf bank_mask:0xf
    v_add_f32_dpp v69, v69, v69 row_ror:8 row_mask:0xf bank_mask:0xf
    v_add_f32_dpp v70, v70, v70 row_ror:8 row_mask:0xf bank_mask:0xf
    v_add_f32_dpp v71, v71, v71 row_ror:8 row_mask:0xf bank_mask:0xf
    v_cvt_pk_bf16_f32 v68, v68, v69
    v_cvt_pk_bf16_f32 v69, v70, v71
    s_cbranch_vccnz C_S_r_poll
    buffer_store_dwordx2 v[68:69], v7, s[24:27], s34 offen sc1
    v_mov_b64 v[62:63], s[50:51]
    buffer_store_dwordx2 v[62:63], v7, s[24:27], s35 offen sc1
    s_branch C_S_gather
C_S_notearly:
    s_cmp_eq_u32 s38, 2
    s_waitcnt vmcnt(0)
    s_cbranch_scc1 C_S_gather
    s_branch C_S_r_poll
C_S_g_out:
    s_waitcnt vmcnt(0)
    s_branch C_S_top
C_S_late1:
    s_mov_b32 s47, 0
C_S_late1l:
    buffer_load_dwordx4 v[38:41], v1, s[24:27], s69 offen offset:1024 sc1
    s_add_u32 s47, s47, 1
    s_waitcnt vmcnt(0)
    v_cmp_eq_u32 s[44:45], s50, v38
    v_cmp_eq_u32 vcc, s50, v40
    s_nop 0
    s_or_b64 vcc, vcc, s[44:45]
    s_cmp_gt_u32 s47, 20000
    s_cbranch_scc1 C_S_late1r
    s_cbranch_vccnz C_S_late1l
    s_branch C_S_late1r
C_S_kvw:
    s_nop 3
    v_lshrrev_b32 v65, 2, v1
    s_mov_b32 s47, 0
C_S_kvl:
    buffer_load_dword v64, v65, s[24:27], s68 offen sc1
    s_add_u32 s47, s47, 1
    s_waitcnt vmcnt(0)
    v_cmp_eq_u32 vcc, 0x01010101, v64
    s_nop 0
    s_ff0_i32_b64 s37, vcc
    s_min_u32 s37, s37, 64
    s_cmp_gt_u32 s47, 160000
    s_nop 0
    s_cbranch_scc1 C_S_kvl_d
    s_cmp_gt_u32 s37, s46
    s_cbranch_scc1 C_S_kvl_d
    s_sleep 4
    s_branch C_S_kvl
C_S_kvl_d:
    s_branch C_S_kvr
C_S_slow:
    s_nop 15
    v_max3_f32 v30, v10, v11, v12
    v_max3_f32 v31, v13, v14, v15
    v_max3_f32 v30, v30, v16, v17
    v_max3_f32 v31, v31, v18, v19
    v_max_f32 v30, v30, v31
    v_mov_b32 v31, v30
    s_nop 1
    v_permlane32_swap_b32 v30, v31
    v_max_f32 v30, v30, v31
    v_mov_b32 v31, v30
    s_nop 1
    v_permlane16_swap_b32 v30, v31
    v_max_f32 v30, v30, v31
    v_sub_f32 v10, v10, v30
    v_sub_f32 v11, v11, v30
    v_sub_f32 v12, v12, v30
    v_sub_f32 v13, v13, v30
    v_sub_f32 v14, v14, v30
    v_sub_f32 v15, v15, v30
    v_sub_f32 v16, v16, v30
    v_sub_f32 v17, v17, v30
    v_sub_f32 v18, v18, v30
    v_sub_f32 v19, v19, v30
    v_exp_f32 v10, v10
    v_exp_f32 v11, v11
    v_exp_f32 v12, v12
    v_exp_f32 v13, v13
    v_exp_f32 v14, v14
    v_exp_f32 v15, v15
    v_exp_f32 v16, v16
    v_exp_f32 v17, v17
    v_exp_f32 v18, v18
    v_exp_f32 v19, v19
    v_cvt_pk_bf16_f32 v58, v10, v11
    v_cvt_pk_bf16_f32 v59, v12, v13
    v_cvt_pk_bf16_f32 v60, v14, v15
    v_cvt_pk_bf16_f32 v61, v16, v17
    v_cvt_pk_bf16_f32 v20, v18, v19
    v_mov_b32 v21, 0
    v_mov_b32 v18, 0
    v_mov_b32 v19, v20
    v_mfma_f32_16x16x32_bf16 v[38:41], v[68:71], v[58:61], 0
    v_mfma_f32_16x16x32_bf16 v[34:37], v[64:67], v[58:61], 0
    v_mfma_f32_16x16x32_bf16 v[30:33], v[22:25], v[58:61], 0
    v_mfma_f32_16x16x16_bf16 v[38:41], v[28:29], v[18:19], v[38:41]
    v_mfma_f32_16x16x16_bf16 v[34:37], v[28:29], v[20:21], v[34:37]
    v_mfma_f32_16x16x16_bf16 v[30:33], v[22:23], v[20:21], v[30:33]
    s_nop 7
    v_rcp_f32 v31, v30
    s_mov_b64 exec, s[48:49]
    v_pk_mul_f32 v[34:35], v[34:35], v[30:31] op_sel:[0,1] op_sel_hi:[1,1]
    v_pk_mul_f32 v[36:37], v[36:37], v[30:31] op_sel:[0,1] op_sel_hi:[1,1]
    v_cvt_pk_bf16_f32 v58, v34, v35
    v_cvt_pk_bf16_f32 v59, v36, v37
    ds_write_b64 v5, v[58:59] offset:0
    v_pk_mul_f32 v[38:39], v[38:39], v[30:31] op_sel:[0,1] op_sel_hi:[1,1]
    v_pk_mul_f32 v[40:41], v[40:41], v[30:31] op_sel:[0,1] op_sel_hi:[1,1]
    v_cvt_pk_bf16_f32 v60, v38, v39
    v_cvt_pk_bf16_f32 v61, v40, v41
    ds_write_b64 v5, v[60:61] offset:8
    s_mov_b64 exec, -1
    s_waitcnt lgkmcnt(0)
    s_branch C_S_slowret
C_end:
    s_endpgm
    s_endpgm
.section .rodata,"a"
.p2align 6
.amdhsa_kernel concat_heads__softmax_full_mha__memory_aug_recurrent_mem_tr__prompt_kernel
  .amdhsa_next_free_vgpr 512
  .amdhsa_next_free_sgpr 102
  .amdhsa_accum_offset 256
  .amdhsa_group_segment_fixed_size 0
  .amdhsa_kernarg_size 104
  .amdhsa_user_sgpr_count 2
  .amdhsa_user_sgpr_kernarg_segment_ptr 1
  .amdhsa_system_sgpr_workgroup_id_x 1
.end_amdhsa_kernel
.text
```
